```python
import torch

def _softmax(x, axis=-1):
    return torch.softmax(x, dim=axis)

def _gelu(x):
    return torch.nn.functional.gelu(x, approximate='tanh')

def _silu(x):
    return torch.nn.functional.silu(x)

def _sigmoid(x):
    return torch.sigmoid(x)

def _layernorm(x, axis=-1, eps=1e-05):
    m = x.mean(dim=axis, keepdim=True)
    v = x.var(dim=axis, keepdim=True, unbiased=False)
    return (x - m) / torch.sqrt(v + eps)

def _scatter_add(tgt, idx, src, axis=0):
    return tgt.clone().index_add_(axis, idx, src)

def _segment_sum(src, seg, n):
    out = torch.zeros((n,) + src.shape[1:], dtype=src.dtype)
    return out.index_add_(0, seg, src)

def _pad(x, pw):
    flat = tuple((v for pair in reversed(pw) for v in pair))
    return torch.nn.functional.pad(x, flat)
kernel_name = 'adaLN_cond__mha_block_cached__mixer_s_mlp__prompt'

def setup_inputs():

    _w = lambda a: (lambda t: t.to(torch.bfloat16) if t.is_floating_point() else t)(torch.as_tensor(a))

    def _A_setup():
        B, Sq, D = (1, 2048, 512)
        H, Sk, Dh = (32, 2048, 128)
        return {'x': _w((lambda *s: torch.randn(*s, dtype=torch.bfloat16) * 0.1)(B, Sq, D)), 'k_cache': _w((lambda *s: torch.randn(*s, dtype=torch.bfloat16) * 0.8)(B, H, Sk, Dh)), 'v_cache': _w((lambda *s: torch.randn(*s, dtype=torch.bfloat16) * 0.8)(B, H, Sk, Dh)), 'wq': _w((lambda *s: torch.randn(*s, dtype=torch.bfloat16) * 0.8)(D, H * Dh) * D ** (-0.5)), 'wo': _w((lambda *s: torch.randn(*s, dtype=torch.bfloat16) * 0.8)(H * Dh, D) * (H * Dh) ** (-0.5))}
    _A_in = _A_setup()

    def _B_setup():
        B, S, D, F = (1, 2048, 512, 1792)
        return {'x': _w((lambda *s: torch.randn(*s, dtype=torch.bfloat16) * 0.1)(B, S, D)), 'w1': _w((lambda *s: torch.randn(*s, dtype=torch.bfloat16) * 3.2)(D, D) * D ** (-0.5)), 'w2': _w((lambda *s: torch.randn(*s, dtype=torch.bfloat16) * 3.2)(D, D) * D ** (-0.5)), 'w3': _w((lambda *s: torch.randn(*s, dtype=torch.bfloat16) * 3.2)(D, F) * D ** (-0.5)), 'w4': _w((lambda *s: torch.randn(*s, dtype=torch.bfloat16) * 3.2)(F, D) * F ** (-0.5))}
    _B_in = _B_setup()
    return {'A_x': _A_in['x'], 'A_k_cache': _A_in['k_cache'], 'A_v_cache': _A_in['v_cache'], 'A_wq': _A_in['wq'], 'A_wo': _A_in['wo'], 'B_x': _B_in['x'], 'B_w1': _B_in['w1'], 'B_w2': _B_in['w2'], 'B_w3': _B_in['w3'], 'B_w4': _B_in['w4'], 'c': _w((lambda *s: torch.randn(*s, dtype=torch.bfloat16) * 0.2)(1, 512) * 8.0), 'w_mod': _w((lambda *s: torch.randn(*s, dtype=torch.bfloat16) * 0.2)(512, 6 * 512) * 512 ** (-0.5) * 8.0)}

def reference(A_x, A_k_cache, A_v_cache, A_wq, A_wo, B_x, B_w1, B_w2, B_w3, B_w4, c, w_mod):

    def _A_ref(x, k_cache, v_cache, wq, wo):
        B, Sq, D = x.shape
        H, Dh = (32, 128)
        q = (lambda x, *d: x.permute(*d))((x @ wq).reshape(B, Sq, H, Dh), 0, 2, 1, 3)
        scores = torch.einsum('bhqd,bhkd->bhqk', q, k_cache) * Dh ** (-0.5)
        p = _softmax(scores, axis=-1)
        o = torch.einsum('bhqk,bhkd->bhqd', p, v_cache)
        return (lambda x, *d: x.permute(*d))(o, 0, 2, 1, 3).reshape(B, Sq, H * Dh) @ wo

    def _B_ref(x, w1, w2, w3, w4):
        B, S, D = x.shape
        h = _gelu(_layernorm(x, axis=-1) @ w1)
        c = D // 4
        g0 = _pad(h[:, :, 0 * c:1 * c], ((0, 0), (1, 0), (0, 0)))[:, :S, :]
        g1 = _pad(h[:, :, 1 * c:2 * c], ((0, 0), (0, 1), (0, 0)))[:, 1:, :]
        g2 = _pad(h[:, :, 2 * c:3 * c], ((0, 0), (2, 0), (0, 0)))[:, :S, :]
        g3 = _pad(h[:, :, 3 * c:], ((0, 0), (0, 2), (0, 0)))[:, 2:, :]
        hs = torch.concatenate([g0, g1, g2, g3], axis=-1) @ w2
        x1 = x + hs
        h2 = _gelu(_layernorm(x1, axis=-1) @ w3) @ w4
        return x1 + h2
    x = A_x
    mod = (_silu(c) @ w_mod).reshape(c.shape[0], 6, 1, -1)
    sa, ca, ga, sb, cb, gb = (mod[:, 0].clone(), mod[:, 1].clone(), mod[:, 2].clone(), mod[:, 3].clone(), mod[:, 4].clone(), mod[:, 5].clone())
    h = _layernorm(x, axis=-1) * (1 + ca) + sa
    x = x + ga * _A_ref(h, A_k_cache, A_v_cache, A_wq, A_wo)
    h = _layernorm(x, axis=-1) * (1 + cb) + sb
    x = x + gb * _B_ref(h, B_w1, B_w2, B_w3, B_w4)
    return x
```

```asm
; @launch grid=(256,1,1) block=(256,1,1) lds=133120
.amdgcn_target "amdgcn-amd-amdhsa--gfx950"
.text
.globl adaLN_cond__mha_block_cached__mixer_s_mlp__prompt_kernel
.p2align 8
.type adaLN_cond__mha_block_cached__mixer_s_mlp__prompt_kernel,@function
adaLN_cond__mha_block_cached__mixer_s_mlp__prompt_kernel:
    s_cmp_ge_u32 s2, 256
    s_cbranch_scc1 L_at_end
    s_load_dwordx2 s[4:5], s[0:1], 0
    s_load_dwordx2 s[6:7], s[0:1], 64
    s_load_dwordx4 s[8:11], s[0:1], 80
    s_load_dwordx4 s[12:15], s[0:1], 104
    s_load_dwordx4 s[60:63], s[0:1], 8
    s_load_dwordx2 s[48:49], s[0:1], 24
    v_and_b32 v1, 7, v0
    v_lshrrev_b32 v2, 3, v0
    v_and_b32 v3, 63, v0
    v_lshrrev_b32 v4, 6, v0
    v_and_b32 v80, 15, v0
    v_lshrrev_b32 v81, 4, v0
    v_readfirstlane_b32 s55, v4
    s_lshl_b32 s40, s2, 14
    v_lshlrev_b32 v5, 10, v80
    v_lshl_add_u32 v5, v81, 4, v5
    v_add_u32 v5, s40, v5
    s_waitcnt lgkmcnt(0)
    s_mov_b32 s30, s48
    s_mov_b32 s31, s49
    s_add_u32 s16, s8, 0
    s_addc_u32 s17, s9, 0
    s_mov_b32 s18, 1024
    s_mov_b32 s19, 0x00020000
    s_add_u32 s20, s10, 0
    s_addc_u32 s21, s11, 0
    s_mov_b32 s22, 3145728
    s_mov_b32 s23, 0x00020000
    s_add_u32 s24, s4, 0
    s_addc_u32 s25, s5, 0
    s_mov_b32 s26, 2097152
    s_mov_b32 s27, 0x00020000
    s_add_u32 s32, s14, 0
    s_addc_u32 s33, s15, 0
    s_mov_b32 s34, 32768
    s_mov_b32 s35, 0x00020000
    s_add_u32 s36, s12, 0
    s_addc_u32 s37, s13, 0
    s_mov_b32 s38, 256
    s_mov_b32 s39, 0x00020000
    s_add_u32 s64, s14, 49283072
    s_addc_u32 s65, s15, 0
    s_mov_b32 s66, 237568
    s_mov_b32 s67, 0x00020000
    s_add_u32 s46, s14, 49520640
    s_addc_u32 s47, s15, 0
    s_load_dword s100, s[46:47], 0
    s_cmp_ge_u32 s2, 128
    s_cbranch_scc1 L_pre_role3
    s_cmp_ge_u32 s2, 64
    s_cbranch_scc1 L_pre_role2
    s_and_b32 s41, s2, 15
    s_lshr_b32 s42, s2, 4
    s_lshl_b32 s43, s42, 8
    v_lshlrev_b32 v6, 1, v2
    buffer_load_ushort v120, v6, s[16:19], s43 offen offset:0
    buffer_load_ushort v121, v6, s[16:19], s43 offen offset:64
    buffer_load_ushort v122, v6, s[16:19], s43 offen offset:128
    buffer_load_ushort v123, v6, s[16:19], s43 offen offset:192
    s_mov_b32 s44, 6144
    v_mul_lo_u32 v7, v2, s44
    v_lshl_add_u32 v7, v1, 4, v7
    s_mul_i32 s45, s42, 786432
    s_lshl_b32 s46, s41, 7
    s_add_u32 s45, s45, s46
    buffer_load_dwordx4 v[48:51], v7, s[20:23], s45 offen
    s_add_u32 s45, s45, 196608
    buffer_load_dwordx4 v[52:55], v7, s[20:23], s45 offen
    s_add_u32 s45, s45, 196608
    buffer_load_dwordx4 v[56:59], v7, s[20:23], s45 offen
    s_add_u32 s45, s45, 196608
    buffer_load_dwordx4 v[60:63], v7, s[20:23], s45 offen
    s_add_u32 s45, s45, 196608
    buffer_load_dwordx4 v[96:99], v5, s[24:27], 0 offen offset:0
    buffer_load_dwordx4 v[100:103], v5, s[24:27], 0 offen offset:256
    buffer_load_dwordx4 v[104:107], v5, s[24:27], 0 offen offset:512
    buffer_load_dwordx4 v[108:111], v5, s[24:27], 0 offen offset:768
    s_waitcnt vmcnt(8)
    v_lshlrev_b32 v120, 16, v120
    v_lshlrev_b32 v121, 16, v121
    v_lshlrev_b32 v122, 16, v122
    v_lshlrev_b32 v123, 16, v123
    v_mul_f32 v124, 0xbfb8aa3b, v120
    v_mul_f32 v125, 0xbfb8aa3b, v121
    v_mul_f32 v126, 0xbfb8aa3b, v122
    v_mul_f32 v127, 0xbfb8aa3b, v123
    v_exp_f32 v124, v124
    v_exp_f32 v125, v125
    v_exp_f32 v126, v126
    v_exp_f32 v127, v127
    s_nop 0
    v_add_f32 v124, 1.0, v124
    v_add_f32 v125, 1.0, v125
    v_add_f32 v126, 1.0, v126
    v_add_f32 v127, 1.0, v127
    v_rcp_f32 v124, v124
    v_rcp_f32 v125, v125
    v_rcp_f32 v126, v126
    v_rcp_f32 v127, v127
    s_nop 0
    v_mul_f32 v120, v120, v124
    v_mul_f32 v121, v121, v125
    v_mul_f32 v122, v122, v126
    v_mul_f32 v123, v123, v127
    v_cvt_pk_bf16_f32 v124, v120, v120
    v_cvt_pk_bf16_f32 v125, v121, v121
    v_cvt_pk_bf16_f32 v126, v122, v122
    v_cvt_pk_bf16_f32 v127, v123, v123
    v_lshlrev_b32 v120, 16, v124
    v_lshlrev_b32 v121, 16, v125
    v_lshlrev_b32 v122, 16, v126
    v_lshlrev_b32 v123, 16, v127
    v_mov_b32 v112, 0
    v_mov_b32 v113, 0
    v_mov_b32 v114, 0
    v_mov_b32 v115, 0
    v_mov_b32 v116, 0
    v_mov_b32 v117, 0
    v_mov_b32 v118, 0
    v_mov_b32 v119, 0
    s_waitcnt vmcnt(7)
    v_lshlrev_b32 v8, 16, v48
    v_and_b32 v5, 0xffff0000, v48
    v_fmac_f32 v112, v8, v120
    v_fmac_f32 v113, v5, v120
    v_lshlrev_b32 v8, 16, v49
    v_and_b32 v5, 0xffff0000, v49
    v_fmac_f32 v114, v8, v120
    v_fmac_f32 v115, v5, v120
    v_lshlrev_b32 v8, 16, v50
    v_and_b32 v5, 0xffff0000, v50
    v_fmac_f32 v116, v8, v120
    v_fmac_f32 v117, v5, v120
    v_lshlrev_b32 v8, 16, v51
    v_and_b32 v5, 0xffff0000, v51
    v_fmac_f32 v118, v8, v120
    v_fmac_f32 v119, v5, v120
    s_waitcnt vmcnt(6)
    v_lshlrev_b32 v8, 16, v52
    v_and_b32 v5, 0xffff0000, v52
    v_fmac_f32 v112, v8, v121
    v_fmac_f32 v113, v5, v121
    v_lshlrev_b32 v8, 16, v53
    v_and_b32 v5, 0xffff0000, v53
    v_fmac_f32 v114, v8, v121
    v_fmac_f32 v115, v5, v121
    v_lshlrev_b32 v8, 16, v54
    v_and_b32 v5, 0xffff0000, v54
    v_fmac_f32 v116, v8, v121
    v_fmac_f32 v117, v5, v121
    v_lshlrev_b32 v8, 16, v55
    v_and_b32 v5, 0xffff0000, v55
    v_fmac_f32 v118, v8, v121
    v_fmac_f32 v119, v5, v121
    s_waitcnt vmcnt(5)
    v_lshlrev_b32 v8, 16, v56
    v_and_b32 v5, 0xffff0000, v56
    v_fmac_f32 v112, v8, v122
    v_fmac_f32 v113, v5, v122
    v_lshlrev_b32 v8, 16, v57
    v_and_b32 v5, 0xffff0000, v57
    v_fmac_f32 v114, v8, v122
    v_fmac_f32 v115, v5, v122
    v_lshlrev_b32 v8, 16, v58
    v_and_b32 v5, 0xffff0000, v58
    v_fmac_f32 v116, v8, v122
    v_fmac_f32 v117, v5, v122
    v_lshlrev_b32 v8, 16, v59
    v_and_b32 v5, 0xffff0000, v59
    v_fmac_f32 v118, v8, v122
    v_fmac_f32 v119, v5, v122
    s_waitcnt vmcnt(4)
    v_lshlrev_b32 v8, 16, v60
    v_and_b32 v5, 0xffff0000, v60
    v_fmac_f32 v112, v8, v123
    v_fmac_f32 v113, v5, v123
    v_lshlrev_b32 v8, 16, v61
    v_and_b32 v5, 0xffff0000, v61
    v_fmac_f32 v114, v8, v123
    v_fmac_f32 v115, v5, v123
    v_lshlrev_b32 v8, 16, v62
    v_and_b32 v5, 0xffff0000, v62
    v_fmac_f32 v116, v8, v123
    v_fmac_f32 v117, v5, v123
    v_lshlrev_b32 v8, 16, v63
    v_and_b32 v5, 0xffff0000, v63
    v_fmac_f32 v118, v8, v123
    v_fmac_f32 v119, v5, v123
    v_lshlrev_b32 v6, 8, v2
    v_lshl_add_u32 v6, v1, 5, v6
    ds_write_b128 v6, v[112:115] offset:2048
    ds_write_b128 v6, v[116:119] offset:2064
    s_waitcnt lgkmcnt(0)
    s_add_u32 s100, s100, 1
    s_barrier
    s_cmp_lg_u32 s55, 0
    s_cbranch_scc1 L_pre_join
    v_lshlrev_b32 v6, 2, v3
    ds_read_b32 v48, v6 offset:2048
    ds_read_b32 v49, v6 offset:2304
    ds_read_b32 v50, v6 offset:2560
    ds_read_b32 v51, v6 offset:2816
    ds_read_b32 v52, v6 offset:3072
    ds_read_b32 v53, v6 offset:3328
    ds_read_b32 v54, v6 offset:3584
    ds_read_b32 v55, v6 offset:3840
    ds_read_b32 v56, v6 offset:4096
    ds_read_b32 v57, v6 offset:4352
    ds_read_b32 v58, v6 offset:4608
    ds_read_b32 v59, v6 offset:4864
    ds_read_b32 v60, v6 offset:5120
    ds_read_b32 v61, v6 offset:5376
    ds_read_b32 v62, v6 offset:5632
    ds_read_b32 v63, v6 offset:5888
    ds_read_b32 v64, v6 offset:6144
    ds_read_b32 v65, v6 offset:6400
    ds_read_b32 v66, v6 offset:6656
    ds_read_b32 v67, v6 offset:6912
    ds_read_b32 v68, v6 offset:7168
    ds_read_b32 v69, v6 offset:7424
    ds_read_b32 v70, v6 offset:7680
    ds_read_b32 v71, v6 offset:7936
    ds_read_b32 v72, v6 offset:8192
    ds_read_b32 v73, v6 offset:8448
    ds_read_b32 v74, v6 offset:8704
    ds_read_b32 v75, v6 offset:8960
    ds_read_b32 v76, v6 offset:9216
    ds_read_b32 v77, v6 offset:9472
    ds_read_b32 v78, v6 offset:9728
    ds_read_b32 v79, v6 offset:9984
    s_waitcnt lgkmcnt(0)
    v_add_f32 v48, v48, v64
    v_add_f32 v49, v49, v65
    v_add_f32 v50, v50, v66
    v_add_f32 v51, v51, v67
    v_add_f32 v52, v52, v68
    v_add_f32 v53, v53, v69
    v_add_f32 v54, v54, v70
    v_add_f32 v55, v55, v71
    v_add_f32 v56, v56, v72
    v_add_f32 v57, v57, v73
    v_add_f32 v58, v58, v74
    v_add_f32 v59, v59, v75
    v_add_f32 v60, v60, v76
    v_add_f32 v61, v61, v77
    v_add_f32 v62, v62, v78
    v_add_f32 v63, v63, v79
    v_add_f32 v48, v48, v56
    v_add_f32 v49, v49, v57
    v_add_f32 v50, v50, v58
    v_add_f32 v51, v51, v59
    v_add_f32 v52, v52, v60
    v_add_f32 v53, v53, v61
    v_add_f32 v54, v54, v62
    v_add_f32 v55, v55, v63
    v_add_f32 v48, v48, v52
    v_add_f32 v49, v49, v53
    v_add_f32 v50, v50, v54
    v_add_f32 v51, v51, v55
    v_add_f32 v48, v48, v50
    v_add_f32 v49, v49, v51
    v_add_f32 v48, v48, v49
    s_lshl_b32 s45, s42, 12
    s_lshl_b32 s46, s41, 8
    s_add_u32 s45, s45, s46
    s_add_u32 s45, s45, 16384
    s_and_b32 s46, s100, 0xff
    v_and_b32 v48, 0xffffff00, v48
    v_or_b32 v48, s46, v48
    buffer_store_dword v48, v6, s[32:35], s45 offen sc1
    s_waitcnt vmcnt(1)
    s_branch L_pre_join2
L_pre_role2:
    buffer_load_dwordx4 v[96:99], v5, s[24:27], 0 offen offset:0
    buffer_load_dwordx4 v[100:103], v5, s[24:27], 0 offen offset:256
    buffer_load_dwordx4 v[104:107], v5, s[24:27], 0 offen offset:512
    buffer_load_dwordx4 v[108:111], v5, s[24:27], 0 offen offset:768
    s_waitcnt lgkmcnt(0)
    s_add_u32 s100, s100, 1
    s_branch L_pre_join
L_pre_role3:
    s_getpc_b64 s[48:49]
L_cpf0_ref:
    s_sub_u32 s50, s2, 128
    s_lshr_b32 s50, s50, 3
    s_lshl_b32 s50, s50, 2
    s_add_u32 s50, s50, s55
    s_lshl_b32 s50, s50, 12
    v_lshlrev_b32 v10, 6, v3
    v_add_u32 v10, s50, v10
    v_min_u32 v10, L_at_loopend-L_cpf0_ref, v10
    v_mov_b32 v11, s49
    v_add_co_u32 v10, vcc, s48, v10
    s_nop 1
    v_addc_co_u32 v11, vcc, 0, v11, vcc
    global_load_dword v12, v[10:11], off
    s_waitcnt lgkmcnt(0)
    s_add_u32 s100, s100, 1
    s_sub_u32 s41, s2, 128
    s_and_b32 s42, s41, 7
    s_lshr_b32 s41, s41, 3
    s_cmp_ge_u32 s41, 8
    s_cselect_b32 s53, 1, 0
    s_and_b32 s41, s41, 7
    s_lshr_b32 s50, s41, 1
    s_lshl_b32 s50, s50, 4
    s_and_b32 s41, s41, 1
    s_add_u32 s41, s41, s50
    s_lshl_b32 s42, s42, 1
    s_add_u32 s41, s41, s42
    s_cmp_ge_u32 s41, 56
    s_cselect_b32 s50, s53, 0
    s_cmp_eq_u32 s50, 1
    s_cbranch_scc1 L_pre_r3done
    s_lshl_b32 s43, s41, 6
    s_lshl_b32 s54, s41, 7
    s_cmp_eq_u32 s53, 1
    s_cselect_b32 s56, s6, s10
    s_cselect_b32 s57, s7, s11
    s_cselect_b32 s58, 1835008, s22
    s_mov_b32 s59, 0x00020000
    s_mov_b32 s42, 6144
    s_cselect_b32 s42, 3584, s42
    s_cselect_b32 s50, 0, 2048
    s_add_u32 s43, s43, s50
    s_cmp_eq_u32 s53, 1
    s_cselect_b32 s50, 8192, 0
    s_add_u32 s54, s54, s50
    v_lshlrev_b32 v6, 2, v0
    buffer_load_dword v6, v6, s[16:19], 0 offen
    v_lshrrev_b32 v46, 2, v0
    v_and_b32 v47, 3, v0
    v_mul_lo_u32 v7, v46, s42
    v_lshl_add_u32 v7, v47, 4, v7
    s_lshl_b32 s45, s42, 6
    buffer_load_dwordx4 v[48:51], v7, s[56:59], s43 offen
    s_add_u32 s43, s43, s45
    buffer_load_dwordx4 v[52:55], v7, s[56:59], s43 offen
    s_add_u32 s43, s43, s45
    buffer_load_dwordx4 v[56:59], v7, s[56:59], s43 offen
    s_add_u32 s43, s43, s45
    buffer_load_dwordx4 v[60:63], v7, s[56:59], s43 offen
    s_add_u32 s43, s43, s45
    buffer_load_dwordx4 v[64:67], v7, s[56:59], s43 offen
    s_add_u32 s43, s43, s45
    buffer_load_dwordx4 v[68:71], v7, s[56:59], s43 offen
    s_add_u32 s43, s43, s45
    buffer_load_dwordx4 v[72:75], v7, s[56:59], s43 offen
    s_add_u32 s43, s43, s45
    buffer_load_dwordx4 v[76:79], v7, s[56:59], s43 offen
    s_add_u32 s43, s43, s45
    s_waitcnt vmcnt(8)
    v_lshlrev_b32 v36, 16, v6
    v_and_b32 v37, 0xffff0000, v6
    v_mul_f32 v38, 0xbfb8aa3b, v36
    v_mul_f32 v39, 0xbfb8aa3b, v37
    v_exp_f32 v38, v38
    v_exp_f32 v39, v39
    s_nop 0
    v_add_f32 v38, 1.0, v38
    v_add_f32 v39, 1.0, v39
    v_rcp_f32 v38, v38
    v_rcp_f32 v39, v39
    s_nop 0
    v_mul_f32 v36, v36, v38
    v_mul_f32 v37, v37, v39
    v_cvt_pk_bf16_f32 v38, v36, v37
    v_lshlrev_b32 v36, 16, v38
    v_and_b32 v37, 0xffff0000, v38
    s_cmp_eq_u32 s53, 1
    s_cbranch_scc0 L_pre_silu_keep
    v_mov_b32 v36, 1.0
    v_mov_b32 v37, 1.0
L_pre_silu_keep:
    v_lshlrev_b32 v38, 3, v0
    ds_write_b64 v38, v[36:37] offset:0
    s_waitcnt lgkmcnt(0)
    s_barrier
    v_lshlrev_b32 v6, 2, v46
    ds_read_b32 v16, v6 offset:0
    ds_read_b32 v17, v6 offset:256
    ds_read_b32 v18, v6 offset:512
    ds_read_b32 v19, v6 offset:768
    ds_read_b32 v20, v6 offset:1024
    ds_read_b32 v21, v6 offset:1280
    ds_read_b32 v22, v6 offset:1536
    ds_read_b32 v23, v6 offset:1792
    v_mov_b32 v112, 0
    v_mov_b32 v113, 0
    v_mov_b32 v114, 0
    v_mov_b32 v115, 0
    v_mov_b32 v116, 0
    v_mov_b32 v117, 0
    v_mov_b32 v118, 0
    v_mov_b32 v119, 0
    s_waitcnt lgkmcnt(0)
    s_waitcnt vmcnt(7)
    v_lshlrev_b32 v8, 16, v48
    v_and_b32 v5, 0xffff0000, v48
    v_fmac_f32 v112, v8, v16
    v_fmac_f32 v113, v5, v16
    v_lshlrev_b32 v8, 16, v49
    v_and_b32 v5, 0xffff0000, v49
    v_fmac_f32 v114, v8, v16
    v_fmac_f32 v115, v5, v16
    v_lshlrev_b32 v8, 16, v50
    v_and_b32 v5, 0xffff0000, v50
    v_fmac_f32 v116, v8, v16
    v_fmac_f32 v117, v5, v16
    v_lshlrev_b32 v8, 16, v51
    v_and_b32 v5, 0xffff0000, v51
    v_fmac_f32 v118, v8, v16
    v_fmac_f32 v119, v5, v16
    s_waitcnt vmcnt(6)
    v_lshlrev_b32 v8, 16, v52
    v_and_b32 v5, 0xffff0000, v52
    v_fmac_f32 v112, v8, v17
    v_fmac_f32 v113, v5, v17
    v_lshlrev_b32 v8, 16, v53
    v_and_b32 v5, 0xffff0000, v53
    v_fmac_f32 v114, v8, v17
    v_fmac_f32 v115, v5, v17
    v_lshlrev_b32 v8, 16, v54
    v_and_b32 v5, 0xffff0000, v54
    v_fmac_f32 v116, v8, v17
    v_fmac_f32 v117, v5, v17
    v_lshlrev_b32 v8, 16, v55
    v_and_b32 v5, 0xffff0000, v55
    v_fmac_f32 v118, v8, v17
    v_fmac_f32 v119, v5, v17
    s_waitcnt vmcnt(5)
    v_lshlrev_b32 v8, 16, v56
    v_and_b32 v5, 0xffff0000, v56
    v_fmac_f32 v112, v8, v18
    v_fmac_f32 v113, v5, v18
    v_lshlrev_b32 v8, 16, v57
    v_and_b32 v5, 0xffff0000, v57
    v_fmac_f32 v114, v8, v18
    v_fmac_f32 v115, v5, v18
    v_lshlrev_b32 v8, 16, v58
    v_and_b32 v5, 0xffff0000, v58
    v_fmac_f32 v116, v8, v18
    v_fmac_f32 v117, v5, v18
    v_lshlrev_b32 v8, 16, v59
    v_and_b32 v5, 0xffff0000, v59
    v_fmac_f32 v118, v8, v18
    v_fmac_f32 v119, v5, v18
    s_waitcnt vmcnt(4)
    v_lshlrev_b32 v8, 16, v60
    v_and_b32 v5, 0xffff0000, v60
    v_fmac_f32 v112, v8, v19
    v_fmac_f32 v113, v5, v19
    v_lshlrev_b32 v8, 16, v61
    v_and_b32 v5, 0xffff0000, v61
    v_fmac_f32 v114, v8, v19
    v_fmac_f32 v115, v5, v19
    v_lshlrev_b32 v8, 16, v62
    v_and_b32 v5, 0xffff0000, v62
    v_fmac_f32 v116, v8, v19
    v_fmac_f32 v117, v5, v19
    v_lshlrev_b32 v8, 16, v63
    v_and_b32 v5, 0xffff0000, v63
    v_fmac_f32 v118, v8, v19
    v_fmac_f32 v119, v5, v19
    s_waitcnt vmcnt(3)
    v_lshlrev_b32 v8, 16, v64
    v_and_b32 v5, 0xffff0000, v64
    v_fmac_f32 v112, v8, v20
    v_fmac_f32 v113, v5, v20
    v_lshlrev_b32 v8, 16, v65
    v_and_b32 v5, 0xffff0000, v65
    v_fmac_f32 v114, v8, v20
    v_fmac_f32 v115, v5, v20
    v_lshlrev_b32 v8, 16, v66
    v_and_b32 v5, 0xffff0000, v66
    v_fmac_f32 v116, v8, v20
    v_fmac_f32 v117, v5, v20
    v_lshlrev_b32 v8, 16, v67
    v_and_b32 v5, 0xffff0000, v67
    v_fmac_f32 v118, v8, v20
    v_fmac_f32 v119, v5, v20
    s_waitcnt vmcnt(2)
    v_lshlrev_b32 v8, 16, v68
    v_and_b32 v5, 0xffff0000, v68
    v_fmac_f32 v112, v8, v21
    v_fmac_f32 v113, v5, v21
    v_lshlrev_b32 v8, 16, v69
    v_and_b32 v5, 0xffff0000, v69
    v_fmac_f32 v114, v8, v21
    v_fmac_f32 v115, v5, v21
    v_lshlrev_b32 v8, 16, v70
    v_and_b32 v5, 0xffff0000, v70
    v_fmac_f32 v116, v8, v21
    v_fmac_f32 v117, v5, v21
    v_lshlrev_b32 v8, 16, v71
    v_and_b32 v5, 0xffff0000, v71
    v_fmac_f32 v118, v8, v21
    v_fmac_f32 v119, v5, v21
    s_waitcnt vmcnt(1)
    v_lshlrev_b32 v8, 16, v72
    v_and_b32 v5, 0xffff0000, v72
    v_fmac_f32 v112, v8, v22
    v_fmac_f32 v113, v5, v22
    v_lshlrev_b32 v8, 16, v73
    v_and_b32 v5, 0xffff0000, v73
    v_fmac_f32 v114, v8, v22
    v_fmac_f32 v115, v5, v22
    v_lshlrev_b32 v8, 16, v74
    v_and_b32 v5, 0xffff0000, v74
    v_fmac_f32 v116, v8, v22
    v_fmac_f32 v117, v5, v22
    v_lshlrev_b32 v8, 16, v75
    v_and_b32 v5, 0xffff0000, v75
    v_fmac_f32 v118, v8, v22
    v_fmac_f32 v119, v5, v22
    s_waitcnt vmcnt(0)
    v_lshlrev_b32 v8, 16, v76
    v_and_b32 v5, 0xffff0000, v76
    v_fmac_f32 v112, v8, v23
    v_fmac_f32 v113, v5, v23
    v_lshlrev_b32 v8, 16, v77
    v_and_b32 v5, 0xffff0000, v77
    v_fmac_f32 v114, v8, v23
    v_fmac_f32 v115, v5, v23
    v_lshlrev_b32 v8, 16, v78
    v_and_b32 v5, 0xffff0000, v78
    v_fmac_f32 v116, v8, v23
    v_fmac_f32 v117, v5, v23
    v_lshlrev_b32 v8, 16, v79
    v_and_b32 v5, 0xffff0000, v79
    v_fmac_f32 v118, v8, v23
    v_fmac_f32 v119, v5, v23
    v_lshlrev_b32 v6, 7, v46
    v_lshl_add_u32 v6, v47, 5, v6
    ds_write_b128 v6, v[112:115] offset:2048
    ds_write_b128 v6, v[116:119] offset:2064
    s_waitcnt lgkmcnt(0)
    s_barrier
    s_cmp_lg_u32 s55, 0
    s_cbranch_scc1 L_pre_r3done
    v_and_b32 v6, 31, v3
    v_lshlrev_b32 v6, 2, v6
    v_lshrrev_b32 v7, 5, v3
    v_lshl_add_u32 v6, v7, 12, v6
    ds_read_b32 v48, v6 offset:2048
    ds_read_b32 v49, v6 offset:2176
    ds_read_b32 v50, v6 offset:2304
    ds_read_b32 v51, v6 offset:2432
    ds_read_b32 v52, v6 offset:2560
    ds_read_b32 v53, v6 offset:2688
    ds_read_b32 v54, v6 offset:2816
    ds_read_b32 v55, v6 offset:2944
    ds_read_b32 v56, v6 offset:3072
    ds_read_b32 v57, v6 offset:3200
    ds_read_b32 v58, v6 offset:3328
    ds_read_b32 v59, v6 offset:3456
    ds_read_b32 v60, v6 offset:3584
    ds_read_b32 v61, v6 offset:3712
    ds_read_b32 v62, v6 offset:3840
    ds_read_b32 v63, v6 offset:3968
    ds_read_b32 v64, v6 offset:4096
    ds_read_b32 v65, v6 offset:4224
    ds_read_b32 v66, v6 offset:4352
    ds_read_b32 v67, v6 offset:4480
    ds_read_b32 v68, v6 offset:4608
    ds_read_b32 v69, v6 offset:4736
    ds_read_b32 v70, v6 offset:4864
    ds_read_b32 v71, v6 offset:4992
    ds_read_b32 v72, v6 offset:5120
    ds_read_b32 v73, v6 offset:5248
    ds_read_b32 v74, v6 offset:5376
    ds_read_b32 v75, v6 offset:5504
    ds_read_b32 v76, v6 offset:5632
    ds_read_b32 v77, v6 offset:5760
    ds_read_b32 v78, v6 offset:5888
    ds_read_b32 v79, v6 offset:6016
    s_waitcnt lgkmcnt(0)
    v_add_f32 v48, v48, v64
    v_add_f32 v49, v49, v65
    v_add_f32 v50, v50, v66
    v_add_f32 v51, v51, v67
    v_add_f32 v52, v52, v68
    v_add_f32 v53, v53, v69
    v_add_f32 v54, v54, v70
    v_add_f32 v55, v55, v71
    v_add_f32 v56, v56, v72
    v_add_f32 v57, v57, v73
    v_add_f32 v58, v58, v74
    v_add_f32 v59, v59, v75
    v_add_f32 v60, v60, v76
    v_add_f32 v61, v61, v77
    v_add_f32 v62, v62, v78
    v_add_f32 v63, v63, v79
    v_add_f32 v48, v48, v56
    v_add_f32 v49, v49, v57
    v_add_f32 v50, v50, v58
    v_add_f32 v51, v51, v59
    v_add_f32 v52, v52, v60
    v_add_f32 v53, v53, v61
    v_add_f32 v54, v54, v62
    v_add_f32 v55, v55, v63
    v_add_f32 v48, v48, v52
    v_add_f32 v49, v49, v53
    v_add_f32 v50, v50, v54
    v_add_f32 v51, v51, v55
    v_add_f32 v48, v48, v50
    v_add_f32 v49, v49, v51
    v_add_f32 v48, v48, v49
    v_mov_b32 v49, v48
    s_nop 1
    v_permlane32_swap_b32 v48, v49
    s_nop 1
    v_add_f32 v48, v48, v49
    s_cmp_eq_u32 s53, 1
    s_cbranch_scc1 L_pre_BC_store
    v_cvt_pk_bf16_f32 v49, v48, v48
    v_lshlrev_b32 v48, 16, v49
    s_lshr_b32 s50, s41, 4
    s_cmp_eq_u32 s50, 2
    s_cbranch_scc0 L_pre_BC_store
    v_add_f32 v48, 1.0, v48
    v_cvt_pk_bf16_f32 v49, v48, v48
    v_lshlrev_b32 v48, 16, v49
L_pre_BC_store:
    v_and_b32 v6, 31, v3
    v_lshlrev_b32 v6, 2, v6
    buffer_store_dword v48, v6, s[32:35], s54 offen sc1
L_pre_r3done:
    s_and_b32 s42, s2, 7
    s_sub_u32 s43, s2, 128
    s_lshr_b32 s43, s43, 3
    s_lshl_b32 s43, s43, 2
    s_add_u32 s43, s43, s55
    s_lshr_b32 s50, s43, 4
    s_lshl_b32 s50, s50, 3
    s_add_u32 s50, s50, s42
    s_and_b32 s43, s43, 15
    s_lshl_b32 s51, s50, 8
    s_add_u32 s72, s30, s51
    s_addc_u32 s73, s31, 0
    s_sub_u32 s74, 4194304, s51
    s_mov_b32 s75, 0x00020000
    v_lshrrev_b32 v8, 1, v3
    v_and_b32 v9, 1, v3
    v_lshlrev_b32 v8, 13, v8
    v_lshl_add_u32 v8, v9, 7, v8
    s_lshl_b32 s51, s43, 18
    buffer_load_dword v126, v8, s[72:75], s51 offen
    s_lshl_b32 s51, s50, 19
    v_lshlrev_b32 v9, 5, v3
    s_lshl_b32 s52, s43, 11
    s_add_u32 s76, s60, s51
    s_addc_u32 s77, s61, 0
    s_mov_b32 s78, 524288
    s_mov_b32 s79, 0x00020000
    buffer_load_dword v127, v9, s[76:79], s52 offen
    v_lshlrev_b32 v9, 4, v3
    s_lshl_b32 s52, s43, 10
    s_add_u32 s76, s62, s51
    s_addc_u32 s77, s63, 0
    s_mov_b32 s78, 524288
    s_mov_b32 s79, 0x00020000
    buffer_load_dword v123, v9, s[76:79], s52 offen
    s_barrier
    s_branch L_pre_fin
L_pre_join:
    s_waitcnt vmcnt(0)
L_pre_join2:
    v_lshlrev_b32 v16, 16, v96
    v_and_b32 v17, 0xffff0000, v96
    v_lshlrev_b32 v18, 16, v97
    v_and_b32 v19, 0xffff0000, v97
    v_lshlrev_b32 v20, 16, v98
    v_and_b32 v21, 0xffff0000, v98
    v_lshlrev_b32 v22, 16, v99
    v_and_b32 v23, 0xffff0000, v99
    v_lshlrev_b32 v24, 16, v100
    v_and_b32 v25, 0xffff0000, v100
    v_lshlrev_b32 v26, 16, v101
    v_and_b32 v27, 0xffff0000, v101
    v_lshlrev_b32 v28, 16, v102
    v_and_b32 v29, 0xffff0000, v102
    v_lshlrev_b32 v30, 16, v103
    v_and_b32 v31, 0xffff0000, v103
    v_lshlrev_b32 v32, 16, v104
    v_and_b32 v33, 0xffff0000, v104
    v_lshlrev_b32 v34, 16, v105
    v_and_b32 v35, 0xffff0000, v105
    v_lshlrev_b32 v36, 16, v106
    v_and_b32 v37, 0xffff0000, v106
    v_lshlrev_b32 v38, 16, v107
    v_and_b32 v39, 0xffff0000, v107
    v_lshlrev_b32 v40, 16, v108
    v_and_b32 v41, 0xffff0000, v108
    v_lshlrev_b32 v42, 16, v109
    v_and_b32 v43, 0xffff0000, v109
    v_lshlrev_b32 v44, 16, v110
    v_and_b32 v45, 0xffff0000, v110
    v_lshlrev_b32 v46, 16, v111
    v_and_b32 v47, 0xffff0000, v111
    v_mov_b32 v124, 0
    v_mov_b32 v125, 0
    v_add_f32 v124, v124, v16
    v_fmac_f32 v125, v16, v16
    v_add_f32 v124, v124, v17
    v_fmac_f32 v125, v17, v17
    v_add_f32 v124, v124, v18
    v_fmac_f32 v125, v18, v18
    v_add_f32 v124, v124, v19
    v_fmac_f32 v125, v19, v19
    v_add_f32 v124, v124, v20
    v_fmac_f32 v125, v20, v20
    v_add_f32 v124, v124, v21
    v_fmac_f32 v125, v21, v21
    v_add_f32 v124, v124, v22
    v_fmac_f32 v125, v22, v22
    v_add_f32 v124, v124, v23
    v_fmac_f32 v125, v23, v23
    v_add_f32 v124, v124, v24
    v_fmac_f32 v125, v24, v24
    v_add_f32 v124, v124, v25
    v_fmac_f32 v125, v25, v25
    v_add_f32 v124, v124, v26
    v_fmac_f32 v125, v26, v26
    v_add_f32 v124, v124, v27
    v_fmac_f32 v125, v27, v27
    v_add_f32 v124, v124, v28
    v_fmac_f32 v125, v28, v28
    v_add_f32 v124, v124, v29
    v_fmac_f32 v125, v29, v29
    v_add_f32 v124, v124, v30
    v_fmac_f32 v125, v30, v30
    v_add_f32 v124, v124, v31
    v_fmac_f32 v125, v31, v31
    v_add_f32 v124, v124, v32
    v_fmac_f32 v125, v32, v32
    v_add_f32 v124, v124, v33
    v_fmac_f32 v125, v33, v33
    v_add_f32 v124, v124, v34
    v_fmac_f32 v125, v34, v34
    v_add_f32 v124, v124, v35
    v_fmac_f32 v125, v35, v35
    v_add_f32 v124, v124, v36
    v_fmac_f32 v125, v36, v36
    v_add_f32 v124, v124, v37
    v_fmac_f32 v125, v37, v37
    v_add_f32 v124, v124, v38
    v_fmac_f32 v125, v38, v38
    v_add_f32 v124, v124, v39
    v_fmac_f32 v125, v39, v39
    v_add_f32 v124, v124, v40
    v_fmac_f32 v125, v40, v40
    v_add_f32 v124, v124, v41
    v_fmac_f32 v125, v41, v41
    v_add_f32 v124, v124, v42
    v_fmac_f32 v125, v42, v42
    v_add_f32 v124, v124, v43
    v_fmac_f32 v125, v43, v43
    v_add_f32 v124, v124, v44
    v_fmac_f32 v125, v44, v44
    v_add_f32 v124, v124, v45
    v_fmac_f32 v125, v45, v45
    v_add_f32 v124, v124, v46
    v_fmac_f32 v125, v46, v46
    v_add_f32 v124, v124, v47
    v_fmac_f32 v125, v47, v47
    v_mov_b32 v8, v124
    v_mov_b32 v9, v125
    s_nop 1
    v_permlane16_swap_b32 v124, v8
    v_permlane16_swap_b32 v125, v9
    s_nop 1
    v_add_f32 v124, v124, v8
    v_add_f32 v125, v125, v9
    v_mov_b32 v8, v124
    v_mov_b32 v9, v125
    s_nop 1
    v_permlane32_swap_b32 v124, v8
    v_permlane32_swap_b32 v125, v9
    s_nop 1
    v_add_f32 v124, v124, v8
    v_add_f32 v125, v125, v9
    v_lshrrev_b32 v8, 6, v0
    v_lshlrev_b32 v8, 3, v8
    v_lshl_add_u32 v8, v80, 5, v8
    ds_write_b64 v8, v[124:125] offset:14336
    s_waitcnt lgkmcnt(0)
    s_barrier
    v_lshlrev_b32 v8, 5, v80
    ds_read_b128 v[12:15], v8 offset:14352
    ds_read_b128 v[8:11], v8 offset:14336
    s_waitcnt lgkmcnt(0)
    v_add_f32 v8, v8, v10
    v_add_f32 v9, v9, v11
    v_add_f32 v12, v12, v14
    v_add_f32 v13, v13, v15
    v_add_f32 v124, v8, v12
    v_add_f32 v125, v9, v13
    v_mul_f32 v124, 0.001953125, v124
    v_mul_f32 v125, 0.001953125, v125
    v_fma_f32 v125, -v124, v124, v125
    v_max_f32 v125, 0, v125
    v_add_f32 v125, 0x3727c5ac, v125
    v_rsq_f32 v125, v125
    s_nop 0
    v_mul_f32 v124, v124, v125
    v_lshlrev_b32 v6, 4, v0
    s_mov_b32 s52, 524288
    s_and_b32 s53, s100, 0xff
L_pre_dpoll:
    s_mov_b32 s50, 16384
    buffer_load_dwordx4 v[48:51], v6, s[32:35], s50 offen sc1
    s_mov_b32 s50, 20480
    buffer_load_dwordx4 v[52:55], v6, s[32:35], s50 offen sc1
    s_mov_b32 s50, 24576
    buffer_load_dwordx4 v[56:59], v6, s[32:35], s50 offen sc1
    s_mov_b32 s50, 28672
    buffer_load_dwordx4 v[60:63], v6, s[32:35], s50 offen sc1
    s_waitcnt vmcnt(0)
    v_xor_b32 v64, s53, v48
    v_xor_b32 v65, s53, v49
    v_xor_b32 v66, s53, v50
    v_xor_b32 v67, s53, v51
    v_xor_b32 v68, s53, v52
    v_xor_b32 v69, s53, v53
    v_xor_b32 v70, s53, v54
    v_xor_b32 v71, s53, v55
    v_xor_b32 v72, s53, v56
    v_xor_b32 v73, s53, v57
    v_xor_b32 v74, s53, v58
    v_xor_b32 v75, s53, v59
    v_xor_b32 v76, s53, v60
    v_xor_b32 v77, s53, v61
    v_xor_b32 v78, s53, v62
    v_xor_b32 v79, s53, v63
    v_or3_b32 v64, v64, v64, v65
    v_or3_b32 v64, v64, v66, v67
    v_or3_b32 v64, v64, v68, v69
    v_or3_b32 v64, v64, v70, v71
    v_or3_b32 v64, v64, v72, v73
    v_or3_b32 v64, v64, v74, v75
    v_or3_b32 v64, v64, v76, v77
    v_or3_b32 v64, v64, v78, v79
    v_and_b32 v64, 0xff, v64
    v_cmp_ne_u32 vcc, 0, v64
    s_cbranch_vccz L_pre_dgo
    s_sleep 2
    s_sub_u32 s52, s52, 1
    s_cmp_lg_u32 s52, 0
    s_cbranch_scc1 L_pre_dpoll
L_pre_dgo:
    v_and_b32 v48, 0xffffff00, v48
    v_and_b32 v49, 0xffffff00, v49
    v_and_b32 v50, 0xffffff00, v50
    v_and_b32 v51, 0xffffff00, v51
    v_and_b32 v52, 0xffffff00, v52
    v_and_b32 v53, 0xffffff00, v53
    v_and_b32 v54, 0xffffff00, v54
    v_and_b32 v55, 0xffffff00, v55
    v_and_b32 v56, 0xffffff00, v56
    v_and_b32 v57, 0xffffff00, v57
    v_and_b32 v58, 0xffffff00, v58
    v_and_b32 v59, 0xffffff00, v59
    v_and_b32 v60, 0xffffff00, v60
    v_and_b32 v61, 0xffffff00, v61
    v_and_b32 v62, 0xffffff00, v62
    v_and_b32 v63, 0xffffff00, v63
    s_add_u32 s28, s14, 1048576
    s_addc_u32 s29, s15, 0
    s_mov_b32 s30, 2097152
    s_mov_b32 s31, 0x00020000
    s_waitcnt vmcnt(0)
    v_add_f32 v48, v48, v52
    v_add_f32 v56, v56, v60
    v_add_f32 v49, v49, v53
    v_add_f32 v57, v57, v61
    v_add_f32 v50, v50, v54
    v_add_f32 v58, v58, v62
    v_add_f32 v51, v51, v55
    v_add_f32 v59, v59, v63
    v_add_f32 v48, v48, v56
    v_add_f32 v49, v49, v57
    v_add_f32 v50, v50, v58
    v_add_f32 v51, v51, v59
    v_cvt_pk_bf16_f32 v52, v48, v48
    v_lshlrev_b32 v48, 16, v52
    v_cvt_pk_bf16_f32 v53, v49, v49
    v_lshlrev_b32 v49, 16, v53
    v_cvt_pk_bf16_f32 v54, v50, v50
    v_lshlrev_b32 v50, 16, v54
    v_cvt_pk_bf16_f32 v55, v51, v51
    v_lshlrev_b32 v51, 16, v55
    v_add_f32 v56, 1.0, v48
    v_cvt_pk_bf16_f32 v52, v56, v56
    v_lshlrev_b32 v56, 16, v52
    v_add_f32 v57, 1.0, v49
    v_cvt_pk_bf16_f32 v53, v57, v57
    v_lshlrev_b32 v57, 16, v53
    v_add_f32 v58, 1.0, v50
    v_cvt_pk_bf16_f32 v54, v58, v58
    v_lshlrev_b32 v58, 16, v54
    v_add_f32 v59, 1.0, v51
    v_cvt_pk_bf16_f32 v55, v59, v59
    v_lshlrev_b32 v59, 16, v55
    v_cmp_le_u32 vcc, 128, v0
    s_nop 1
    v_cndmask_b32 v48, v48, v56, vcc
    v_cndmask_b32 v49, v49, v57, vcc
    v_cndmask_b32 v50, v50, v58, vcc
    v_cndmask_b32 v51, v51, v59, vcc
    ds_write_b128 v6, v[48:51] offset:10240
    s_waitcnt lgkmcnt(0)
    s_barrier
    v_lshlrev_b32 v6, 5, v81
    s_lshr_b32 s50, s2, 1
    s_lshl_b32 s50, s50, 15
    s_and_b32 s51, s2, 1
    s_lshl_b32 s51, s51, 8
    s_add_u32 s50, s50, s51
    v_lshlrev_b32 v7, 9, v81
    v_lshl_add_u32 v7, v80, 4, v7
    v_add_u32 v7, s50, v7
    s_mov_b32 s51, 0x3e0293ee
    ds_read_b128 v[48:51], v6 offset:10240
    ds_read_b128 v[56:59], v6 offset:12288
    ds_read_b128 v[52:55], v6 offset:10256
    ds_read_b128 v[60:63], v6 offset:12304
    v_fma_f32 v16, v16, v125, -v124
    v_fma_f32 v17, v17, v125, -v124
    v_fma_f32 v18, v18, v125, -v124
    v_fma_f32 v19, v19, v125, -v124
    v_fma_f32 v20, v20, v125, -v124
    v_fma_f32 v21, v21, v125, -v124
    v_fma_f32 v22, v22, v125, -v124
    v_fma_f32 v23, v23, v125, -v124
    s_waitcnt lgkmcnt(0)
    v_fma_f32 v16, v16, v56, v48
    v_fma_f32 v17, v17, v57, v49
    v_fma_f32 v18, v18, v58, v50
    v_fma_f32 v19, v19, v59, v51
    v_fma_f32 v20, v20, v60, v52
    v_fma_f32 v21, v21, v61, v53
    v_fma_f32 v22, v22, v62, v54
    v_fma_f32 v23, v23, v63, v55
    v_mul_f32 v16, s51, v16
    v_mul_f32 v17, s51, v17
    v_mul_f32 v18, s51, v18
    v_mul_f32 v19, s51, v19
    v_mul_f32 v20, s51, v20
    v_mul_f32 v21, s51, v21
    v_mul_f32 v22, s51, v22
    v_mul_f32 v23, s51, v23
    v_cvt_pk_bf16_f32 v96, v16, v17
    v_cvt_pk_bf16_f32 v97, v18, v19
    v_cvt_pk_bf16_f32 v98, v20, v21
    v_cvt_pk_bf16_f32 v99, v22, v23
    s_mov_b32 s50, 0
    buffer_store_dwordx4 v[96:99], v7, s[28:31], s50 offen sc1
    ds_read_b128 v[64:67], v6 offset:10752
    ds_read_b128 v[72:75], v6 offset:12800
    ds_read_b128 v[68:71], v6 offset:10768
    ds_read_b128 v[76:79], v6 offset:12816
    v_fma_f32 v24, v24, v125, -v124
    v_fma_f32 v25, v25, v125, -v124
    v_fma_f32 v26, v26, v125, -v124
    v_fma_f32 v27, v27, v125, -v124
    v_fma_f32 v28, v28, v125, -v124
    v_fma_f32 v29, v29, v125, -v124
    v_fma_f32 v30, v30, v125, -v124
    v_fma_f32 v31, v31, v125, -v124
    s_waitcnt lgkmcnt(0)
    v_fma_f32 v24, v24, v72, v64
    v_fma_f32 v25, v25, v73, v65
    v_fma_f32 v26, v26, v74, v66
    v_fma_f32 v27, v27, v75, v67
    v_fma_f32 v28, v28, v76, v68
    v_fma_f32 v29, v29, v77, v69
    v_fma_f32 v30, v30, v78, v70
    v_fma_f32 v31, v31, v79, v71
    v_mul_f32 v24, s51, v24
    v_mul_f32 v25, s51, v25
    v_mul_f32 v26, s51, v26
    v_mul_f32 v27, s51, v27
    v_mul_f32 v28, s51, v28
    v_mul_f32 v29, s51, v29
    v_mul_f32 v30, s51, v30
    v_mul_f32 v31, s51, v31
    v_cvt_pk_bf16_f32 v100, v24, v25
    v_cvt_pk_bf16_f32 v101, v26, v27
    v_cvt_pk_bf16_f32 v102, v28, v29
    v_cvt_pk_bf16_f32 v103, v30, v31
    s_mov_b32 s50, 8192
    buffer_store_dwordx4 v[100:103], v7, s[28:31], s50 offen sc1
    ds_read_b128 v[48:51], v6 offset:11264
    ds_read_b128 v[56:59], v6 offset:13312
    ds_read_b128 v[52:55], v6 offset:11280
    ds_read_b128 v[60:63], v6 offset:13328
    v_fma_f32 v32, v32, v125, -v124
    v_fma_f32 v33, v33, v125, -v124
    v_fma_f32 v34, v34, v125, -v124
    v_fma_f32 v35, v35, v125, -v124
    v_fma_f32 v36, v36, v125, -v124
    v_fma_f32 v37, v37, v125, -v124
    v_fma_f32 v38, v38, v125, -v124
    v_fma_f32 v39, v39, v125, -v124
    s_waitcnt lgkmcnt(0)
    v_fma_f32 v32, v32, v56, v48
    v_fma_f32 v33, v33, v57, v49
    v_fma_f32 v34, v34, v58, v50
    v_fma_f32 v35, v35, v59, v51
    v_fma_f32 v36, v36, v60, v52
    v_fma_f32 v37, v37, v61, v53
    v_fma_f32 v38, v38, v62, v54
    v_fma_f32 v39, v39, v63, v55
    v_mul_f32 v32, s51, v32
    v_mul_f32 v33, s51, v33
    v_mul_f32 v34, s51, v34
    v_mul_f32 v35, s51, v35
    v_mul_f32 v36, s51, v36
    v_mul_f32 v37, s51, v37
    v_mul_f32 v38, s51, v38
    v_mul_f32 v39, s51, v39
    v_cvt_pk_bf16_f32 v104, v32, v33
    v_cvt_pk_bf16_f32 v105, v34, v35
    v_cvt_pk_bf16_f32 v106, v36, v37
    v_cvt_pk_bf16_f32 v107, v38, v39
    s_mov_b32 s50, 16384
    buffer_store_dwordx4 v[104:107], v7, s[28:31], s50 offen sc1
    ds_read_b128 v[64:67], v6 offset:11776
    ds_read_b128 v[72:75], v6 offset:13824
    ds_read_b128 v[68:71], v6 offset:11792
    ds_read_b128 v[76:79], v6 offset:13840
    v_fma_f32 v40, v40, v125, -v124
    v_fma_f32 v41, v41, v125, -v124
    v_fma_f32 v42, v42, v125, -v124
    v_fma_f32 v43, v43, v125, -v124
    v_fma_f32 v44, v44, v125, -v124
    v_fma_f32 v45, v45, v125, -v124
    v_fma_f32 v46, v46, v125, -v124
    v_fma_f32 v47, v47, v125, -v124
    s_waitcnt lgkmcnt(0)
    v_fma_f32 v40, v40, v72, v64
    v_fma_f32 v41, v41, v73, v65
    v_fma_f32 v42, v42, v74, v66
    v_fma_f32 v43, v43, v75, v67
    v_fma_f32 v44, v44, v76, v68
    v_fma_f32 v45, v45, v77, v69
    v_fma_f32 v46, v46, v78, v70
    v_fma_f32 v47, v47, v79, v71
    v_mul_f32 v40, s51, v40
    v_mul_f32 v41, s51, v41
    v_mul_f32 v42, s51, v42
    v_mul_f32 v43, s51, v43
    v_mul_f32 v44, s51, v44
    v_mul_f32 v45, s51, v45
    v_mul_f32 v46, s51, v46
    v_mul_f32 v47, s51, v47
    v_cvt_pk_bf16_f32 v108, v40, v41
    v_cvt_pk_bf16_f32 v109, v42, v43
    v_cvt_pk_bf16_f32 v110, v44, v45
    v_cvt_pk_bf16_f32 v111, v46, v47
    s_mov_b32 s50, 24576
    buffer_store_dwordx4 v[108:111], v7, s[28:31], s50 offen sc1
    s_waitcnt vmcnt(0)
    s_barrier
    s_add_u32 s50, s2, 64
    s_lshl_b32 s50, s50, 7
    s_cmp_lg_u32 s55, 0
    s_cbranch_scc1 L_po1
    v_mov_b32 v6, 0
    v_mov_b32 v7, s100
    s_mov_b64 exec, 1
    buffer_store_dword v7, v6, s[64:67], s50 offen sc1
    s_mov_b64 exec, -1
L_po1:
L_pre_fin:
    s_load_dwordx4 s[36:39], s[0:1], 8
    s_load_dwordx2 s[40:41], s[0:1], 24
    s_load_dwordx2 s[42:43], s[0:1], 112
    s_load_dwordx2 s[52:53], s[0:1], 32
    s_load_dwordx4 s[56:59], s[0:1], 48
    s_load_dwordx4 s[60:63], s[0:1], 64
    v_and_b32 v1, 63, v0
    v_lshrrev_b32 v2, 6, v0
    s_nop 0
    v_readfirstlane_b32 s44, v2
    s_and_b32 s45, s2, 7
    s_lshr_b32 s46, s2, 6
    s_lshl_b32 s46, s46, 3
    s_add_u32 s45, s45, s46
    s_lshr_b32 s46, s2, 3
    s_and_b32 s46, s46, 7
    s_lshr_b32 s92, s45, 3
    s_lshl_b32 s93, s46, 2
    s_add_u32 s92, s92, s93
    s_and_b32 s93, s45, 7
    s_lshl_b32 s28, s44, 12
    s_lshl_b32 s34, s44, 13
    s_mov_b32 s33, 0
    s_waitcnt lgkmcnt(0)
    s_lshl_b32 s47, s45, 8
    s_add_u32 s16, s40, 0
    s_addc_u32 s17, s41, 0
    s_add_u32 s16, s16, s47
    s_addc_u32 s17, s17, 0
    s_mov_b32 s18, 0
    s_mov_b32 s19, 0x00020000
    s_sub_u32 s18, 4194304, s47
    s_lshl_b32 s48, s46, 3
    s_lshl_b32 s49, s44, 1
    s_add_u32 s48, s48, s49
    s_lshl_b32 s47, s48, 15
    s_add_u32 s20, s42, 1048576
    s_addc_u32 s21, s43, 0
    s_add_u32 s20, s20, s47
    s_addc_u32 s21, s21, 0
    s_mov_b32 s22, 65536
    s_mov_b32 s23, 0x00020000
    s_mov_b32 s94, s48
    v_lshrrev_b32 v2, 4, v1
    v_and_b32 v3, 15, v1
    v_lshlrev_b32 v4, 2, v2
    v_xor_b32 v4, v4, v3
    v_lshlrev_b32 v5, 4, v4
    v_lshl_add_u32 v241, v2, 13, v5
    s_lshl_b32 s47, s44, 18
    v_add_u32 v241, s47, v241
    v_lshlrev_b32 v240, 4, v1
    s_add_u32 m0, s34, 0
    s_mov_b32 s31, 0
    buffer_load_dwordx4 v241, s[16:19], s31 offen offset:0 lds
    s_mov_b32 s31, 31744
    buffer_load_dwordx4 v241, s[16:19], s31 offen offset:1024 lds
    s_mov_b32 s31, 63488
    buffer_load_dwordx4 v241, s[16:19], s31 offen offset:2048 lds
    s_mov_b32 s31, 95232
    buffer_load_dwordx4 v241, s[16:19], s31 offen offset:3072 lds
    s_add_u32 m0, s34, 4096
    s_mov_b32 s31, 131072
    buffer_load_dwordx4 v241, s[16:19], s31 offen offset:0 lds
    s_mov_b32 s31, 162816
    buffer_load_dwordx4 v241, s[16:19], s31 offen offset:1024 lds
    s_mov_b32 s31, 194560
    buffer_load_dwordx4 v241, s[16:19], s31 offen offset:2048 lds
    s_mov_b32 s31, 226304
    buffer_load_dwordx4 v241, s[16:19], s31 offen offset:3072 lds
    s_lshl_b32 s47, s45, 19
    s_add_u32 s8, s36, 0
    s_addc_u32 s9, s37, 0
    s_add_u32 s8, s8, s47
    s_addc_u32 s9, s9, 0
    s_mov_b32 s10, 524288
    s_mov_b32 s11, 0x00020000
    s_add_u32 s12, s38, 0
    s_addc_u32 s13, s39, 0
    s_add_u32 s12, s12, s47
    s_addc_u32 s13, s13, 0
    s_mov_b32 s14, 524288
    s_mov_b32 s15, 0x00020000
    s_lshl_b32 s47, s94, 18
    s_lshl_b32 s49, s45, 13
    s_add_u32 s47, s47, s49
    s_add_u32 s24, s42, 4194304
    s_addc_u32 s25, s43, 0
    s_add_u32 s24, s24, s47
    s_addc_u32 s25, s25, 0
    s_mov_b32 s26, 270336
    s_mov_b32 s27, 0x00020000
    v_lshrrev_b32 v2, 4, v1
    v_and_b32 v3, 15, v1
    v_lshlrev_b32 v4, 2, v2
    v_xor_b32 v4, v4, v3
    v_lshlrev_b32 v5, 4, v4
    v_lshl_add_u32 v26, v2, 8, v5
    v_add_u32 v26, s28, v26
    v_add_u32 v6, 0, v2
    v_xor_b32 v6, v6, v3
    v_lshlrev_b32 v6, 4, v6
    v_lshl_add_u32 v22, v2, 8, v6
    v_add_u32 v22, s28, v22
    v_add_u32 v6, 4, v2
    v_xor_b32 v6, v6, v3
    v_lshlrev_b32 v6, 4, v6
    v_lshl_add_u32 v23, v2, 8, v6
    v_add_u32 v23, s28, v23
    v_add_u32 v6, 8, v2
    v_xor_b32 v6, v6, v3
    v_lshlrev_b32 v6, 4, v6
    v_lshl_add_u32 v24, v2, 8, v6
    v_add_u32 v24, s28, v24
    v_add_u32 v6, 12, v2
    v_xor_b32 v6, v6, v3
    v_lshlrev_b32 v6, 4, v6
    v_lshl_add_u32 v25, v2, 8, v6
    v_add_u32 v25, s28, v25
    v_and_b32 v4, 31, v1
    v_lshrrev_b32 v5, 5, v1
    v_and_b32 v6, 15, v4
    v_xor_b32 v6, v6, v5
    v_xor_b32 v7, 0, v6
    v_lshlrev_b32 v7, 4, v7
    v_lshl_add_u32 v10, v4, 8, v7
    v_xor_b32 v7, 2, v6
    v_lshlrev_b32 v7, 4, v7
    v_lshl_add_u32 v11, v4, 8, v7
    v_xor_b32 v7, 4, v6
    v_lshlrev_b32 v7, 4, v7
    v_lshl_add_u32 v12, v4, 8, v7
    v_xor_b32 v7, 6, v6
    v_lshlrev_b32 v7, 4, v7
    v_lshl_add_u32 v13, v4, 8, v7
    v_xor_b32 v7, 8, v6
    v_lshlrev_b32 v7, 4, v7
    v_lshl_add_u32 v14, v4, 8, v7
    v_xor_b32 v7, 10, v6
    v_lshlrev_b32 v7, 4, v7
    v_lshl_add_u32 v15, v4, 8, v7
    v_xor_b32 v7, 12, v6
    v_lshlrev_b32 v7, 4, v7
    v_lshl_add_u32 v16, v4, 8, v7
    v_xor_b32 v7, 14, v6
    v_lshlrev_b32 v7, 4, v7
    v_lshl_add_u32 v17, v4, 8, v7
    v_lshrrev_b32 v6, 2, v3
    v_and_b32 v7, 3, v1
    v_and_b32 v8, 1, v2
    v_and_b32 v9, 1, v7
    v_lshl_add_u32 v9, v8, 1, v9
    v_lshlrev_b32 v9, 4, v9
    v_lshrrev_b32 v7, 1, v7
    v_lshl_add_u32 v9, v7, 3, v9
    v_lshl_add_u32 v9, v6, 8, v9
    v_xor_b32 v7, 0, v6
    v_lshl_add_u32 v7, v7, 6, v9
    v_lshl_add_u32 v18, v5, 10, v7
    v_add_u32 v18, 65536, v18
    v_lshl_add_u32 v232, v5, 11, v7
    v_add_u32 v236, 65536, v232
    v_xor_b32 v7, 1, v6
    v_lshl_add_u32 v7, v7, 6, v9
    v_lshl_add_u32 v19, v5, 10, v7
    v_add_u32 v19, 65536, v19
    v_lshl_add_u32 v233, v5, 11, v7
    v_add_u32 v237, 65536, v233
    v_xor_b32 v7, 2, v6
    v_lshl_add_u32 v7, v7, 6, v9
    v_lshl_add_u32 v20, v5, 10, v7
    v_add_u32 v20, 65536, v20
    v_lshl_add_u32 v234, v5, 11, v7
    v_add_u32 v238, 65536, v234
    v_xor_b32 v7, 3, v6
    v_lshl_add_u32 v7, v7, 6, v9
    v_lshl_add_u32 v21, v5, 10, v7
    v_add_u32 v21, 65536, v21
    v_lshl_add_u32 v235, v5, 11, v7
    v_add_u32 v239, 65536, v235
    v_mov_b32 v28, 0
    v_mov_b32 v29, 0
    v_mov_b32 v30, 0
    v_mov_b32 v31, 0
    v_mov_b32 v2, 0
    v_mov_b32 v3, 131072
    ds_write_b32 v3, v2
    s_and_b32 s47, s2, 3
    s_lshl_b32 s47, s47, 20
    s_lshr_b32 s48, s2, 3
    s_lshl_b32 s48, s48, 2
    s_add_u32 s48, s48, s44
    s_lshl_b32 s48, s48, 13
    s_add_u32 s47, s47, s48
    s_add_u32 s84, s52, s47
    s_addc_u32 s85, s53, 0
    s_mov_b32 s86, 8192
    s_mov_b32 s87, 0x00020000
    s_lshl_b32 s47, s2, 2
    s_add_u32 s47, s47, s44
    s_mov_b32 s48, s56
    s_mov_b32 s49, s57
    s_mov_b32 s50, 0
    s_cmp_ge_u32 s47, 64
    s_cselect_b32 s48, s58, s48
    s_cselect_b32 s49, s59, s49
    s_cselect_b32 s50, 64, s50
    s_cmp_ge_u32 s47, 128
    s_cselect_b32 s48, s60, s48
    s_cselect_b32 s49, s61, s49
    s_cselect_b32 s50, 128, s50
    s_cmp_ge_u32 s47, 352
    s_cselect_b32 s48, s62, s48
    s_cselect_b32 s49, s63, s49
    s_cselect_b32 s50, 352, s50
    s_sub_u32 s50, s47, s50
    s_lshl_b32 s50, s50, 13
    s_add_u32 s88, s48, s50
    s_addc_u32 s89, s49, 0
    s_cmp_lt_u32 s47, 576
    s_cselect_b32 s90, 8192, 0
    s_mov_b32 s91, 0x00020000
    v_lshlrev_b32 v242, 7, v1
    v_and_b32 v249, 15, v1
    v_lshlrev_b32 v249, 7, v249
    s_getpc_b64 s[48:49]
L_cpf_ref:
    s_add_u32 s48, s48, L_at_loopend-L_cpf_ref
    s_addc_u32 s49, s49, 0
    s_lshr_b32 s50, s2, 3
    s_lshl_b32 s50, s50, 2
    s_add_u32 s50, s50, s44
    s_lshl_b32 s50, s50, 12
    v_lshlrev_b32 v246, 6, v1
    v_add_u32 v246, s50, v246
    v_min_u32 v246, L_at_end-L_at_loopend, v246
    v_mov_b32 v247, s49
    v_add_co_u32 v246, vcc, s48, v246
    s_nop 1
    v_addc_co_u32 v247, vcc, 0, v247, vcc
    s_lshl_b32 s49, s46, 4
    s_add_u32 s49, s49, 64
    s_lshl_b32 s49, s49, 7
    s_cmp_lg_u32 s44, 1
    s_cbranch_scc1 L_pd2
    s_mov_b32 s50, 524288
    v_min_u32 v2, 15, v1
    v_lshlrev_b32 v2, 7, v2
L_fp3:
    buffer_load_dword v3, v2, s[64:67], s49 offen sc1
    s_waitcnt vmcnt(0)
    v_cmp_ne_u32 vcc, s100, v3
    s_cbranch_vccz L_pd2
    s_sleep 1
    s_sub_u32 s50, s50, 1
    s_cmp_lg_u32 s50, 0
    s_cbranch_scc1 L_fp3
L_pd2:
    s_barrier
    s_mov_b32 s51, 0
    buffer_load_dwordx4 a[0:3], v240, s[20:23], s51 offen offset:0 sc1
    s_mov_b32 s51, 32768
    buffer_load_dwordx4 a[4:7], v240, s[20:23], s51 offen offset:0 sc1
    s_mov_b32 s51, 0
    buffer_load_dwordx4 a[8:11], v240, s[20:23], s51 offen offset:1024 sc1
    s_mov_b32 s51, 32768
    buffer_load_dwordx4 a[12:15], v240, s[20:23], s51 offen offset:1024 sc1
    s_mov_b32 s51, 0
    buffer_load_dwordx4 a[16:19], v240, s[20:23], s51 offen offset:2048 sc1
    s_mov_b32 s51, 32768
    buffer_load_dwordx4 a[20:23], v240, s[20:23], s51 offen offset:2048 sc1
    s_mov_b32 s51, 0
    buffer_load_dwordx4 a[24:27], v240, s[20:23], s51 offen offset:3072 sc1
    s_mov_b32 s51, 32768
    buffer_load_dwordx4 a[28:31], v240, s[20:23], s51 offen offset:3072 sc1
    s_waitcnt vmcnt(8)
    s_cmp_lt_u32 s2, 128
    s_cbranch_scc1 L_at_noside
    s_sub_u32 s50, s2, 128
    s_add_u32 s50, s50, 192
    s_lshl_b32 s50, s50, 7
    s_cmp_lg_u32 s44, 0
    s_cbranch_scc1 L_po4
    v_mov_b32 v2, 0
    v_mov_b32 v3, s100
    s_mov_b64 exec, 1
    buffer_store_dword v3, v2, s[64:67], s50 offen sc1
    s_mov_b64 exec, -1
L_po4:
L_at_noside:
    s_waitcnt lgkmcnt(0)
    s_barrier
    ds_read_b64_tr_b16 a[128:129], v232 offset:0
    ds_read_b64_tr_b16 a[130:131], v232 offset:1024
    ds_read_b64_tr_b16 a[132:133], v233 offset:0
    ds_read_b64_tr_b16 a[134:135], v233 offset:1024
    ds_read_b64_tr_b16 a[136:137], v234 offset:0
    ds_read_b64_tr_b16 a[138:139], v234 offset:1024
    ds_read_b64_tr_b16 a[140:141], v235 offset:0
    ds_read_b64_tr_b16 a[142:143], v235 offset:1024
    s_mov_b32 s29, 0
    s_mov_b32 s30, 0
    s_waitcnt lgkmcnt(0)
    s_waitcnt vmcnt(6)
    v_mfma_f32_32x32x16_bf16 v[40:55], a[128:131], a[0:3], 0
    ds_read_b64_tr_b16 a[144:145], v232 offset:4096
    s_mov_b32 s51, 4096
    buffer_load_dwordx4 a[32:35], v240, s[20:23], s51 offen offset:0 sc1
    v_mfma_f32_32x32x16_bf16 v[56:71], a[128:131], a[4:7], 0
    ds_read_b64_tr_b16 a[146:147], v232 offset:5120
    s_mov_b32 s51, 36864
    v_mfma_f32_32x32x16_bf16 v[72:87], a[132:135], a[0:3], 0
    ds_read_b64_tr_b16 a[148:149], v233 offset:4096
    buffer_load_dwordx4 a[36:39], v240, s[20:23], s51 offen offset:0 sc1
    v_mfma_f32_32x32x16_bf16 v[88:103], a[132:135], a[4:7], 0
    ds_read_b64_tr_b16 a[150:151], v233 offset:5120
    s_add_u32 m0, s34, 65536
    v_mfma_f32_32x32x16_bf16 v[104:119], a[136:139], a[0:3], 0
    ds_read_b64_tr_b16 a[152:153], v234 offset:4096
    s_mov_b32 s31, 1048576
    v_mfma_f32_32x32x16_bf16 v[120:135], a[136:139], a[4:7], 0
    ds_read_b64_tr_b16 a[154:155], v234 offset:5120
    ds_read_b64_tr_b16 a[156:157], v235 offset:4096
    ds_read_b64_tr_b16 a[158:159], v235 offset:5120
    buffer_load_dwordx4 v241, s[16:19], s31 offen offset:0 lds
    v_mfma_f32_32x32x16_bf16 v[136:151], a[140:143], a[0:3], 0
    s_mov_b32 s31, 1080320
    v_mfma_f32_32x32x16_bf16 v[152:167], a[140:143], a[4:7], 0
    buffer_load_dwordx4 v241, s[16:19], s31 offen offset:1024 lds
    s_waitcnt lgkmcnt(0)
    s_waitcnt vmcnt(8)
    v_mfma_f32_32x32x16_bf16 v[40:55], a[144:147], a[8:11], v[40:55]
    ds_read_b64_tr_b16 a[128:129], v232 offset:8192
    s_mov_b32 s51, 4096
    v_mfma_f32_32x32x16_bf16 v[56:71], a[144:147], a[12:15], v[56:71]
    ds_read_b64_tr_b16 a[130:131], v232 offset:9216
    buffer_load_dwordx4 a[40:43], v240, s[20:23], s51 offen offset:1024 sc1
    v_mfma_f32_32x32x16_bf16 v[72:87], a[148:151], a[8:11], v[72:87]
    ds_read_b64_tr_b16 a[132:133], v233 offset:8192
    s_mov_b32 s51, 36864
    v_mfma_f32_32x32x16_bf16 v[88:103], a[148:151], a[12:15], v[88:103]
    ds_read_b64_tr_b16 a[134:135], v233 offset:9216
    buffer_load_dwordx4 a[44:47], v240, s[20:23], s51 offen offset:1024 sc1
    v_mfma_f32_32x32x16_bf16 v[104:119], a[152:155], a[8:11], v[104:119]
    ds_read_b64_tr_b16 a[136:137], v234 offset:8192
    s_mov_b32 s31, 1112064
    v_mfma_f32_32x32x16_bf16 v[120:135], a[152:155], a[12:15], v[120:135]
    ds_read_b64_tr_b16 a[138:139], v234 offset:9216
    ds_read_b64_tr_b16 a[140:141], v235 offset:8192
    ds_read_b64_tr_b16 a[142:143], v235 offset:9216
    buffer_load_dwordx4 v241, s[16:19], s31 offen offset:2048 lds
    v_mfma_f32_32x32x16_bf16 v[136:151], a[156:159], a[8:11], v[136:151]
    s_mov_b32 s31, 1143808
    v_mfma_f32_32x32x16_bf16 v[152:167], a[156:159], a[12:15], v[152:167]
    buffer_load_dwordx4 v241, s[16:19], s31 offen offset:3072 lds
    s_waitcnt lgkmcnt(0)
    s_waitcnt vmcnt(10)
    v_mfma_f32_32x32x16_bf16 v[40:55], a[128:131], a[16:19], v[40:55]
    ds_read_b64_tr_b16 a[144:145], v232 offset:12288
    s_mov_b32 s51, 4096
    buffer_load_dwordx4 a[48:51], v240, s[20:23], s51 offen offset:2048 sc1
    v_mfma_f32_32x32x16_bf16 v[56:71], a[128:131], a[20:23], v[56:71]
    ds_read_b64_tr_b16 a[146:147], v232 offset:13312
    s_mov_b32 s51, 36864
    v_mfma_f32_32x32x16_bf16 v[72:87], a[132:135], a[16:19], v[72:87]
    ds_read_b64_tr_b16 a[148:149], v233 offset:12288
    buffer_load_dwordx4 a[52:55], v240, s[20:23], s51 offen offset:2048 sc1
    v_mfma_f32_32x32x16_bf16 v[88:103], a[132:135], a[20:23], v[88:103]
    ds_read_b64_tr_b16 a[150:151], v233 offset:13312
    s_add_u32 m0, s34, 69632
    v_mfma_f32_32x32x16_bf16 v[104:119], a[136:139], a[16:19], v[104:119]
    ds_read_b64_tr_b16 a[152:153], v234 offset:12288
    s_mov_b32 s31, 1179648
    v_mfma_f32_32x32x16_bf16 v[120:135], a[136:139], a[20:23], v[120:135]
    ds_read_b64_tr_b16 a[154:155], v234 offset:13312
    ds_read_b64_tr_b16 a[156:157], v235 offset:12288
    ds_read_b64_tr_b16 a[158:159], v235 offset:13312
    buffer_load_dwordx4 v241, s[16:19], s31 offen offset:0 lds
    v_mfma_f32_32x32x16_bf16 v[136:151], a[140:143], a[16:19], v[136:151]
    s_mov_b32 s31, 1211392
    v_mfma_f32_32x32x16_bf16 v[152:167], a[140:143], a[20:23], v[152:167]
    buffer_load_dwordx4 v241, s[16:19], s31 offen offset:1024 lds
    s_waitcnt lgkmcnt(0)
    s_waitcnt vmcnt(12)
    v_mfma_f32_32x32x16_bf16 v[40:55], a[144:147], a[24:27], v[40:55]
    ds_read_b64_tr_b16 a[128:129], v232 offset:16384
    s_mov_b32 s51, 4096
    v_mfma_f32_32x32x16_bf16 v[56:71], a[144:147], a[28:31], v[56:71]
    ds_read_b64_tr_b16 a[130:131], v232 offset:17408
    buffer_load_dwordx4 a[56:59], v240, s[20:23], s51 offen offset:3072 sc1
    v_mfma_f32_32x32x16_bf16 v[72:87], a[148:151], a[24:27], v[72:87]
    ds_read_b64_tr_b16 a[132:133], v233 offset:16384
    s_mov_b32 s51, 36864
    v_mfma_f32_32x32x16_bf16 v[88:103], a[148:151], a[28:31], v[88:103]
    ds_read_b64_tr_b16 a[134:135], v233 offset:17408
    buffer_load_dwordx4 a[60:63], v240, s[20:23], s51 offen offset:3072 sc1
    v_mfma_f32_32x32x16_bf16 v[104:119], a[152:155], a[24:27], v[104:119]
    ds_read_b64_tr_b16 a[136:137], v234 offset:16384
    s_mov_b32 s31, 1243136
    v_mfma_f32_32x32x16_bf16 v[120:135], a[152:155], a[28:31], v[120:135]
    ds_read_b64_tr_b16 a[138:139], v234 offset:17408
    ds_read_b64_tr_b16 a[140:141], v235 offset:16384
    ds_read_b64_tr_b16 a[142:143], v235 offset:17408
    buffer_load_dwordx4 v241, s[16:19], s31 offen offset:2048 lds
    v_mfma_f32_32x32x16_bf16 v[136:151], a[156:159], a[24:27], v[136:151]
    s_mov_b32 s31, 1274880
    v_mfma_f32_32x32x16_bf16 v[152:167], a[156:159], a[28:31], v[152:167]
    buffer_load_dwordx4 v241, s[16:19], s31 offen offset:3072 lds
    s_waitcnt lgkmcnt(0)
    s_waitcnt vmcnt(14)
    v_mfma_f32_32x32x16_bf16 v[40:55], a[128:131], a[32:35], v[40:55]
    ds_read_b64_tr_b16 a[144:145], v232 offset:20480
    s_mov_b32 s51, 8192
    v_mfma_f32_32x32x16_bf16 v[56:71], a[128:131], a[36:39], v[56:71]
    ds_read_b64_tr_b16 a[146:147], v232 offset:21504
    buffer_load_dwordx4 a[64:67], v240, s[20:23], s51 offen offset:0 sc1
    v_mfma_f32_32x32x16_bf16 v[72:87], a[132:135], a[32:35], v[72:87]
    ds_read_b64_tr_b16 a[148:149], v233 offset:20480
    s_mov_b32 s51, 40960
    v_mfma_f32_32x32x16_bf16 v[88:103], a[132:135], a[36:39], v[88:103]
    ds_read_b64_tr_b16 a[150:151], v233 offset:21504
    buffer_load_dwordx4 a[68:71], v240, s[20:23], s51 offen offset:0 sc1
    v_mfma_f32_32x32x16_bf16 v[104:119], a[136:139], a[32:35], v[104:119]
    ds_read_b64_tr_b16 a[152:153], v234 offset:20480
    s_add_u32 m0, s34, 32768
    v_mfma_f32_32x32x16_bf16 v[120:135], a[136:139], a[36:39], v[120:135]
    ds_read_b64_tr_b16 a[154:155], v234 offset:21504
    ds_read_b64_tr_b16 a[156:157], v235 offset:20480
    ds_read_b64_tr_b16 a[158:159], v235 offset:21504
    s_mov_b32 s31, 2097152
    v_mfma_f32_32x32x16_bf16 v[136:151], a[140:143], a[32:35], v[136:151]
    buffer_load_dwordx4 v241, s[16:19], s31 offen offset:0 lds
    v_mfma_f32_32x32x16_bf16 v[152:167], a[140:143], a[36:39], v[152:167]
    s_waitcnt lgkmcnt(0)
    s_waitcnt vmcnt(13)
    v_mfma_f32_32x32x16_bf16 v[40:55], a[144:147], a[40:43], v[40:55]
    ds_read_b64_tr_b16 a[128:129], v232 offset:24576
    s_mov_b32 s51, 8192
    v_mfma_f32_32x32x16_bf16 v[56:71], a[144:147], a[44:47], v[56:71]
    ds_read_b64_tr_b16 a[130:131], v232 offset:25600
    buffer_load_dwordx4 a[72:75], v240, s[20:23], s51 offen offset:1024 sc1
    v_mfma_f32_32x32x16_bf16 v[72:87], a[148:151], a[40:43], v[72:87]
    ds_read_b64_tr_b16 a[132:133], v233 offset:24576
    s_mov_b32 s51, 40960
    v_mfma_f32_32x32x16_bf16 v[88:103], a[148:151], a[44:47], v[88:103]
    ds_read_b64_tr_b16 a[134:135], v233 offset:25600
    v_mfma_f32_32x32x16_bf16 v[104:119], a[152:155], a[40:43], v[104:119]
    ds_read_b64_tr_b16 a[136:137], v234 offset:24576
    buffer_load_dwordx4 a[76:79], v240, s[20:23], s51 offen offset:1024 sc1
    v_mfma_f32_32x32x16_bf16 v[120:135], a[152:155], a[44:47], v[120:135]
    ds_read_b64_tr_b16 a[138:139], v234 offset:25600
    ds_read_b64_tr_b16 a[140:141], v235 offset:24576
    ds_read_b64_tr_b16 a[142:143], v235 offset:25600
    s_mov_b32 s31, 2128896
    v_mfma_f32_32x32x16_bf16 v[136:151], a[156:159], a[40:43], v[136:151]
    buffer_load_dwordx4 v241, s[16:19], s31 offen offset:1024 lds
    v_mfma_f32_32x32x16_bf16 v[152:167], a[156:159], a[44:47], v[152:167]
    s_waitcnt lgkmcnt(0)
    s_waitcnt vmcnt(12)
    v_mfma_f32_32x32x16_bf16 v[40:55], a[128:131], a[48:51], v[40:55]
    ds_read_b64_tr_b16 a[144:145], v232 offset:28672
    s_mov_b32 s51, 8192
    v_mfma_f32_32x32x16_bf16 v[56:71], a[128:131], a[52:55], v[56:71]
    ds_read_b64_tr_b16 a[146:147], v232 offset:29696
    buffer_load_dwordx4 a[80:83], v240, s[20:23], s51 offen offset:2048 sc1
    v_mfma_f32_32x32x16_bf16 v[72:87], a[132:135], a[48:51], v[72:87]
    ds_read_b64_tr_b16 a[148:149], v233 offset:28672
    s_mov_b32 s51, 40960
    v_mfma_f32_32x32x16_bf16 v[88:103], a[132:135], a[52:55], v[88:103]
    ds_read_b64_tr_b16 a[150:151], v233 offset:29696
    v_mfma_f32_32x32x16_bf16 v[104:119], a[136:139], a[48:51], v[104:119]
    ds_read_b64_tr_b16 a[152:153], v234 offset:28672
    buffer_load_dwordx4 a[84:87], v240, s[20:23], s51 offen offset:2048 sc1
    v_mfma_f32_32x32x16_bf16 v[120:135], a[136:139], a[52:55], v[120:135]
    ds_read_b64_tr_b16 a[154:155], v234 offset:29696
    ds_read_b64_tr_b16 a[156:157], v235 offset:28672
    ds_read_b64_tr_b16 a[158:159], v235 offset:29696
    s_mov_b32 s31, 2160640
    v_mfma_f32_32x32x16_bf16 v[136:151], a[140:143], a[48:51], v[136:151]
    buffer_load_dwordx4 v241, s[16:19], s31 offen offset:2048 lds
    v_mfma_f32_32x32x16_bf16 v[152:167], a[140:143], a[52:55], v[152:167]
    s_waitcnt lgkmcnt(0)
    s_waitcnt vmcnt(11)
    s_waitcnt vmcnt(9)
    s_barrier
    v_mfma_f32_32x32x16_bf16 v[40:55], a[144:147], a[56:59], v[40:55]
    ds_read_b64_tr_b16 a[128:129], v236 offset:0
    s_mov_b32 s51, 8192
    v_mfma_f32_32x32x16_bf16 v[56:71], a[144:147], a[60:63], v[56:71]
    ds_read_b64_tr_b16 a[130:131], v236 offset:1024
    buffer_load_dwordx4 a[88:91], v240, s[20:23], s51 offen offset:3072 sc1
    v_mfma_f32_32x32x16_bf16 v[72:87], a[148:151], a[56:59], v[72:87]
    ds_read_b64_tr_b16 a[132:133], v237 offset:0
    s_mov_b32 s51, 40960
    v_mfma_f32_32x32x16_bf16 v[88:103], a[148:151], a[60:63], v[88:103]
    ds_read_b64_tr_b16 a[134:135], v237 offset:1024
    v_mfma_f32_32x32x16_bf16 v[104:119], a[152:155], a[56:59], v[104:119]
    ds_read_b64_tr_b16 a[136:137], v238 offset:0
    buffer_load_dwordx4 a[92:95], v240, s[20:23], s51 offen offset:3072 sc1
    v_mfma_f32_32x32x16_bf16 v[120:135], a[152:155], a[60:63], v[120:135]
    ds_read_b64_tr_b16 a[138:139], v238 offset:1024
    ds_read_b64_tr_b16 a[140:141], v239 offset:0
    ds_read_b64_tr_b16 a[142:143], v239 offset:1024
    s_mov_b32 s31, 2192384
    v_mfma_f32_32x32x16_bf16 v[136:151], a[156:159], a[56:59], v[136:151]
    buffer_load_dwordx4 v241, s[16:19], s31 offen offset:3072 lds
    v_mfma_f32_32x32x16_bf16 v[152:167], a[156:159], a[60:63], v[152:167]
    s_waitcnt lgkmcnt(0)
    s_waitcnt vmcnt(10)
    v_mfma_f32_32x32x16_bf16 v[40:55], a[128:131], a[64:67], v[40:55]
    ds_read_b64_tr_b16 a[144:145], v236 offset:4096
    s_mov_b32 s51, 12288
    v_mfma_f32_32x32x16_bf16 v[56:71], a[128:131], a[68:71], v[56:71]
    ds_read_b64_tr_b16 a[146:147], v236 offset:5120
    buffer_load_dwordx4 a[96:99], v240, s[20:23], s51 offen offset:0 sc1
    v_mfma_f32_32x32x16_bf16 v[72:87], a[132:135], a[64:67], v[72:87]
    ds_read_b64_tr_b16 a[148:149], v237 offset:4096
    s_mov_b32 s51, 45056
    v_mfma_f32_32x32x16_bf16 v[88:103], a[132:135], a[68:71], v[88:103]
    ds_read_b64_tr_b16 a[150:151], v237 offset:5120
    buffer_load_dwordx4 a[100:103], v240, s[20:23], s51 offen offset:0 sc1
    v_mfma_f32_32x32x16_bf16 v[104:119], a[136:139], a[64:67], v[104:119]
    ds_read_b64_tr_b16 a[152:153], v238 offset:4096
    s_add_u32 m0, s34, 36864
    v_mfma_f32_32x32x16_bf16 v[120:135], a[136:139], a[68:71], v[120:135]
    ds_read_b64_tr_b16 a[154:155], v238 offset:5120
    ds_read_b64_tr_b16 a[156:157], v239 offset:4096
    ds_read_b64_tr_b16 a[158:159], v239 offset:5120
    s_mov_b32 s31, 2228224
    v_mfma_f32_32x32x16_bf16 v[136:151], a[140:143], a[64:67], v[136:151]
    buffer_load_dwordx4 v241, s[16:19], s31 offen offset:0 lds
    v_mfma_f32_32x32x16_bf16 v[152:167], a[140:143], a[68:71], v[152:167]
    s_waitcnt lgkmcnt(0)
    s_waitcnt vmcnt(10)
    v_mfma_f32_32x32x16_bf16 v[40:55], a[144:147], a[72:75], v[40:55]
    ds_read_b64_tr_b16 a[128:129], v236 offset:8192
    s_mov_b32 s51, 12288
    v_mfma_f32_32x32x16_bf16 v[56:71], a[144:147], a[76:79], v[56:71]
    ds_read_b64_tr_b16 a[130:131], v236 offset:9216
    buffer_load_dwordx4 a[104:107], v240, s[20:23], s51 offen offset:1024 sc1
    v_mfma_f32_32x32x16_bf16 v[72:87], a[148:151], a[72:75], v[72:87]
    ds_read_b64_tr_b16 a[132:133], v237 offset:8192
    s_mov_b32 s51, 45056
    v_mfma_f32_32x32x16_bf16 v[88:103], a[148:151], a[76:79], v[88:103]
    ds_read_b64_tr_b16 a[134:135], v237 offset:9216
    v_mfma_f32_32x32x16_bf16 v[104:119], a[152:155], a[72:75], v[104:119]
    ds_read_b64_tr_b16 a[136:137], v238 offset:8192
    buffer_load_dwordx4 a[108:111], v240, s[20:23], s51 offen offset:1024 sc1
    v_mfma_f32_32x32x16_bf16 v[120:135], a[152:155], a[76:79], v[120:135]
    ds_read_b64_tr_b16 a[138:139], v238 offset:9216
    ds_read_b64_tr_b16 a[140:141], v239 offset:8192
    ds_read_b64_tr_b16 a[142:143], v239 offset:9216
    s_mov_b32 s31, 2259968
    v_mfma_f32_32x32x16_bf16 v[136:151], a[156:159], a[72:75], v[136:151]
    buffer_load_dwordx4 v241, s[16:19], s31 offen offset:1024 lds
    v_mfma_f32_32x32x16_bf16 v[152:167], a[156:159], a[76:79], v[152:167]
    s_waitcnt lgkmcnt(0)
    s_waitcnt vmcnt(10)
    v_mfma_f32_32x32x16_bf16 v[40:55], a[128:131], a[80:83], v[40:55]
    ds_read_b64_tr_b16 a[144:145], v236 offset:12288
    s_mov_b32 s51, 12288
    v_mfma_f32_32x32x16_bf16 v[56:71], a[128:131], a[84:87], v[56:71]
    ds_read_b64_tr_b16 a[146:147], v236 offset:13312
    buffer_load_dwordx4 a[112:115], v240, s[20:23], s51 offen offset:2048 sc1
    v_mfma_f32_32x32x16_bf16 v[72:87], a[132:135], a[80:83], v[72:87]
    ds_read_b64_tr_b16 a[148:149], v237 offset:12288
    s_mov_b32 s51, 45056
    v_mfma_f32_32x32x16_bf16 v[88:103], a[132:135], a[84:87], v[88:103]
    ds_read_b64_tr_b16 a[150:151], v237 offset:13312
    v_mfma_f32_32x32x16_bf16 v[104:119], a[136:139], a[80:83], v[104:119]
    ds_read_b64_tr_b16 a[152:153], v238 offset:12288
    buffer_load_dwordx4 a[116:119], v240, s[20:23], s51 offen offset:2048 sc1
    v_mfma_f32_32x32x16_bf16 v[120:135], a[136:139], a[84:87], v[120:135]
    ds_read_b64_tr_b16 a[154:155], v238 offset:13312
    ds_read_b64_tr_b16 a[156:157], v239 offset:12288
    ds_read_b64_tr_b16 a[158:159], v239 offset:13312
    s_mov_b32 s31, 2291712
    v_mfma_f32_32x32x16_bf16 v[136:151], a[140:143], a[80:83], v[136:151]
    buffer_load_dwordx4 v241, s[16:19], s31 offen offset:2048 lds
    v_mfma_f32_32x32x16_bf16 v[152:167], a[140:143], a[84:87], v[152:167]
    s_waitcnt lgkmcnt(0)
    s_waitcnt vmcnt(10)
    v_mfma_f32_32x32x16_bf16 v[40:55], a[144:147], a[88:91], v[40:55]
    ds_read_b64_tr_b16 a[128:129], v236 offset:16384
    s_mov_b32 s51, 12288
    v_mfma_f32_32x32x16_bf16 v[56:71], a[144:147], a[92:95], v[56:71]
    ds_read_b64_tr_b16 a[130:131], v236 offset:17408
    buffer_load_dwordx4 a[120:123], v240, s[20:23], s51 offen offset:3072 sc1
    v_mfma_f32_32x32x16_bf16 v[72:87], a[148:151], a[88:91], v[72:87]
    ds_read_b64_tr_b16 a[132:133], v237 offset:16384
    s_mov_b32 s51, 45056
    v_mfma_f32_32x32x16_bf16 v[88:103], a[148:151], a[92:95], v[88:103]
    ds_read_b64_tr_b16 a[134:135], v237 offset:17408
    v_mfma_f32_32x32x16_bf16 v[104:119], a[152:155], a[88:91], v[104:119]
    ds_read_b64_tr_b16 a[136:137], v238 offset:16384
    buffer_load_dwordx4 a[124:127], v240, s[20:23], s51 offen offset:3072 sc1
    v_mfma_f32_32x32x16_bf16 v[120:135], a[152:155], a[92:95], v[120:135]
    ds_read_b64_tr_b16 a[138:139], v238 offset:17408
    ds_read_b64_tr_b16 a[140:141], v239 offset:16384
    ds_read_b64_tr_b16 a[142:143], v239 offset:17408
    s_mov_b32 s31, 2323456
    v_mfma_f32_32x32x16_bf16 v[136:151], a[156:159], a[88:91], v[136:151]
    buffer_load_dwordx4 v241, s[16:19], s31 offen offset:3072 lds
    v_mfma_f32_32x32x16_bf16 v[152:167], a[156:159], a[92:95], v[152:167]
    s_waitcnt lgkmcnt(0)
    s_waitcnt vmcnt(10)
    v_mfma_f32_32x32x16_bf16 v[40:55], a[128:131], a[96:99], v[40:55]
    ds_read_b64_tr_b16 a[144:145], v236 offset:20480
    s_mov_b32 s51, 16384
    v_mfma_f32_32x32x16_bf16 v[56:71], a[128:131], a[100:103], v[56:71]
    ds_read_b64_tr_b16 a[146:147], v236 offset:21504
    buffer_load_dwordx4 a[0:3], v240, s[20:23], s51 offen offset:0 sc1
    v_mfma_f32_32x32x16_bf16 v[72:87], a[132:135], a[96:99], v[72:87]
    ds_read_b64_tr_b16 a[148:149], v237 offset:20480
    s_mov_b32 s51, 49152
    v_mfma_f32_32x32x16_bf16 v[88:103], a[132:135], a[100:103], v[88:103]
    ds_read_b64_tr_b16 a[150:151], v237 offset:21504
    buffer_load_dwordx4 a[4:7], v240, s[20:23], s51 offen offset:0 sc1
    v_mfma_f32_32x32x16_bf16 v[104:119], a[136:139], a[96:99], v[104:119]
    ds_read_b64_tr_b16 a[152:153], v238 offset:20480
    s_add_u32 m0, s34, 98304
    v_mfma_f32_32x32x16_bf16 v[120:135], a[136:139], a[100:103], v[120:135]
    ds_read_b64_tr_b16 a[154:155], v238 offset:21504
    ds_read_b64_tr_b16 a[156:157], v239 offset:20480
    ds_read_b64_tr_b16 a[158:159], v239 offset:21504
    s_mov_b32 s31, 3145728
    v_mfma_f32_32x32x16_bf16 v[136:151], a[140:143], a[96:99], v[136:151]
    buffer_load_dwordx4 v241, s[16:19], s31 offen offset:0 lds
    v_mfma_f32_32x32x16_bf16 v[152:167], a[140:143], a[100:103], v[152:167]
    s_waitcnt lgkmcnt(0)
    s_waitcnt vmcnt(10)
    v_mfma_f32_32x32x16_bf16 v[40:55], a[144:147], a[104:107], v[40:55]
    ds_read_b64_tr_b16 a[128:129], v236 offset:24576
    s_mov_b32 s51, 16384
    v_mfma_f32_32x32x16_bf16 v[56:71], a[144:147], a[108:111], v[56:71]
    ds_read_b64_tr_b16 a[130:131], v236 offset:25600
    buffer_load_dwordx4 a[8:11], v240, s[20:23], s51 offen offset:1024 sc1
    v_mfma_f32_32x32x16_bf16 v[72:87], a[148:151], a[104:107], v[72:87]
    ds_read_b64_tr_b16 a[132:133], v237 offset:24576
    s_mov_b32 s51, 49152
    v_mfma_f32_32x32x16_bf16 v[88:103], a[148:151], a[108:111], v[88:103]
    ds_read_b64_tr_b16 a[134:135], v237 offset:25600
    v_mfma_f32_32x32x16_bf16 v[104:119], a[152:155], a[104:107], v[104:119]
    ds_read_b64_tr_b16 a[136:137], v238 offset:24576
    buffer_load_dwordx4 a[12:15], v240, s[20:23], s51 offen offset:1024 sc1
    v_mfma_f32_32x32x16_bf16 v[120:135], a[152:155], a[108:111], v[120:135]
    ds_read_b64_tr_b16 a[138:139], v238 offset:25600
    ds_read_b64_tr_b16 a[140:141], v239 offset:24576
    ds_read_b64_tr_b16 a[142:143], v239 offset:25600
    s_mov_b32 s31, 3177472
    v_mfma_f32_32x32x16_bf16 v[136:151], a[156:159], a[104:107], v[136:151]
    buffer_load_dwordx4 v241, s[16:19], s31 offen offset:1024 lds
    v_mfma_f32_32x32x16_bf16 v[152:167], a[156:159], a[108:111], v[152:167]
    s_waitcnt lgkmcnt(0)
    s_waitcnt vmcnt(10)
    v_mfma_f32_32x32x16_bf16 v[40:55], a[128:131], a[112:115], v[40:55]
    ds_read_b64_tr_b16 a[144:145], v236 offset:28672
    s_mov_b32 s51, 16384
    v_mfma_f32_32x32x16_bf16 v[56:71], a[128:131], a[116:119], v[56:71]
    ds_read_b64_tr_b16 a[146:147], v236 offset:29696
    buffer_load_dwordx4 a[16:19], v240, s[20:23], s51 offen offset:2048 sc1
    v_mfma_f32_32x32x16_bf16 v[72:87], a[132:135], a[112:115], v[72:87]
    ds_read_b64_tr_b16 a[148:149], v237 offset:28672
    s_mov_b32 s51, 49152
    v_mfma_f32_32x32x16_bf16 v[88:103], a[132:135], a[116:119], v[88:103]
    ds_read_b64_tr_b16 a[150:151], v237 offset:29696
    v_mfma_f32_32x32x16_bf16 v[104:119], a[136:139], a[112:115], v[104:119]
    ds_read_b64_tr_b16 a[152:153], v238 offset:28672
    buffer_load_dwordx4 a[20:23], v240, s[20:23], s51 offen offset:2048 sc1
    v_mfma_f32_32x32x16_bf16 v[120:135], a[136:139], a[116:119], v[120:135]
    ds_read_b64_tr_b16 a[154:155], v238 offset:29696
    ds_read_b64_tr_b16 a[156:157], v239 offset:28672
    ds_read_b64_tr_b16 a[158:159], v239 offset:29696
    s_mov_b32 s31, 3209216
    v_mfma_f32_32x32x16_bf16 v[136:151], a[140:143], a[112:115], v[136:151]
    buffer_load_dwordx4 v241, s[16:19], s31 offen offset:2048 lds
    v_mfma_f32_32x32x16_bf16 v[152:167], a[140:143], a[116:119], v[152:167]
    s_waitcnt lgkmcnt(0)
    s_waitcnt vmcnt(10)
    s_waitcnt vmcnt(9)
    s_barrier
    v_mfma_f32_32x32x16_bf16 v[40:55], a[144:147], a[120:123], v[40:55]
    ds_read_b64_tr_b16 a[128:129], v232 offset:32768
    s_mov_b32 s51, 16384
    v_mfma_f32_32x32x16_bf16 v[56:71], a[144:147], a[124:127], v[56:71]
    ds_read_b64_tr_b16 a[130:131], v232 offset:33792
    buffer_load_dwordx4 a[24:27], v240, s[20:23], s51 offen offset:3072 sc1
    v_mfma_f32_32x32x16_bf16 v[72:87], a[148:151], a[120:123], v[72:87]
    ds_read_b64_tr_b16 a[132:133], v233 offset:32768
    s_mov_b32 s51, 49152
    v_mfma_f32_32x32x16_bf16 v[88:103], a[148:151], a[124:127], v[88:103]
    ds_read_b64_tr_b16 a[134:135], v233 offset:33792
    v_mfma_f32_32x32x16_bf16 v[104:119], a[152:155], a[120:123], v[104:119]
    ds_read_b64_tr_b16 a[136:137], v234 offset:32768
    buffer_load_dwordx4 a[28:31], v240, s[20:23], s51 offen offset:3072 sc1
    v_mfma_f32_32x32x16_bf16 v[120:135], a[152:155], a[124:127], v[120:135]
    ds_read_b64_tr_b16 a[138:139], v234 offset:33792
    ds_read_b64_tr_b16 a[140:141], v235 offset:32768
    ds_read_b64_tr_b16 a[142:143], v235 offset:33792
    s_mov_b32 s31, 3240960
    v_mfma_f32_32x32x16_bf16 v[136:151], a[156:159], a[120:123], v[136:151]
    buffer_load_dwordx4 v241, s[16:19], s31 offen offset:3072 lds
    v_mfma_f32_32x32x16_bf16 v[152:167], a[156:159], a[124:127], v[152:167]
    s_waitcnt lgkmcnt(0)
    s_waitcnt vmcnt(10)
    v_mfma_f32_32x32x16_bf16 v[40:55], a[128:131], a[0:3], v[40:55]
    ds_read_b64_tr_b16 a[144:145], v232 offset:36864
    s_mov_b32 s51, 20480
    v_mfma_f32_32x32x16_bf16 v[56:71], a[128:131], a[4:7], v[56:71]
    ds_read_b64_tr_b16 a[146:147], v232 offset:37888
    buffer_load_dwordx4 a[32:35], v240, s[20:23], s51 offen offset:0 sc1
    v_mfma_f32_32x32x16_bf16 v[72:87], a[132:135], a[0:3], v[72:87]
    ds_read_b64_tr_b16 a[148:149], v233 offset:36864
    s_mov_b32 s51, 53248
    v_mfma_f32_32x32x16_bf16 v[88:103], a[132:135], a[4:7], v[88:103]
    ds_read_b64_tr_b16 a[150:151], v233 offset:37888
    buffer_load_dwordx4 a[36:39], v240, s[20:23], s51 offen offset:0 sc1
    v_mfma_f32_32x32x16_bf16 v[104:119], a[136:139], a[0:3], v[104:119]
    ds_read_b64_tr_b16 a[152:153], v234 offset:36864
    s_add_u32 m0, s34, 102400
    v_mfma_f32_32x32x16_bf16 v[120:135], a[136:139], a[4:7], v[120:135]
    ds_read_b64_tr_b16 a[154:155], v234 offset:37888
    ds_read_b64_tr_b16 a[156:157], v235 offset:36864
    ds_read_b64_tr_b16 a[158:159], v235 offset:37888
    s_mov_b32 s31, 3276800
    v_mfma_f32_32x32x16_bf16 v[136:151], a[140:143], a[0:3], v[136:151]
    buffer_load_dwordx4 v241, s[16:19], s31 offen offset:0 lds
    v_mfma_f32_32x32x16_bf16 v[152:167], a[140:143], a[4:7], v[152:167]
    s_waitcnt lgkmcnt(0)
    s_waitcnt vmcnt(10)
    v_mfma_f32_32x32x16_bf16 v[40:55], a[144:147], a[8:11], v[40:55]
    ds_read_b64_tr_b16 a[128:129], v232 offset:40960
    s_mov_b32 s51, 20480
    v_accvgpr_write_b32 a0, 0
    v_mfma_f32_32x32x16_bf16 v[56:71], a[144:147], a[12:15], v[56:71]
    ds_read_b64_tr_b16 a[130:131], v232 offset:41984
    buffer_load_dwordx4 a[40:43], v240, s[20:23], s51 offen offset:1024 sc1
    v_accvgpr_write_b32 a1, 0
    v_mfma_f32_32x32x16_bf16 v[72:87], a[148:151], a[8:11], v[72:87]
    ds_read_b64_tr_b16 a[132:133], v233 offset:40960
    s_mov_b32 s51, 53248
    v_accvgpr_write_b32 a2, 0
    v_mfma_f32_32x32x16_bf16 v[88:103], a[148:151], a[12:15], v[88:103]
    ds_read_b64_tr_b16 a[134:135], v233 offset:41984
    v_accvgpr_write_b32 a3, 0
    v_mfma_f32_32x32x16_bf16 v[104:119], a[152:155], a[8:11], v[104:119]
    ds_read_b64_tr_b16 a[136:137], v234 offset:40960
    buffer_load_dwordx4 a[44:47], v240, s[20:23], s51 offen offset:1024 sc1
    v_accvgpr_write_b32 a4, 0
    v_mfma_f32_32x32x16_bf16 v[120:135], a[152:155], a[12:15], v[120:135]
    ds_read_b64_tr_b16 a[138:139], v234 offset:41984
    ds_read_b64_tr_b16 a[140:141], v235 offset:40960
    ds_read_b64_tr_b16 a[142:143], v235 offset:41984
    s_mov_b32 s31, 3308544
    v_accvgpr_write_b32 a5, 0
    v_mfma_f32_32x32x16_bf16 v[136:151], a[156:159], a[8:11], v[136:151]
    buffer_load_dwordx4 v241, s[16:19], s31 offen offset:1024 lds
    v_accvgpr_write_b32 a6, 0
    v_mfma_f32_32x32x16_bf16 v[152:167], a[156:159], a[12:15], v[152:167]
    v_accvgpr_write_b32 a7, 0
    s_waitcnt lgkmcnt(0)
    s_waitcnt vmcnt(10)
    v_mfma_f32_32x32x16_bf16 v[40:55], a[128:131], a[16:19], v[40:55]
    ds_read_b64_tr_b16 a[144:145], v232 offset:45056
    s_mov_b32 s51, 20480
    v_accvgpr_write_b32 a8, 0
    v_mfma_f32_32x32x16_bf16 v[56:71], a[128:131], a[20:23], v[56:71]
    ds_read_b64_tr_b16 a[146:147], v232 offset:46080
    buffer_load_dwordx4 a[48:51], v240, s[20:23], s51 offen offset:2048 sc1
    v_accvgpr_write_b32 a9, 0
    v_mfma_f32_32x32x16_bf16 v[72:87], a[132:135], a[16:19], v[72:87]
    ds_read_b64_tr_b16 a[148:149], v233 offset:45056
    s_mov_b32 s51, 53248
    v_accvgpr_write_b32 a10, 0
    v_mfma_f32_32x32x16_bf16 v[88:103], a[132:135], a[20:23], v[88:103]
    ds_read_b64_tr_b16 a[150:151], v233 offset:46080
    v_accvgpr_write_b32 a11, 0
    v_mfma_f32_32x32x16_bf16 v[104:119], a[136:139], a[16:19], v[104:119]
    ds_read_b64_tr_b16 a[152:153], v234 offset:45056
    buffer_load_dwordx4 a[52:55], v240, s[20:23], s51 offen offset:2048 sc1
    v_accvgpr_write_b32 a12, 0
    v_mfma_f32_32x32x16_bf16 v[120:135], a[136:139], a[20:23], v[120:135]
    ds_read_b64_tr_b16 a[154:155], v234 offset:46080
    ds_read_b64_tr_b16 a[156:157], v235 offset:45056
    ds_read_b64_tr_b16 a[158:159], v235 offset:46080
    s_mov_b32 s31, 3340288
    v_accvgpr_write_b32 a13, 0
    v_mfma_f32_32x32x16_bf16 v[136:151], a[140:143], a[16:19], v[136:151]
    buffer_load_dwordx4 v241, s[16:19], s31 offen offset:2048 lds
    v_accvgpr_write_b32 a14, 0
    v_mfma_f32_32x32x16_bf16 v[152:167], a[140:143], a[20:23], v[152:167]
    v_accvgpr_write_b32 a15, 0
    s_waitcnt lgkmcnt(0)
    s_waitcnt vmcnt(10)
    v_mfma_f32_32x32x16_bf16 v[40:55], a[144:147], a[24:27], v[40:55]
    ds_read_b64_tr_b16 a[128:129], v232 offset:49152
    s_mov_b32 s51, 20480
    v_accvgpr_write_b32 a16, 0
    v_mfma_f32_32x32x16_bf16 v[56:71], a[144:147], a[28:31], v[56:71]
    ds_read_b64_tr_b16 a[130:131], v232 offset:50176
    buffer_load_dwordx4 a[56:59], v240, s[20:23], s51 offen offset:3072 sc1
    v_accvgpr_write_b32 a17, 0
    v_mfma_f32_32x32x16_bf16 v[72:87], a[148:151], a[24:27], v[72:87]
    ds_read_b64_tr_b16 a[132:133], v233 offset:49152
    s_mov_b32 s51, 53248
    v_accvgpr_write_b32 a18, 0
    v_mfma_f32_32x32x16_bf16 v[88:103], a[148:151], a[28:31], v[88:103]
    ds_read_b64_tr_b16 a[134:135], v233 offset:50176
    v_accvgpr_write_b32 a19, 0
    v_mfma_f32_32x32x16_bf16 v[104:119], a[152:155], a[24:27], v[104:119]
    ds_read_b64_tr_b16 a[136:137], v234 offset:49152
    buffer_load_dwordx4 a[60:63], v240, s[20:23], s51 offen offset:3072 sc1
    v_accvgpr_write_b32 a20, 0
    v_mfma_f32_32x32x16_bf16 v[120:135], a[152:155], a[28:31], v[120:135]
    ds_read_b64_tr_b16 a[138:139], v234 offset:50176
    ds_read_b64_tr_b16 a[140:141], v235 offset:49152
    ds_read_b64_tr_b16 a[142:143], v235 offset:50176
    s_mov_b32 s31, 3372032
    v_accvgpr_write_b32 a21, 0
    v_mfma_f32_32x32x16_bf16 v[136:151], a[156:159], a[24:27], v[136:151]
    buffer_load_dwordx4 v241, s[16:19], s31 offen offset:3072 lds
    v_accvgpr_write_b32 a22, 0
    v_mfma_f32_32x32x16_bf16 v[152:167], a[156:159], a[28:31], v[152:167]
    v_accvgpr_write_b32 a23, 0
    s_waitcnt lgkmcnt(0)
    s_waitcnt vmcnt(10)
    v_mfma_f32_32x32x16_bf16 v[40:55], a[128:131], a[32:35], v[40:55]
    ds_read_b64_tr_b16 a[144:145], v232 offset:53248
    s_mov_b32 s51, 24576
    v_accvgpr_write_b32 a24, 0
    v_mfma_f32_32x32x16_bf16 v[56:71], a[128:131], a[36:39], v[56:71]
    ds_read_b64_tr_b16 a[146:147], v232 offset:54272
    buffer_load_dwordx4 a[64:67], v240, s[20:23], s51 offen offset:0 sc1
    v_accvgpr_write_b32 a25, 0
    v_mfma_f32_32x32x16_bf16 v[72:87], a[132:135], a[32:35], v[72:87]
    ds_read_b64_tr_b16 a[148:149], v233 offset:53248
    s_mov_b32 s51, 57344
    v_accvgpr_write_b32 a26, 0
    v_mfma_f32_32x32x16_bf16 v[88:103], a[132:135], a[36:39], v[88:103]
    ds_read_b64_tr_b16 a[150:151], v233 offset:54272
    v_accvgpr_write_b32 a27, 0
    v_mfma_f32_32x32x16_bf16 v[104:119], a[136:139], a[32:35], v[104:119]
    ds_read_b64_tr_b16 a[152:153], v234 offset:53248
    buffer_load_dwordx4 a[68:71], v240, s[20:23], s51 offen offset:0 sc1
    v_accvgpr_write_b32 a28, 0
    v_mfma_f32_32x32x16_bf16 v[120:135], a[136:139], a[36:39], v[120:135]
    ds_read_b64_tr_b16 a[154:155], v234 offset:54272
    ds_read_b64_tr_b16 a[156:157], v235 offset:53248
    ds_read_b64_tr_b16 a[158:159], v235 offset:54272
    s_add_u32 m0, s28, 0
    v_accvgpr_write_b32 a29, 0
    v_mfma_f32_32x32x16_bf16 v[136:151], a[140:143], a[32:35], v[136:151]
    buffer_load_dwordx4 v22, s[8:11], s29 offen offset:0 lds
    v_accvgpr_write_b32 a30, 0
    v_mfma_f32_32x32x16_bf16 v[152:167], a[140:143], a[36:39], v[152:167]
    v_accvgpr_write_b32 a31, 0
    s_waitcnt lgkmcnt(0)
    s_waitcnt vmcnt(10)
    v_mfma_f32_32x32x16_bf16 v[40:55], a[144:147], a[40:43], v[40:55]
    ds_read_b64_tr_b16 a[128:129], v232 offset:57344
    s_mov_b32 s51, 24576
    v_accvgpr_write_b32 a32, 0
    v_mfma_f32_32x32x16_bf16 v[56:71], a[144:147], a[44:47], v[56:71]
    ds_read_b64_tr_b16 a[130:131], v232 offset:58368
    buffer_load_dwordx4 a[72:75], v240, s[20:23], s51 offen offset:1024 sc1
    v_accvgpr_write_b32 a33, 0
    v_mfma_f32_32x32x16_bf16 v[72:87], a[148:151], a[40:43], v[72:87]
    ds_read_b64_tr_b16 a[132:133], v233 offset:57344
    v_accvgpr_write_b32 a34, 0
    v_mfma_f32_32x32x16_bf16 v[88:103], a[148:151], a[44:47], v[88:103]
    ds_read_b64_tr_b16 a[134:135], v233 offset:58368
    s_mov_b32 s51, 57344
    v_accvgpr_write_b32 a35, 0
    v_mfma_f32_32x32x16_bf16 v[104:119], a[152:155], a[40:43], v[104:119]
    ds_read_b64_tr_b16 a[136:137], v234 offset:57344
    buffer_load_dwordx4 a[76:79], v240, s[20:23], s51 offen offset:1024 sc1
    v_accvgpr_write_b32 a36, 0
    v_mfma_f32_32x32x16_bf16 v[120:135], a[152:155], a[44:47], v[120:135]
    ds_read_b64_tr_b16 a[138:139], v234 offset:58368
    ds_read_b64_tr_b16 a[140:141], v235 offset:57344
    ds_read_b64_tr_b16 a[142:143], v235 offset:58368
    v_accvgpr_write_b32 a37, 0
    v_mfma_f32_32x32x16_bf16 v[136:151], a[156:159], a[40:43], v[136:151]
    buffer_load_dwordx4 v23, s[8:11], s29 offen offset:1024 lds
    v_accvgpr_write_b32 a38, 0
    v_mfma_f32_32x32x16_bf16 v[152:167], a[156:159], a[44:47], v[152:167]
    v_accvgpr_write_b32 a39, 0
    s_waitcnt lgkmcnt(0)
    s_waitcnt vmcnt(10)
    v_mfma_f32_32x32x16_bf16 v[40:55], a[128:131], a[48:51], v[40:55]
    ds_read_b64_tr_b16 a[144:145], v232 offset:61440
    s_mov_b32 s51, 24576
    v_accvgpr_write_b32 a40, 0
    v_mfma_f32_32x32x16_bf16 v[56:71], a[128:131], a[52:55], v[56:71]
    ds_read_b64_tr_b16 a[146:147], v232 offset:62464
    buffer_load_dwordx4 a[80:83], v240, s[20:23], s51 offen offset:2048 sc1
    v_accvgpr_write_b32 a41, 0
    v_mfma_f32_32x32x16_bf16 v[72:87], a[132:135], a[48:51], v[72:87]
    ds_read_b64_tr_b16 a[148:149], v233 offset:61440
    v_accvgpr_write_b32 a42, 0
    v_mfma_f32_32x32x16_bf16 v[88:103], a[132:135], a[52:55], v[88:103]
    ds_read_b64_tr_b16 a[150:151], v233 offset:62464
    s_mov_b32 s51, 57344
    v_accvgpr_write_b32 a43, 0
    v_mfma_f32_32x32x16_bf16 v[104:119], a[136:139], a[48:51], v[104:119]
    ds_read_b64_tr_b16 a[152:153], v234 offset:61440
    buffer_load_dwordx4 a[84:87], v240, s[20:23], s51 offen offset:2048 sc1
    v_accvgpr_write_b32 a44, 0
    v_mfma_f32_32x32x16_bf16 v[120:135], a[136:139], a[52:55], v[120:135]
    ds_read_b64_tr_b16 a[154:155], v234 offset:62464
    ds_read_b64_tr_b16 a[156:157], v235 offset:61440
    ds_read_b64_tr_b16 a[158:159], v235 offset:62464
    v_accvgpr_write_b32 a45, 0
    v_mfma_f32_32x32x16_bf16 v[136:151], a[140:143], a[48:51], v[136:151]
    buffer_load_dwordx4 v24, s[8:11], s29 offen offset:2048 lds
    v_accvgpr_write_b32 a46, 0
    v_mfma_f32_32x32x16_bf16 v[152:167], a[140:143], a[52:55], v[152:167]
    v_accvgpr_write_b32 a47, 0
    s_waitcnt lgkmcnt(0)
    s_waitcnt vmcnt(10)
    s_waitcnt vmcnt(9)
    s_barrier
    v_mfma_f32_32x32x16_bf16 v[40:55], a[144:147], a[56:59], v[40:55]
    ds_read_b64_tr_b16 a[128:129], v236 offset:32768
    s_mov_b32 s51, 24576
    v_accvgpr_write_b32 a48, 0
    v_mfma_f32_32x32x16_bf16 v[56:71], a[144:147], a[60:63], v[56:71]
    ds_read_b64_tr_b16 a[130:131], v236 offset:33792
    buffer_load_dwordx4 a[88:91], v240, s[20:23], s51 offen offset:3072 sc1
    v_accvgpr_write_b32 a49, 0
    v_mfma_f32_32x32x16_bf16 v[72:87], a[148:151], a[56:59], v[72:87]
    ds_read_b64_tr_b16 a[132:133], v237 offset:32768
    v_accvgpr_write_b32 a50, 0
    v_mfma_f32_32x32x16_bf16 v[88:103], a[148:151], a[60:63], v[88:103]
    ds_read_b64_tr_b16 a[134:135], v237 offset:33792
    s_mov_b32 s51, 57344
    v_accvgpr_write_b32 a51, 0
    v_mfma_f32_32x32x16_bf16 v[104:119], a[152:155], a[56:59], v[104:119]
    ds_read_b64_tr_b16 a[136:137], v238 offset:32768
    buffer_load_dwordx4 a[92:95], v240, s[20:23], s51 offen offset:3072 sc1
    v_accvgpr_write_b32 a52, 0
    v_mfma_f32_32x32x16_bf16 v[120:135], a[152:155], a[60:63], v[120:135]
    ds_read_b64_tr_b16 a[138:139], v238 offset:33792
    ds_read_b64_tr_b16 a[140:141], v239 offset:32768
    ds_read_b64_tr_b16 a[142:143], v239 offset:33792
    v_accvgpr_write_b32 a53, 0
    v_mfma_f32_32x32x16_bf16 v[136:151], a[156:159], a[56:59], v[136:151]
    buffer_load_dwordx4 v25, s[8:11], s29 offen offset:3072 lds
    v_accvgpr_write_b32 a54, 0
    v_mfma_f32_32x32x16_bf16 v[152:167], a[156:159], a[60:63], v[152:167]
    v_accvgpr_write_b32 a55, 0
    s_waitcnt lgkmcnt(0)
    s_waitcnt vmcnt(10)
    v_mfma_f32_32x32x16_bf16 v[40:55], a[128:131], a[64:67], v[40:55]
    ds_read_b64_tr_b16 a[144:145], v236 offset:36864
    s_mov_b32 s51, 28672
    v_accvgpr_write_b32 a56, 0
    v_mfma_f32_32x32x16_bf16 v[56:71], a[128:131], a[68:71], v[56:71]
    ds_read_b64_tr_b16 a[146:147], v236 offset:37888
    buffer_load_dwordx4 a[96:99], v240, s[20:23], s51 offen offset:0 sc1
    v_accvgpr_write_b32 a57, 0
    v_mfma_f32_32x32x16_bf16 v[72:87], a[132:135], a[64:67], v[72:87]
    ds_read_b64_tr_b16 a[148:149], v237 offset:36864
    s_mov_b32 s51, 61440
    v_accvgpr_write_b32 a58, 0
    v_mfma_f32_32x32x16_bf16 v[88:103], a[132:135], a[68:71], v[88:103]
    ds_read_b64_tr_b16 a[150:151], v237 offset:37888
    buffer_load_dwordx4 a[100:103], v240, s[20:23], s51 offen offset:0 sc1
    v_accvgpr_write_b32 a59, 0
    v_mfma_f32_32x32x16_bf16 v[104:119], a[136:139], a[64:67], v[104:119]
    ds_read_b64_tr_b16 a[152:153], v238 offset:36864
    s_add_u32 s29, s29, 16384
    v_accvgpr_write_b32 a60, 0
    v_mfma_f32_32x32x16_bf16 v[120:135], a[136:139], a[68:71], v[120:135]
    ds_read_b64_tr_b16 a[154:155], v238 offset:37888
    ds_read_b64_tr_b16 a[156:157], v239 offset:36864
    ds_read_b64_tr_b16 a[158:159], v239 offset:37888
    s_min_u32 s29, s29, 507904
    v_accvgpr_write_b32 a61, 0
    v_mfma_f32_32x32x16_bf16 v[136:151], a[140:143], a[64:67], v[136:151]
    s_add_u32 m0, s28, 16384
    v_accvgpr_write_b32 a62, 0
    v_mfma_f32_32x32x16_bf16 v[152:167], a[140:143], a[68:71], v[152:167]
    buffer_load_dwordx4 v22, s[8:11], s29 offen offset:0 lds
    v_accvgpr_write_b32 a63, 0
    s_waitcnt lgkmcnt(0)
    s_waitcnt vmcnt(10)
    v_mfma_f32_32x32x16_bf16 v[40:55], a[144:147], a[72:75], v[40:55]
    ds_read_b64_tr_b16 a[128:129], v236 offset:40960
    s_mov_b32 s51, 28672
    v_accvgpr_write_b32 a64, 0
    v_mfma_f32_32x32x16_bf16 v[56:71], a[144:147], a[76:79], v[56:71]
    ds_read_b64_tr_b16 a[130:131], v236 offset:41984
    buffer_load_dwordx4 a[104:107], v240, s[20:23], s51 offen offset:1024 sc1
    v_accvgpr_write_b32 a65, 0
    v_mfma_f32_32x32x16_bf16 v[72:87], a[148:151], a[72:75], v[72:87]
    ds_read_b64_tr_b16 a[132:133], v237 offset:40960
    v_accvgpr_write_b32 a66, 0
    v_mfma_f32_32x32x16_bf16 v[88:103], a[148:151], a[76:79], v[88:103]
    ds_read_b64_tr_b16 a[134:135], v237 offset:41984
    s_mov_b32 s51, 61440
    v_accvgpr_write_b32 a67, 0
    v_mfma_f32_32x32x16_bf16 v[104:119], a[152:155], a[72:75], v[104:119]
    ds_read_b64_tr_b16 a[136:137], v238 offset:40960
    buffer_load_dwordx4 a[108:111], v240, s[20:23], s51 offen offset:1024 sc1
    v_accvgpr_write_b32 a68, 0
    v_mfma_f32_32x32x16_bf16 v[120:135], a[152:155], a[76:79], v[120:135]
    ds_read_b64_tr_b16 a[138:139], v238 offset:41984
    ds_read_b64_tr_b16 a[140:141], v239 offset:40960
    ds_read_b64_tr_b16 a[142:143], v239 offset:41984
    v_accvgpr_write_b32 a69, 0
    v_mfma_f32_32x32x16_bf16 v[136:151], a[156:159], a[72:75], v[136:151]
    buffer_load_dwordx4 v23, s[8:11], s29 offen offset:1024 lds
    v_accvgpr_write_b32 a70, 0
    v_mfma_f32_32x32x16_bf16 v[152:167], a[156:159], a[76:79], v[152:167]
    v_accvgpr_write_b32 a71, 0
    s_waitcnt lgkmcnt(0)
    s_waitcnt vmcnt(10)
    v_mfma_f32_32x32x16_bf16 v[40:55], a[128:131], a[80:83], v[40:55]
    ds_read_b64_tr_b16 a[144:145], v236 offset:45056
    s_mov_b32 s51, 28672
    v_accvgpr_write_b32 a72, 0
    v_mfma_f32_32x32x16_bf16 v[56:71], a[128:131], a[84:87], v[56:71]
    ds_read_b64_tr_b16 a[146:147], v236 offset:46080
    buffer_load_dwordx4 a[112:115], v240, s[20:23], s51 offen offset:2048 sc1
    v_accvgpr_write_b32 a73, 0
    v_mfma_f32_32x32x16_bf16 v[72:87], a[132:135], a[80:83], v[72:87]
    ds_read_b64_tr_b16 a[148:149], v237 offset:45056
    v_accvgpr_write_b32 a74, 0
    v_mfma_f32_32x32x16_bf16 v[88:103], a[132:135], a[84:87], v[88:103]
    ds_read_b64_tr_b16 a[150:151], v237 offset:46080
    s_mov_b32 s51, 61440
    v_accvgpr_write_b32 a75, 0
    v_mfma_f32_32x32x16_bf16 v[104:119], a[136:139], a[80:83], v[104:119]
    ds_read_b64_tr_b16 a[152:153], v238 offset:45056
    buffer_load_dwordx4 a[116:119], v240, s[20:23], s51 offen offset:2048 sc1
    v_accvgpr_write_b32 a76, 0
    v_mfma_f32_32x32x16_bf16 v[120:135], a[136:139], a[84:87], v[120:135]
    ds_read_b64_tr_b16 a[154:155], v238 offset:46080
    ds_read_b64_tr_b16 a[156:157], v239 offset:45056
    ds_read_b64_tr_b16 a[158:159], v239 offset:46080
    v_accvgpr_write_b32 a77, 0
    v_mfma_f32_32x32x16_bf16 v[136:151], a[140:143], a[80:83], v[136:151]
    buffer_load_dwordx4 v24, s[8:11], s29 offen offset:2048 lds
    v_accvgpr_write_b32 a78, 0
    v_mfma_f32_32x32x16_bf16 v[152:167], a[140:143], a[84:87], v[152:167]
    v_accvgpr_write_b32 a79, 0
    s_waitcnt lgkmcnt(0)
    s_waitcnt vmcnt(10)
    v_mfma_f32_32x32x16_bf16 v[40:55], a[144:147], a[88:91], v[40:55]
    ds_read_b64_tr_b16 a[128:129], v236 offset:49152
    s_mov_b32 s51, 28672
    v_accvgpr_write_b32 a80, 0
    v_mfma_f32_32x32x16_bf16 v[56:71], a[144:147], a[92:95], v[56:71]
    ds_read_b64_tr_b16 a[130:131], v236 offset:50176
    buffer_load_dwordx4 a[120:123], v240, s[20:23], s51 offen offset:3072 sc1
    v_accvgpr_write_b32 a81, 0
    v_mfma_f32_32x32x16_bf16 v[72:87], a[148:151], a[88:91], v[72:87]
    ds_read_b64_tr_b16 a[132:133], v237 offset:49152
    s_mov_b32 s51, 61440
    v_accvgpr_write_b32 a82, 0
    v_mfma_f32_32x32x16_bf16 v[88:103], a[148:151], a[92:95], v[88:103]
    ds_read_b64_tr_b16 a[134:135], v237 offset:50176
    buffer_load_dwordx4 a[124:127], v240, s[20:23], s51 offen offset:3072 sc1
    v_accvgpr_write_b32 a83, 0
    v_mfma_f32_32x32x16_bf16 v[104:119], a[152:155], a[88:91], v[104:119]
    ds_read_b64_tr_b16 a[136:137], v238 offset:49152
    buffer_load_dwordx4 v25, s[8:11], s29 offen offset:3072 lds
    v_accvgpr_write_b32 a84, 0
    v_mfma_f32_32x32x16_bf16 v[120:135], a[152:155], a[92:95], v[120:135]
    ds_read_b64_tr_b16 a[138:139], v238 offset:50176
    ds_read_b64_tr_b16 a[140:141], v239 offset:49152
    ds_read_b64_tr_b16 a[142:143], v239 offset:50176
    s_add_u32 s29, s29, 16384
    v_accvgpr_write_b32 a85, 0
    v_mfma_f32_32x32x16_bf16 v[136:151], a[156:159], a[88:91], v[136:151]
    s_min_u32 s29, s29, 507904
    v_accvgpr_write_b32 a86, 0
    v_mfma_f32_32x32x16_bf16 v[152:167], a[156:159], a[92:95], v[152:167]
    v_accvgpr_write_b32 a87, 0
    s_waitcnt lgkmcnt(0)
    s_waitcnt vmcnt(10)
    v_mfma_f32_32x32x16_bf16 v[40:55], a[128:131], a[96:99], v[40:55]
    ds_read_b64_tr_b16 a[144:145], v236 offset:53248
    s_add_u32 m0, s28, 65536
    v_accvgpr_write_b32 a88, 0
    v_mfma_f32_32x32x16_bf16 v[56:71], a[128:131], a[100:103], v[56:71]
    ds_read_b64_tr_b16 a[146:147], v236 offset:54272
    v_accvgpr_write_b32 a89, 0
    v_mfma_f32_32x32x16_bf16 v[72:87], a[132:135], a[96:99], v[72:87]
    ds_read_b64_tr_b16 a[148:149], v237 offset:53248
    v_accvgpr_write_b32 a90, 0
    v_mfma_f32_32x32x16_bf16 v[88:103], a[132:135], a[100:103], v[88:103]
    ds_read_b64_tr_b16 a[150:151], v237 offset:54272
    v_accvgpr_write_b32 a91, 0
    v_mfma_f32_32x32x16_bf16 v[104:119], a[136:139], a[96:99], v[104:119]
    ds_read_b64_tr_b16 a[152:153], v238 offset:53248
    buffer_load_dwordx4 v26, s[12:15], s30 offen offset:0 lds
    v_accvgpr_write_b32 a92, 0
    v_mfma_f32_32x32x16_bf16 v[120:135], a[136:139], a[100:103], v[120:135]
    ds_read_b64_tr_b16 a[154:155], v238 offset:54272
    ds_read_b64_tr_b16 a[156:157], v239 offset:53248
    ds_read_b64_tr_b16 a[158:159], v239 offset:54272
    v_accvgpr_write_b32 a93, 0
    v_mfma_f32_32x32x16_bf16 v[136:151], a[140:143], a[96:99], v[136:151]
    v_accvgpr_write_b32 a94, 0
    v_mfma_f32_32x32x16_bf16 v[152:167], a[140:143], a[100:103], v[152:167]
    v_accvgpr_write_b32 a95, 0
    s_waitcnt lgkmcnt(0)
    s_waitcnt vmcnt(8)
    v_mfma_f32_32x32x16_bf16 v[40:55], a[144:147], a[104:107], v[40:55]
    ds_read_b64_tr_b16 a[128:129], v236 offset:57344
    buffer_load_dwordx4 v26, s[12:15], s30 offen offset:1024 lds
    v_accvgpr_write_b32 a96, 0
    v_mfma_f32_32x32x16_bf16 v[56:71], a[144:147], a[108:111], v[56:71]
    ds_read_b64_tr_b16 a[130:131], v236 offset:58368
    v_accvgpr_write_b32 a97, 0
    v_mfma_f32_32x32x16_bf16 v[72:87], a[148:151], a[104:107], v[72:87]
    ds_read_b64_tr_b16 a[132:133], v237 offset:57344
    v_accvgpr_write_b32 a98, 0
    v_mfma_f32_32x32x16_bf16 v[88:103], a[148:151], a[108:111], v[88:103]
    ds_read_b64_tr_b16 a[134:135], v237 offset:58368
    v_accvgpr_write_b32 a99, 0
    v_mfma_f32_32x32x16_bf16 v[104:119], a[152:155], a[104:107], v[104:119]
    ds_read_b64_tr_b16 a[136:137], v238 offset:57344
    v_accvgpr_write_b32 a100, 0
    v_mfma_f32_32x32x16_bf16 v[120:135], a[152:155], a[108:111], v[120:135]
    ds_read_b64_tr_b16 a[138:139], v238 offset:58368
    ds_read_b64_tr_b16 a[140:141], v239 offset:57344
    ds_read_b64_tr_b16 a[142:143], v239 offset:58368
    v_accvgpr_write_b32 a101, 0
    v_mfma_f32_32x32x16_bf16 v[136:151], a[156:159], a[104:107], v[136:151]
    v_accvgpr_write_b32 a102, 0
    v_mfma_f32_32x32x16_bf16 v[152:167], a[156:159], a[108:111], v[152:167]
    v_accvgpr_write_b32 a103, 0
    s_waitcnt lgkmcnt(0)
    s_waitcnt vmcnt(6)
    v_mfma_f32_32x32x16_bf16 v[40:55], a[128:131], a[112:115], v[40:55]
    ds_read_b64_tr_b16 a[144:145], v236 offset:61440
    buffer_load_dwordx4 v26, s[12:15], s30 offen offset:2048 lds
    v_accvgpr_write_b32 a104, 0
    v_mfma_f32_32x32x16_bf16 v[56:71], a[128:131], a[116:119], v[56:71]
    ds_read_b64_tr_b16 a[146:147], v236 offset:62464
    v_accvgpr_write_b32 a105, 0
    v_mfma_f32_32x32x16_bf16 v[72:87], a[132:135], a[112:115], v[72:87]
    ds_read_b64_tr_b16 a[148:149], v237 offset:61440
    v_accvgpr_write_b32 a106, 0
    v_mfma_f32_32x32x16_bf16 v[88:103], a[132:135], a[116:119], v[88:103]
    ds_read_b64_tr_b16 a[150:151], v237 offset:62464
    v_accvgpr_write_b32 a107, 0
    v_mfma_f32_32x32x16_bf16 v[104:119], a[136:139], a[112:115], v[104:119]
    ds_read_b64_tr_b16 a[152:153], v238 offset:61440
    v_accvgpr_write_b32 a108, 0
    v_mfma_f32_32x32x16_bf16 v[120:135], a[136:139], a[116:119], v[120:135]
    ds_read_b64_tr_b16 a[154:155], v238 offset:62464
    ds_read_b64_tr_b16 a[156:157], v239 offset:61440
    ds_read_b64_tr_b16 a[158:159], v239 offset:62464
    v_accvgpr_write_b32 a109, 0
    v_mfma_f32_32x32x16_bf16 v[136:151], a[140:143], a[112:115], v[136:151]
    v_accvgpr_write_b32 a110, 0
    v_mfma_f32_32x32x16_bf16 v[152:167], a[140:143], a[116:119], v[152:167]
    v_accvgpr_write_b32 a111, 0
    s_waitcnt lgkmcnt(0)
    s_waitcnt vmcnt(4)
    v_mfma_f32_32x32x16_bf16 v[40:55], a[144:147], a[120:123], v[40:55]
    buffer_load_dwordx4 v26, s[12:15], s30 offen offset:3072 lds
    v_accvgpr_write_b32 a112, 0
    v_mfma_f32_32x32x16_bf16 v[56:71], a[144:147], a[124:127], v[56:71]
    v_accvgpr_write_b32 a113, 0
    v_mfma_f32_32x32x16_bf16 v[72:87], a[148:151], a[120:123], v[72:87]
    s_add_u32 s30, s30, 16384
    v_accvgpr_write_b32 a114, 0
    v_mfma_f32_32x32x16_bf16 v[88:103], a[148:151], a[124:127], v[88:103]
    v_accvgpr_write_b32 a115, 0
    v_mfma_f32_32x32x16_bf16 v[104:119], a[152:155], a[120:123], v[104:119]
    v_accvgpr_write_b32 a116, 0
    v_mfma_f32_32x32x16_bf16 v[120:135], a[152:155], a[124:127], v[120:135]
    s_min_u32 s30, s30, 507904
    v_accvgpr_write_b32 a117, 0
    v_mfma_f32_32x32x16_bf16 v[136:151], a[156:159], a[120:123], v[136:151]
    v_accvgpr_write_b32 a118, 0
    v_mfma_f32_32x32x16_bf16 v[152:167], a[156:159], a[124:127], v[152:167]
    v_accvgpr_write_b32 a119, 0
    s_barrier
    v_accvgpr_write_b32 a120, 0
    v_accvgpr_write_b32 a121, 0
    v_accvgpr_write_b32 a122, 0
    v_accvgpr_write_b32 a123, 0
    v_accvgpr_write_b32 a124, 0
    v_accvgpr_write_b32 a125, 0
    v_accvgpr_write_b32 a126, 0
    v_accvgpr_write_b32 a127, 0
    s_nop 4
    v_cvt_pk_bf16_f32 v168, v40, v41
    v_cvt_pk_bf16_f32 v169, v42, v43
    v_cvt_pk_bf16_f32 v170, v44, v45
    s_add_u32 m0, s28, 81920
    v_cvt_pk_bf16_f32 v171, v46, v47
    v_cvt_pk_bf16_f32 v172, v48, v49
    buffer_load_dwordx4 v26, s[12:15], s30 offen offset:0 lds
    v_cvt_pk_bf16_f32 v173, v50, v51
    v_cvt_pk_bf16_f32 v174, v52, v53
    buffer_load_dwordx4 v26, s[12:15], s30 offen offset:1024 lds
    v_cvt_pk_bf16_f32 v175, v54, v55
    v_cvt_pk_bf16_f32 v200, v56, v57
    v_cvt_pk_bf16_f32 v201, v58, v59
    buffer_load_dwordx4 v26, s[12:15], s30 offen offset:2048 lds
    v_cvt_pk_bf16_f32 v202, v60, v61
    v_cvt_pk_bf16_f32 v203, v62, v63
    buffer_load_dwordx4 v26, s[12:15], s30 offen offset:3072 lds
    v_cvt_pk_bf16_f32 v204, v64, v65
    v_cvt_pk_bf16_f32 v205, v66, v67
    s_add_u32 s30, s30, 16384
    v_cvt_pk_bf16_f32 v206, v68, v69
    v_cvt_pk_bf16_f32 v207, v70, v71
    s_min_u32 s30, s30, 507904
    v_cvt_pk_bf16_f32 v176, v72, v73
    v_cvt_pk_bf16_f32 v177, v74, v75
    v_cvt_pk_bf16_f32 v178, v76, v77
    s_add_u32 m0, s28, 32768
    v_cvt_pk_bf16_f32 v179, v78, v79
    v_cvt_pk_bf16_f32 v180, v80, v81
    buffer_load_dwordx4 v22, s[8:11], s29 offen offset:0 lds
    v_cvt_pk_bf16_f32 v181, v82, v83
    v_cvt_pk_bf16_f32 v182, v84, v85
    buffer_load_dwordx4 v23, s[8:11], s29 offen offset:1024 lds
    v_cvt_pk_bf16_f32 v183, v86, v87
    v_cvt_pk_bf16_f32 v208, v88, v89
    v_cvt_pk_bf16_f32 v209, v90, v91
    buffer_load_dwordx4 v24, s[8:11], s29 offen offset:2048 lds
    v_cvt_pk_bf16_f32 v210, v92, v93
    v_cvt_pk_bf16_f32 v211, v94, v95
    buffer_load_dwordx4 v25, s[8:11], s29 offen offset:3072 lds
    v_cvt_pk_bf16_f32 v212, v96, v97
    v_cvt_pk_bf16_f32 v213, v98, v99
    s_add_u32 s29, s29, 16384
    v_cvt_pk_bf16_f32 v214, v100, v101
    v_cvt_pk_bf16_f32 v215, v102, v103
    s_min_u32 s29, s29, 507904
    v_cvt_pk_bf16_f32 v184, v104, v105
    v_cvt_pk_bf16_f32 v185, v106, v107
    v_cvt_pk_bf16_f32 v186, v108, v109
    s_add_u32 m0, s28, 49152
    v_cvt_pk_bf16_f32 v187, v110, v111
    v_cvt_pk_bf16_f32 v188, v112, v113
    buffer_load_dwordx4 v22, s[8:11], s29 offen offset:0 lds
    v_cvt_pk_bf16_f32 v189, v114, v115
    v_cvt_pk_bf16_f32 v190, v116, v117
    buffer_load_dwordx4 v23, s[8:11], s29 offen offset:1024 lds
    v_cvt_pk_bf16_f32 v191, v118, v119
    v_cvt_pk_bf16_f32 v216, v120, v121
    v_cvt_pk_bf16_f32 v217, v122, v123
    buffer_load_dwordx4 v24, s[8:11], s29 offen offset:2048 lds
    v_cvt_pk_bf16_f32 v218, v124, v125
    v_cvt_pk_bf16_f32 v219, v126, v127
    buffer_load_dwordx4 v25, s[8:11], s29 offen offset:3072 lds
    v_cvt_pk_bf16_f32 v220, v128, v129
    v_cvt_pk_bf16_f32 v221, v130, v131
    s_add_u32 s29, s29, 16384
    v_cvt_pk_bf16_f32 v222, v132, v133
    v_cvt_pk_bf16_f32 v223, v134, v135
    s_min_u32 s29, s29, 507904
    v_cvt_pk_bf16_f32 v192, v136, v137
    v_cvt_pk_bf16_f32 v193, v138, v139
    v_cvt_pk_bf16_f32 v194, v140, v141
    s_add_u32 m0, s28, 98304
    v_cvt_pk_bf16_f32 v195, v142, v143
    v_cvt_pk_bf16_f32 v196, v144, v145
    buffer_load_dwordx4 v26, s[12:15], s30 offen offset:0 lds
    v_cvt_pk_bf16_f32 v197, v146, v147
    v_cvt_pk_bf16_f32 v198, v148, v149
    buffer_load_dwordx4 v26, s[12:15], s30 offen offset:1024 lds
    v_cvt_pk_bf16_f32 v199, v150, v151
    v_cvt_pk_bf16_f32 v224, v152, v153
    v_cvt_pk_bf16_f32 v225, v154, v155
    buffer_load_dwordx4 v26, s[12:15], s30 offen offset:2048 lds
    v_cvt_pk_bf16_f32 v226, v156, v157
    v_cvt_pk_bf16_f32 v227, v158, v159
    buffer_load_dwordx4 v26, s[12:15], s30 offen offset:3072 lds
    v_cvt_pk_bf16_f32 v228, v160, v161
    v_cvt_pk_bf16_f32 v229, v162, v163
    s_add_u32 s30, s30, 16384
    v_cvt_pk_bf16_f32 v230, v164, v165
    v_cvt_pk_bf16_f32 v231, v166, v167
    s_min_u32 s30, s30, 507904
    s_barrier
    ds_read_b128 a[128:131], v10 offset:0
    ds_read_b128 a[132:135], v11 offset:0
    ds_read_b128 a[136:139], v12 offset:0
    ds_read_b128 a[140:143], v13 offset:0
    ds_read_b128 a[144:147], v14 offset:0
    ds_read_b128 a[148:151], v15 offset:0
    ds_read_b128 a[152:155], v16 offset:0
    ds_read_b128 a[156:159], v17 offset:0
    s_waitcnt lgkmcnt(0)
    v_mfma_f32_32x32x16_bf16 v[40:55], a[128:131], v[168:171], 0
    v_mfma_f32_32x32x16_bf16 v[40:55], a[132:135], v[172:175], v[40:55]
    v_mfma_f32_32x32x16_bf16 v[40:55], a[136:139], v[176:179], v[40:55]
    v_mfma_f32_32x32x16_bf16 v[40:55], a[140:143], v[180:183], v[40:55]
    v_mfma_f32_32x32x16_bf16 v[40:55], a[144:147], v[184:187], v[40:55]
    v_mfma_f32_32x32x16_bf16 v[40:55], a[148:151], v[188:191], v[40:55]
    v_mfma_f32_32x32x16_bf16 v[40:55], a[152:155], v[192:195], v[40:55]
    v_mfma_f32_32x32x16_bf16 v[40:55], a[156:159], v[196:199], v[40:55]
    v_mfma_f32_32x32x16_bf16 v[56:71], a[128:131], v[200:203], 0
    v_mfma_f32_32x32x16_bf16 v[56:71], a[132:135], v[204:207], v[56:71]
    v_mfma_f32_32x32x16_bf16 v[56:71], a[136:139], v[208:211], v[56:71]
    v_mfma_f32_32x32x16_bf16 v[56:71], a[140:143], v[212:215], v[56:71]
    v_mfma_f32_32x32x16_bf16 v[56:71], a[144:147], v[216:219], v[56:71]
    v_mfma_f32_32x32x16_bf16 v[56:71], a[148:151], v[220:223], v[56:71]
    v_mfma_f32_32x32x16_bf16 v[56:71], a[152:155], v[224:227], v[56:71]
    v_mfma_f32_32x32x16_bf16 v[56:71], a[156:159], v[228:231], v[56:71]
    ds_read_b128 a[128:131], v10 offset:8192
    ds_read_b128 a[132:135], v11 offset:8192
    ds_read_b128 a[136:139], v12 offset:8192
    ds_read_b128 a[140:143], v13 offset:8192
    ds_read_b128 a[144:147], v14 offset:8192
    ds_read_b128 a[148:151], v15 offset:8192
    ds_read_b128 a[152:155], v16 offset:8192
    ds_read_b128 a[156:159], v17 offset:8192
    s_nop 3
    v_max3_f32 v2, v40, v41, v42
    v_max3_f32 v2, v2, v43, v44
    v_max3_f32 v2, v2, v45, v46
    v_max3_f32 v2, v2, v47, v48
    v_max3_f32 v2, v2, v49, v50
    v_max3_f32 v2, v2, v51, v52
    v_max3_f32 v2, v2, v53, v54
    v_max_f32 v2, v2, v55
    s_nop 3
    v_max3_f32 v3, v56, v57, v58
    v_max3_f32 v3, v3, v59, v60
    v_max3_f32 v3, v3, v61, v62
    v_max3_f32 v3, v3, v63, v64
    v_max3_f32 v3, v3, v65, v66
    v_max3_f32 v3, v3, v67, v68
    v_max3_f32 v3, v3, v69, v70
    v_max_f32 v3, v3, v71
    v_mov_b32 v4, v2
    v_mov_b32 v5, v3
    s_nop 1
    v_permlane32_swap_b32 v2, v4
    v_permlane32_swap_b32 v3, v5
    s_nop 1
    v_max_f32 v2, v2, v4
    v_sub_f32 v2, 0, v2
    v_max_f32 v3, v3, v5
    v_sub_f32 v3, 0, v3
    v_mov_b32 v104, v2
    v_mov_b32 v105, v2
    v_mov_b32 v106, v2
    v_mov_b32 v107, v2
    v_mov_b32 v108, v2
    v_mov_b32 v109, v2
    v_mov_b32 v110, v2
    v_mov_b32 v111, v2
    v_mov_b32 v112, v2
    v_mov_b32 v113, v2
    v_mov_b32 v114, v2
    v_mov_b32 v115, v2
    v_mov_b32 v116, v2
    v_mov_b32 v117, v2
    v_mov_b32 v118, v2
    v_mov_b32 v119, v2
    v_add_f32 v40, v40, v2
    v_add_f32 v41, v41, v2
    v_add_f32 v42, v42, v2
    v_add_f32 v43, v43, v2
    v_add_f32 v44, v44, v2
    v_add_f32 v45, v45, v2
    v_add_f32 v46, v46, v2
    v_add_f32 v47, v47, v2
    v_add_f32 v48, v48, v2
    v_add_f32 v49, v49, v2
    v_add_f32 v50, v50, v2
    v_add_f32 v51, v51, v2
    v_add_f32 v52, v52, v2
    v_add_f32 v53, v53, v2
    v_add_f32 v54, v54, v2
    v_add_f32 v55, v55, v2
    v_mov_b32 v120, v3
    v_mov_b32 v121, v3
    v_mov_b32 v122, v3
    v_mov_b32 v123, v3
    v_mov_b32 v124, v3
    v_mov_b32 v125, v3
    v_mov_b32 v126, v3
    v_mov_b32 v127, v3
    v_mov_b32 v128, v3
    v_mov_b32 v129, v3
    v_mov_b32 v130, v3
    v_mov_b32 v131, v3
    v_mov_b32 v132, v3
    v_mov_b32 v133, v3
    v_mov_b32 v134, v3
    v_mov_b32 v135, v3
    v_add_f32 v56, v56, v3
    v_add_f32 v57, v57, v3
    v_add_f32 v58, v58, v3
    v_add_f32 v59, v59, v3
    v_add_f32 v60, v60, v3
    v_add_f32 v61, v61, v3
    v_add_f32 v62, v62, v3
    v_add_f32 v63, v63, v3
    v_add_f32 v64, v64, v3
    v_add_f32 v65, v65, v3
    v_add_f32 v66, v66, v3
    v_add_f32 v67, v67, v3
    v_add_f32 v68, v68, v3
    v_add_f32 v69, v69, v3
    v_add_f32 v70, v70, v3
    v_add_f32 v71, v71, v3
L_at_step1:
    s_waitcnt lgkmcnt(0)
    v_mfma_f32_32x32x16_bf16 v[72:87], a[128:131], v[168:171], v[104:119]
    v_exp_f32 v32, v40
    v_exp_f32 v33, v41
    v_exp_f32 v34, v42
    v_add_f32 v28, v28, v32
    v_exp_f32 v35, v43
    v_mfma_f32_32x32x16_bf16 v[72:87], a[132:135], v[172:175], v[72:87]
    v_add_f32 v29, v29, v33
    v_cvt_pk_bf16_f32 v136, v32, v33
    v_exp_f32 v32, v44
    v_add_f32 v28, v28, v34
    v_exp_f32 v33, v45
    v_mfma_f32_32x32x16_bf16 v[72:87], a[136:139], v[176:179], v[72:87]
    v_add_f32 v29, v29, v35
    v_cvt_pk_bf16_f32 v137, v34, v35
    v_exp_f32 v34, v46
    v_add_f32 v28, v28, v32
    v_exp_f32 v35, v47
    v_mfma_f32_32x32x16_bf16 v[72:87], a[140:143], v[180:183], v[72:87]
    v_add_f32 v29, v29, v33
    v_cvt_pk_bf16_f32 v138, v32, v33
    v_exp_f32 v32, v48
    v_add_f32 v28, v28, v34
    v_exp_f32 v33, v49
    v_mfma_f32_32x32x16_bf16 v[72:87], a[144:147], v[184:187], v[72:87]
    v_add_f32 v29, v29, v35
    v_cvt_pk_bf16_f32 v139, v34, v35
    v_exp_f32 v34, v50
    v_add_f32 v28, v28, v32
    v_exp_f32 v35, v51
    v_mfma_f32_32x32x16_bf16 v[72:87], a[148:151], v[188:191], v[72:87]
    v_add_f32 v29, v29, v33
    v_cvt_pk_bf16_f32 v140, v32, v33
    v_exp_f32 v32, v52
    v_add_f32 v28, v28, v34
    v_exp_f32 v33, v53
    v_mfma_f32_32x32x16_bf16 v[72:87], a[152:155], v[192:195], v[72:87]
    v_add_f32 v29, v29, v35
    v_cvt_pk_bf16_f32 v141, v34, v35
    v_exp_f32 v34, v54
    v_add_f32 v28, v28, v32
    v_exp_f32 v35, v55
    v_mfma_f32_32x32x16_bf16 v[72:87], a[156:159], v[196:199], v[72:87]
    v_add_f32 v29, v29, v33
    v_cvt_pk_bf16_f32 v142, v32, v33
    v_exp_f32 v32, v56
    v_add_f32 v28, v28, v34
    v_exp_f32 v33, v57
    v_mfma_f32_32x32x16_bf16 v[88:103], a[128:131], v[200:203], v[120:135]
    v_add_f32 v29, v29, v35
    v_cvt_pk_bf16_f32 v143, v34, v35
    v_exp_f32 v34, v58
    v_add_f32 v30, v30, v32
    v_exp_f32 v35, v59
    v_mfma_f32_32x32x16_bf16 v[88:103], a[132:135], v[204:207], v[88:103]
    v_add_f32 v31, v31, v33
    v_cvt_pk_bf16_f32 v144, v32, v33
    v_exp_f32 v32, v60
    v_add_f32 v30, v30, v34
    v_exp_f32 v33, v61
    v_mfma_f32_32x32x16_bf16 v[88:103], a[136:139], v[208:211], v[88:103]
    v_add_f32 v31, v31, v35
    v_cvt_pk_bf16_f32 v145, v34, v35
    v_exp_f32 v34, v62
    v_add_f32 v30, v30, v32
    v_exp_f32 v35, v63
    v_mfma_f32_32x32x16_bf16 v[88:103], a[140:143], v[212:215], v[88:103]
    v_add_f32 v31, v31, v33
    v_cvt_pk_bf16_f32 v146, v32, v33
    v_exp_f32 v32, v64
    v_add_f32 v30, v30, v34
    v_exp_f32 v33, v65
    v_mfma_f32_32x32x16_bf16 v[88:103], a[144:147], v[216:219], v[88:103]
    v_add_f32 v31, v31, v35
    v_cvt_pk_bf16_f32 v147, v34, v35
    v_exp_f32 v34, v66
    v_add_f32 v30, v30, v32
    v_exp_f32 v35, v67
    v_mfma_f32_32x32x16_bf16 v[88:103], a[148:151], v[220:223], v[88:103]
    v_add_f32 v31, v31, v33
    v_cvt_pk_bf16_f32 v148, v32, v33
    v_exp_f32 v32, v68
    v_add_f32 v30, v30, v34
    v_exp_f32 v33, v69
    v_mfma_f32_32x32x16_bf16 v[88:103], a[152:155], v[224:227], v[88:103]
    v_add_f32 v31, v31, v35
    v_cvt_pk_bf16_f32 v149, v34, v35
    v_exp_f32 v34, v70
    v_add_f32 v30, v30, v32
    v_exp_f32 v35, v71
    v_mfma_f32_32x32x16_bf16 v[88:103], a[156:159], v[228:231], v[88:103]
    v_add_f32 v31, v31, v33
    v_cvt_pk_bf16_f32 v150, v32, v33
    s_nop 0
    v_add_f32 v30, v30, v34
    v_add_f32 v31, v31, v35
    v_cvt_pk_bf16_f32 v151, v34, v35
    s_waitcnt vmcnt(16)
    s_barrier
    ds_read_b64_tr_b16 a[160:161], v18 offset:0
    ds_read_b64_tr_b16 a[162:163], v18 offset:2048
    ds_read_b64_tr_b16 a[168:169], v19 offset:0
    ds_read_b64_tr_b16 a[170:171], v19 offset:2048
    ds_read_b64_tr_b16 a[176:177], v20 offset:0
    ds_read_b64_tr_b16 a[178:179], v20 offset:2048
    ds_read_b64_tr_b16 a[184:185], v21 offset:0
    ds_read_b64_tr_b16 a[186:187], v21 offset:2048
    ds_read_b64_tr_b16 a[164:165], v18 offset:4096
    ds_read_b64_tr_b16 a[166:167], v18 offset:6144
    ds_read_b64_tr_b16 a[172:173], v19 offset:4096
    ds_read_b64_tr_b16 a[174:175], v19 offset:6144
    ds_read_b64_tr_b16 a[180:181], v20 offset:4096
    ds_read_b64_tr_b16 a[182:183], v20 offset:6144
    ds_read_b64_tr_b16 a[188:189], v21 offset:4096
    ds_read_b64_tr_b16 a[190:191], v21 offset:6144
    s_add_u32 m0, s28, 0
    s_nop 0
    buffer_load_dwordx4 v22, s[8:11], s29 offen offset:0 lds
    buffer_load_dwordx4 v23, s[8:11], s29 offen offset:1024 lds
    buffer_load_dwordx4 v24, s[8:11], s29 offen offset:2048 lds
    buffer_load_dwordx4 v25, s[8:11], s29 offen offset:3072 lds
    s_add_u32 s29, s29, 16384
    s_min_u32 s29, s29, 507904
    s_mov_b32 s32, 7
L_at_loop:
    s_waitcnt lgkmcnt(0)
    v_mfma_f32_32x32x16_bf16 a[0:15], a[160:163], v[136:139], a[0:15]
    ds_read_b128 a[128:131], v10 offset:16384
    v_exp_f32 v32, v72
    v_exp_f32 v33, v73
    v_mfma_f32_32x32x16_bf16 a[64:79], a[160:163], v[144:147], a[64:79]
    ds_read_b128 a[132:135], v11 offset:16384
    s_add_u32 m0, s28, 114688
    v_exp_f32 v34, v74
    v_add_f32 v28, v28, v32
    v_mfma_f32_32x32x16_bf16 a[16:31], a[168:171], v[136:139], a[16:31]
    buffer_load_dwordx4 v26, s[12:15], s30 offen offset:0 lds
    v_exp_f32 v35, v75
    v_add_f32 v29, v29, v33
    v_mfma_f32_32x32x16_bf16 a[80:95], a[168:171], v[144:147], a[80:95]
    ds_read_b128 a[136:139], v12 offset:16384
    v_cvt_pk_bf16_f32 v152, v32, v33
    v_exp_f32 v32, v76
    v_add_f32 v28, v28, v34
    v_mfma_f32_32x32x16_bf16 a[32:47], a[176:179], v[136:139], a[32:47]
    ds_read_b128 a[140:143], v13 offset:16384
    v_exp_f32 v33, v77
    v_add_f32 v29, v29, v35
    v_mfma_f32_32x32x16_bf16 a[96:111], a[176:179], v[144:147], a[96:111]
    buffer_load_dwordx4 v26, s[12:15], s30 offen offset:1024 lds
    v_cvt_pk_bf16_f32 v153, v34, v35
    v_exp_f32 v34, v78
    v_add_f32 v28, v28, v32
    v_mfma_f32_32x32x16_bf16 a[48:63], a[184:187], v[136:139], a[48:63]
    ds_read_b128 a[144:147], v14 offset:16384
    v_exp_f32 v35, v79
    v_add_f32 v29, v29, v33
    v_mfma_f32_32x32x16_bf16 a[112:127], a[184:187], v[144:147], a[112:127]
    ds_read_b128 a[148:151], v15 offset:16384
    v_cvt_pk_bf16_f32 v154, v32, v33
    v_exp_f32 v32, v80
    v_add_f32 v28, v28, v34
    v_mfma_f32_32x32x16_bf16 a[0:15], a[164:167], v[140:143], a[0:15]
    buffer_load_dwordx4 v26, s[12:15], s30 offen offset:2048 lds
    v_exp_f32 v33, v81
    v_add_f32 v29, v29, v35
    v_mfma_f32_32x32x16_bf16 a[64:79], a[164:167], v[148:151], a[64:79]
    ds_read_b128 a[152:155], v16 offset:16384
    v_cvt_pk_bf16_f32 v155, v34, v35
    v_exp_f32 v34, v82
    v_add_f32 v28, v28, v32
    v_mfma_f32_32x32x16_bf16 a[16:31], a[172:175], v[140:143], a[16:31]
    ds_read_b128 a[156:159], v17 offset:16384
    v_exp_f32 v35, v83
    v_add_f32 v29, v29, v33
    v_mfma_f32_32x32x16_bf16 a[80:95], a[172:175], v[148:151], a[80:95]
    buffer_load_dwordx4 v26, s[12:15], s30 offen offset:3072 lds
    v_cvt_pk_bf16_f32 v156, v32, v33
    v_exp_f32 v32, v84
    v_add_f32 v28, v28, v34
    v_mfma_f32_32x32x16_bf16 a[32:47], a[180:183], v[140:143], a[32:47]
    v_exp_f32 v33, v85
    v_add_f32 v29, v29, v35
    v_cvt_pk_bf16_f32 v157, v34, v35
    v_mfma_f32_32x32x16_bf16 a[96:111], a[180:183], v[148:151], a[96:111]
    s_add_u32 s30, s30, 16384
    v_exp_f32 v34, v86
    v_add_f32 v28, v28, v32
    v_exp_f32 v35, v87
    v_mfma_f32_32x32x16_bf16 a[48:63], a[188:191], v[140:143], a[48:63]
    s_min_u32 s30, s30, 507904
    v_add_f32 v29, v29, v33
    v_cvt_pk_bf16_f32 v158, v32, v33
    v_mfma_f32_32x32x16_bf16 a[112:127], a[188:191], v[148:151], a[112:127]
    v_exp_f32 v32, v88
    v_add_f32 v28, v28, v34
    v_exp_f32 v33, v89
    s_waitcnt lgkmcnt(0)
    v_mfma_f32_32x32x16_bf16 v[40:55], a[128:131], v[168:171], v[104:119]
    ds_read_b64_tr_b16 a[160:161], v18 offset:8192
    ds_read_b64_tr_b16 a[162:163], v18 offset:10240
    v_add_f32 v29, v29, v35
    v_cvt_pk_bf16_f32 v159, v34, v35
    v_mfma_f32_32x32x16_bf16 v[40:55], a[132:135], v[172:175], v[40:55]
    ds_read_b64_tr_b16 a[168:169], v19 offset:8192
    v_exp_f32 v34, v90
    v_add_f32 v30, v30, v32
    v_mfma_f32_32x32x16_bf16 v[40:55], a[136:139], v[176:179], v[40:55]
    ds_read_b64_tr_b16 a[170:171], v19 offset:10240
    v_exp_f32 v35, v91
    v_add_f32 v31, v31, v33
    v_cvt_pk_bf16_f32 v160, v32, v33
    v_mfma_f32_32x32x16_bf16 v[40:55], a[140:143], v[180:183], v[40:55]
    ds_read_b64_tr_b16 a[176:177], v20 offset:8192
    v_exp_f32 v32, v92
    v_add_f32 v30, v30, v34
    v_mfma_f32_32x32x16_bf16 v[40:55], a[144:147], v[184:187], v[40:55]
    ds_read_b64_tr_b16 a[178:179], v20 offset:10240
    ds_read_b64_tr_b16 a[184:185], v21 offset:8192
    v_exp_f32 v33, v93
    v_add_f32 v31, v31, v35
    v_mfma_f32_32x32x16_bf16 v[40:55], a[148:151], v[188:191], v[40:55]
    ds_read_b64_tr_b16 a[186:187], v21 offset:10240
    v_cvt_pk_bf16_f32 v161, v34, v35
    v_exp_f32 v34, v94
    v_mfma_f32_32x32x16_bf16 v[40:55], a[152:155], v[192:195], v[40:55]
    ds_read_b64_tr_b16 a[164:165], v18 offset:12288
    v_add_f32 v30, v30, v32
    v_exp_f32 v35, v95
    v_add_f32 v31, v31, v33
    v_mfma_f32_32x32x16_bf16 v[40:55], a[156:159], v[196:199], v[40:55]
    ds_read_b64_tr_b16 a[166:167], v18 offset:14336
    v_cvt_pk_bf16_f32 v162, v32, v33
    v_exp_f32 v32, v96
    v_mfma_f32_32x32x16_bf16 v[56:71], a[128:131], v[200:203], v[120:135]
    ds_read_b64_tr_b16 a[172:173], v19 offset:12288
    ds_read_b64_tr_b16 a[174:175], v19 offset:14336
    v_add_f32 v30, v30, v34
    v_exp_f32 v33, v97
    v_mfma_f32_32x32x16_bf16 v[56:71], a[132:135], v[204:207], v[56:71]
    ds_read_b64_tr_b16 a[180:181], v20 offset:12288
    v_add_f32 v31, v31, v35
    v_cvt_pk_bf16_f32 v163, v34, v35
    v_exp_f32 v34, v98
    v_mfma_f32_32x32x16_bf16 v[56:71], a[136:139], v[208:211], v[56:71]
    ds_read_b64_tr_b16 a[182:183], v20 offset:14336
    v_add_f32 v30, v30, v32
    v_exp_f32 v35, v99
    v_mfma_f32_32x32x16_bf16 v[56:71], a[140:143], v[212:215], v[56:71]
    ds_read_b64_tr_b16 a[188:189], v21 offset:12288
    v_add_f32 v31, v31, v33
    v_cvt_pk_bf16_f32 v164, v32, v33
    v_exp_f32 v32, v100
    v_mfma_f32_32x32x16_bf16 v[56:71], a[144:147], v[216:219], v[56:71]
    ds_read_b64_tr_b16 a[190:191], v21 offset:14336
    v_add_f32 v30, v30, v34
    v_exp_f32 v33, v101
    v_mfma_f32_32x32x16_bf16 v[56:71], a[148:151], v[220:223], v[56:71]
    v_add_f32 v31, v31, v35
    v_cvt_pk_bf16_f32 v165, v34, v35
    v_exp_f32 v34, v102
    v_mfma_f32_32x32x16_bf16 v[56:71], a[152:155], v[224:227], v[56:71]
    v_add_f32 v30, v30, v32
    v_exp_f32 v35, v103
    v_add_f32 v31, v31, v33
    v_cvt_pk_bf16_f32 v166, v32, v33
    v_mfma_f32_32x32x16_bf16 v[56:71], a[156:159], v[228:231], v[56:71]
    s_nop 0
    v_add_f32 v30, v30, v34
    v_add_f32 v31, v31, v35
    v_cvt_pk_bf16_f32 v167, v34, v35
    s_waitcnt lgkmcnt(0)
    v_mfma_f32_32x32x16_bf16 a[0:15], a[160:163], v[152:155], a[0:15]
    ds_read_b128 a[128:131], v10 offset:24576
    v_exp_f32 v32, v40
    v_exp_f32 v33, v41
    v_mfma_f32_32x32x16_bf16 a[64:79], a[160:163], v[160:163], a[64:79]
    ds_read_b128 a[132:135], v11 offset:24576
    v_exp_f32 v34, v42
    v_add_f32 v28, v28, v32
    v_exp_f32 v35, v43
    v_mfma_f32_32x32x16_bf16 a[16:31], a[168:171], v[152:155], a[16:31]
    v_add_f32 v29, v29, v33
    v_cvt_pk_bf16_f32 v136, v32, v33
    v_exp_f32 v32, v44
    v_mfma_f32_32x32x16_bf16 a[80:95], a[168:171], v[160:163], a[80:95]
    ds_read_b128 a[136:139], v12 offset:24576
    v_add_f32 v28, v28, v34
    v_exp_f32 v33, v45
    v_mfma_f32_32x32x16_bf16 a[32:47], a[176:179], v[152:155], a[32:47]
    ds_read_b128 a[140:143], v13 offset:24576
    v_add_f32 v29, v29, v35
    v_cvt_pk_bf16_f32 v137, v34, v35
    v_exp_f32 v34, v46
    v_mfma_f32_32x32x16_bf16 a[96:111], a[176:179], v[160:163], a[96:111]
    v_add_f32 v28, v28, v32
    v_exp_f32 v35, v47
    v_add_f32 v29, v29, v33
    v_mfma_f32_32x32x16_bf16 a[48:63], a[184:187], v[152:155], a[48:63]
    ds_read_b128 a[144:147], v14 offset:24576
    v_cvt_pk_bf16_f32 v138, v32, v33
    v_exp_f32 v32, v48
    v_add_f32 v28, v28, v34
    v_mfma_f32_32x32x16_bf16 a[112:127], a[184:187], v[160:163], a[112:127]
    ds_read_b128 a[148:151], v15 offset:24576
    v_exp_f32 v33, v49
    v_add_f32 v29, v29, v35
    v_mfma_f32_32x32x16_bf16 a[0:15], a[164:167], v[156:159], a[0:15]
    v_cvt_pk_bf16_f32 v139, v34, v35
    v_exp_f32 v34, v50
    v_add_f32 v28, v28, v32
    v_exp_f32 v35, v51
    v_mfma_f32_32x32x16_bf16 a[64:79], a[164:167], v[164:167], a[64:79]
    ds_read_b128 a[152:155], v16 offset:24576
    v_add_f32 v29, v29, v33
    v_cvt_pk_bf16_f32 v140, v32, v33
    v_mfma_f32_32x32x16_bf16 a[16:31], a[172:175], v[156:159], a[16:31]
    ds_read_b128 a[156:159], v17 offset:24576
    v_exp_f32 v32, v52
    v_add_f32 v28, v28, v34
    v_exp_f32 v33, v53
    v_mfma_f32_32x32x16_bf16 a[80:95], a[172:175], v[164:167], a[80:95]
    v_add_f32 v29, v29, v35
    v_cvt_pk_bf16_f32 v141, v34, v35
    v_exp_f32 v34, v54
    v_mfma_f32_32x32x16_bf16 a[32:47], a[180:183], v[156:159], a[32:47]
    v_add_f32 v28, v28, v32
    v_exp_f32 v35, v55
    v_add_f32 v29, v29, v33
    v_mfma_f32_32x32x16_bf16 a[96:111], a[180:183], v[164:167], a[96:111]
    v_cvt_pk_bf16_f32 v142, v32, v33
    v_exp_f32 v32, v56
    v_add_f32 v28, v28, v34
    v_exp_f32 v33, v57
    v_mfma_f32_32x32x16_bf16 a[48:63], a[188:191], v[156:159], a[48:63]
    v_add_f32 v29, v29, v35
    v_cvt_pk_bf16_f32 v143, v34, v35
    v_exp_f32 v34, v58
    v_mfma_f32_32x32x16_bf16 a[112:127], a[188:191], v[164:167], a[112:127]
    v_add_f32 v30, v30, v32
    s_waitcnt lgkmcnt(0)
    s_waitcnt vmcnt(16)
    s_barrier
    v_mfma_f32_32x32x16_bf16 v[72:87], a[128:131], v[168:171], v[104:119]
    ds_read_b64_tr_b16 a[160:161], v18 offset:16384
    ds_read_b64_tr_b16 a[162:163], v18 offset:18432
    v_exp_f32 v35, v59
    v_add_f32 v31, v31, v33
    v_mfma_f32_32x32x16_bf16 v[72:87], a[132:135], v[172:175], v[72:87]
    ds_read_b64_tr_b16 a[168:169], v19 offset:16384
    s_add_u32 m0, s28, 16384
    v_cvt_pk_bf16_f32 v144, v32, v33
    v_exp_f32 v32, v60
    v_mfma_f32_32x32x16_bf16 v[72:87], a[136:139], v[176:179], v[72:87]
    ds_read_b64_tr_b16 a[170:171], v19 offset:18432
    buffer_load_dwordx4 v22, s[8:11], s29 offen offset:0 lds
    v_add_f32 v30, v30, v34
    v_exp_f32 v33, v61
    v_mfma_f32_32x32x16_bf16 v[72:87], a[140:143], v[180:183], v[72:87]
    ds_read_b64_tr_b16 a[176:177], v20 offset:16384
    v_add_f32 v31, v31, v35
    v_cvt_pk_bf16_f32 v145, v34, v35
    v_mfma_f32_32x32x16_bf16 v[72:87], a[144:147], v[184:187], v[72:87]
    ds_read_b64_tr_b16 a[178:179], v20 offset:18432
    ds_read_b64_tr_b16 a[184:185], v21 offset:16384
    v_exp_f32 v34, v62
    v_add_f32 v30, v30, v32
    v_mfma_f32_32x32x16_bf16 v[72:87], a[148:151], v[188:191], v[72:87]
    ds_read_b64_tr_b16 a[186:187], v21 offset:18432
    buffer_load_dwordx4 v23, s[8:11], s29 offen offset:1024 lds
    v_exp_f32 v35, v63
    v_add_f32 v31, v31, v33
    v_mfma_f32_32x32x16_bf16 v[72:87], a[152:155], v[192:195], v[72:87]
    ds_read_b64_tr_b16 a[164:165], v18 offset:20480
    v_cvt_pk_bf16_f32 v146, v32, v33
    v_exp_f32 v32, v64
    v_mfma_f32_32x32x16_bf16 v[72:87], a[156:159], v[196:199], v[72:87]
    ds_read_b64_tr_b16 a[166:167], v18 offset:22528
    v_add_f32 v30, v30, v34
    v_exp_f32 v33, v65
    v_add_f32 v31, v31, v35
    v_mfma_f32_32x32x16_bf16 v[88:103], a[128:131], v[200:203], v[120:135]
    ds_read_b64_tr_b16 a[172:173], v19 offset:20480
    ds_read_b64_tr_b16 a[174:175], v19 offset:22528
    buffer_load_dwordx4 v24, s[8:11], s29 offen offset:2048 lds
    v_cvt_pk_bf16_f32 v147, v34, v35
    v_mfma_f32_32x32x16_bf16 v[88:103], a[132:135], v[204:207], v[88:103]
    ds_read_b64_tr_b16 a[180:181], v20 offset:20480
    v_exp_f32 v34, v66
    v_add_f32 v30, v30, v32
    v_exp_f32 v35, v67
    v_mfma_f32_32x32x16_bf16 v[88:103], a[136:139], v[208:211], v[88:103]
    ds_read_b64_tr_b16 a[182:183], v20 offset:22528
    v_add_f32 v31, v31, v33
    v_cvt_pk_bf16_f32 v148, v32, v33
    v_exp_f32 v32, v68
    v_mfma_f32_32x32x16_bf16 v[88:103], a[140:143], v[212:215], v[88:103]
    ds_read_b64_tr_b16 a[188:189], v21 offset:20480
    buffer_load_dwordx4 v25, s[8:11], s29 offen offset:3072 lds
    v_add_f32 v30, v30, v34
    v_mfma_f32_32x32x16_bf16 v[88:103], a[144:147], v[216:219], v[88:103]
    ds_read_b64_tr_b16 a[190:191], v21 offset:22528
    v_exp_f32 v33, v69
    v_add_f32 v31, v31, v35
    v_cvt_pk_bf16_f32 v149, v34, v35
    v_mfma_f32_32x32x16_bf16 v[88:103], a[148:151], v[220:223], v[88:103]
    s_add_u32 s29, s29, 16384
    v_exp_f32 v34, v70
    v_add_f32 v30, v30, v32
    v_mfma_f32_32x32x16_bf16 v[88:103], a[152:155], v[224:227], v[88:103]
    s_min_u32 s29, s29, 507904
    v_exp_f32 v35, v71
    v_add_f32 v31, v31, v33
    v_cvt_pk_bf16_f32 v150, v32, v33
    v_mfma_f32_32x32x16_bf16 v[88:103], a[156:159], v[228:231], v[88:103]
    s_nop 0
    v_add_f32 v30, v30, v34
    v_add_f32 v31, v31, v35
    v_cvt_pk_bf16_f32 v151, v34, v35
    s_waitcnt lgkmcnt(0)
    v_mfma_f32_32x32x16_bf16 a[0:15], a[160:163], v[136:139], a[0:15]
    ds_read_b128 a[128:131], v10 offset:32768
    v_exp_f32 v32, v72
    v_exp_f32 v33, v73
    v_mfma_f32_32x32x16_bf16 a[64:79], a[160:163], v[144:147], a[64:79]
    ds_read_b128 a[132:135], v11 offset:32768
    s_add_u32 m0, s28, 65536
    v_exp_f32 v34, v74
    v_add_f32 v28, v28, v32
    v_mfma_f32_32x32x16_bf16 a[16:31], a[168:171], v[136:139], a[16:31]
    buffer_load_dwordx4 v26, s[12:15], s30 offen offset:0 lds
    v_exp_f32 v35, v75
    v_add_f32 v29, v29, v33
    v_mfma_f32_32x32x16_bf16 a[80:95], a[168:171], v[144:147], a[80:95]
    ds_read_b128 a[136:139], v12 offset:32768
    v_cvt_pk_bf16_f32 v152, v32, v33
    v_exp_f32 v32, v76
    v_add_f32 v28, v28, v34
    v_mfma_f32_32x32x16_bf16 a[32:47], a[176:179], v[136:139], a[32:47]
    ds_read_b128 a[140:143], v13 offset:32768
    v_exp_f32 v33, v77
    v_add_f32 v29, v29, v35
    v_mfma_f32_32x32x16_bf16 a[96:111], a[176:179], v[144:147], a[96:111]
    buffer_load_dwordx4 v26, s[12:15], s30 offen offset:1024 lds
    v_cvt_pk_bf16_f32 v153, v34, v35
    v_exp_f32 v34, v78
    v_add_f32 v28, v28, v32
    v_mfma_f32_32x32x16_bf16 a[48:63], a[184:187], v[136:139], a[48:63]
    ds_read_b128 a[144:147], v14 offset:32768
    v_exp_f32 v35, v79
    v_add_f32 v29, v29, v33
    v_mfma_f32_32x32x16_bf16 a[112:127], a[184:187], v[144:147], a[112:127]
    ds_read_b128 a[148:151], v15 offset:32768
    v_cvt_pk_bf16_f32 v154, v32, v33
    v_exp_f32 v32, v80
    v_add_f32 v28, v28, v34
    v_mfma_f32_32x32x16_bf16 a[0:15], a[164:167], v[140:143], a[0:15]
    buffer_load_dwordx4 v26, s[12:15], s30 offen offset:2048 lds
    v_exp_f32 v33, v81
    v_add_f32 v29, v29, v35
    v_mfma_f32_32x32x16_bf16 a[64:79], a[164:167], v[148:151], a[64:79]
    ds_read_b128 a[152:155], v16 offset:32768
    v_cvt_pk_bf16_f32 v155, v34, v35
    v_exp_f32 v34, v82
    v_add_f32 v28, v28, v32
    v_mfma_f32_32x32x16_bf16 a[16:31], a[172:175], v[140:143], a[16:31]
    ds_read_b128 a[156:159], v17 offset:32768
    v_exp_f32 v35, v83
    v_add_f32 v29, v29, v33
    v_mfma_f32_32x32x16_bf16 a[80:95], a[172:175], v[148:151], a[80:95]
    buffer_load_dwordx4 v26, s[12:15], s30 offen offset:3072 lds
    v_cvt_pk_bf16_f32 v156, v32, v33
    v_exp_f32 v32, v84
    v_add_f32 v28, v28, v34
    v_mfma_f32_32x32x16_bf16 a[32:47], a[180:183], v[140:143], a[32:47]
    v_exp_f32 v33, v85
    v_add_f32 v29, v29, v35
    v_cvt_pk_bf16_f32 v157, v34, v35
    v_mfma_f32_32x32x16_bf16 a[96:111], a[180:183], v[148:151], a[96:111]
    s_add_u32 s30, s30, 16384
    v_exp_f32 v34, v86
    v_add_f32 v28, v28, v32
    v_exp_f32 v35, v87
    v_mfma_f32_32x32x16_bf16 a[48:63], a[188:191], v[140:143], a[48:63]
    s_min_u32 s30, s30, 507904
    v_add_f32 v29, v29, v33
    v_cvt_pk_bf16_f32 v158, v32, v33
    v_mfma_f32_32x32x16_bf16 a[112:127], a[188:191], v[148:151], a[112:127]
    v_exp_f32 v32, v88
    v_add_f32 v28, v28, v34
    v_exp_f32 v33, v89
    s_waitcnt lgkmcnt(0)
    v_mfma_f32_32x32x16_bf16 v[40:55], a[128:131], v[168:171], v[104:119]
    ds_read_b64_tr_b16 a[160:161], v18 offset:24576
    ds_read_b64_tr_b16 a[162:163], v18 offset:26624
    v_add_f32 v29, v29, v35
    v_cvt_pk_bf16_f32 v159, v34, v35
    v_mfma_f32_32x32x16_bf16 v[40:55], a[132:135], v[172:175], v[40:55]
    ds_read_b64_tr_b16 a[168:169], v19 offset:24576
    v_exp_f32 v34, v90
    v_add_f32 v30, v30, v32
    v_mfma_f32_32x32x16_bf16 v[40:55], a[136:139], v[176:179], v[40:55]
    ds_read_b64_tr_b16 a[170:171], v19 offset:26624
    v_exp_f32 v35, v91
    v_add_f32 v31, v31, v33
    v_cvt_pk_bf16_f32 v160, v32, v33
    v_mfma_f32_32x32x16_bf16 v[40:55], a[140:143], v[180:183], v[40:55]
    ds_read_b64_tr_b16 a[176:177], v20 offset:24576
    v_exp_f32 v32, v92
    v_add_f32 v30, v30, v34
    v_mfma_f32_32x32x16_bf16 v[40:55], a[144:147], v[184:187], v[40:55]
    ds_read_b64_tr_b16 a[178:179], v20 offset:26624
    ds_read_b64_tr_b16 a[184:185], v21 offset:24576
    v_exp_f32 v33, v93
    v_add_f32 v31, v31, v35
    v_mfma_f32_32x32x16_bf16 v[40:55], a[148:151], v[188:191], v[40:55]
    ds_read_b64_tr_b16 a[186:187], v21 offset:26624
    v_cvt_pk_bf16_f32 v161, v34, v35
    v_exp_f32 v34, v94
    v_mfma_f32_32x32x16_bf16 v[40:55], a[152:155], v[192:195], v[40:55]
    ds_read_b64_tr_b16 a[164:165], v18 offset:28672
    v_add_f32 v30, v30, v32
    v_exp_f32 v35, v95
    v_add_f32 v31, v31, v33
    v_mfma_f32_32x32x16_bf16 v[40:55], a[156:159], v[196:199], v[40:55]
    ds_read_b64_tr_b16 a[166:167], v18 offset:30720
    v_cvt_pk_bf16_f32 v162, v32, v33
    v_exp_f32 v32, v96
    v_mfma_f32_32x32x16_bf16 v[56:71], a[128:131], v[200:203], v[120:135]
    ds_read_b64_tr_b16 a[172:173], v19 offset:28672
    ds_read_b64_tr_b16 a[174:175], v19 offset:30720
    v_add_f32 v30, v30, v34
    v_exp_f32 v33, v97
    v_mfma_f32_32x32x16_bf16 v[56:71], a[132:135], v[204:207], v[56:71]
    ds_read_b64_tr_b16 a[180:181], v20 offset:28672
    v_add_f32 v31, v31, v35
    v_cvt_pk_bf16_f32 v163, v34, v35
    v_exp_f32 v34, v98
    v_mfma_f32_32x32x16_bf16 v[56:71], a[136:139], v[208:211], v[56:71]
    ds_read_b64_tr_b16 a[182:183], v20 offset:30720
    v_add_f32 v30, v30, v32
    v_exp_f32 v35, v99
    v_mfma_f32_32x32x16_bf16 v[56:71], a[140:143], v[212:215], v[56:71]
    ds_read_b64_tr_b16 a[188:189], v21 offset:28672
    v_add_f32 v31, v31, v33
    v_cvt_pk_bf16_f32 v164, v32, v33
    v_exp_f32 v32, v100
    v_mfma_f32_32x32x16_bf16 v[56:71], a[144:147], v[216:219], v[56:71]
    ds_read_b64_tr_b16 a[190:191], v21 offset:30720
    v_add_f32 v30, v30, v34
    v_exp_f32 v33, v101
    v_mfma_f32_32x32x16_bf16 v[56:71], a[148:151], v[220:223], v[56:71]
    v_add_f32 v31, v31, v35
    v_cvt_pk_bf16_f32 v165, v34, v35
    v_exp_f32 v34, v102
    v_mfma_f32_32x32x16_bf16 v[56:71], a[152:155], v[224:227], v[56:71]
    v_add_f32 v30, v30, v32
    v_exp_f32 v35, v103
    v_add_f32 v31, v31, v33
    v_cvt_pk_bf16_f32 v166, v32, v33
    v_mfma_f32_32x32x16_bf16 v[56:71], a[156:159], v[228:231], v[56:71]
    s_nop 0
    v_add_f32 v30, v30, v34
    v_add_f32 v31, v31, v35
    v_cvt_pk_bf16_f32 v167, v34, v35
    s_waitcnt lgkmcnt(0)
    v_mfma_f32_32x32x16_bf16 a[0:15], a[160:163], v[152:155], a[0:15]
    ds_read_b128 a[128:131], v10 offset:40960
    v_exp_f32 v32, v40
    v_exp_f32 v33, v41
    v_mfma_f32_32x32x16_bf16 a[64:79], a[160:163], v[160:163], a[64:79]
    ds_read_b128 a[132:135], v11 offset:40960
    v_exp_f32 v34, v42
    v_add_f32 v28, v28, v32
    v_exp_f32 v35, v43
    v_mfma_f32_32x32x16_bf16 a[16:31], a[168:171], v[152:155], a[16:31]
    v_add_f32 v29, v29, v33
    v_cvt_pk_bf16_f32 v136, v32, v33
    v_exp_f32 v32, v44
    v_mfma_f32_32x32x16_bf16 a[80:95], a[168:171], v[160:163], a[80:95]
    ds_read_b128 a[136:139], v12 offset:40960
    v_add_f32 v28, v28, v34
    v_exp_f32 v33, v45
    v_mfma_f32_32x32x16_bf16 a[32:47], a[176:179], v[152:155], a[32:47]
    ds_read_b128 a[140:143], v13 offset:40960
    v_add_f32 v29, v29, v35
    v_cvt_pk_bf16_f32 v137, v34, v35
    v_exp_f32 v34, v46
    v_mfma_f32_32x32x16_bf16 a[96:111], a[176:179], v[160:163], a[96:111]
    v_add_f32 v28, v28, v32
    v_exp_f32 v35, v47
    v_add_f32 v29, v29, v33
    v_mfma_f32_32x32x16_bf16 a[48:63], a[184:187], v[152:155], a[48:63]
    ds_read_b128 a[144:147], v14 offset:40960
    v_cvt_pk_bf16_f32 v138, v32, v33
    v_exp_f32 v32, v48
    v_add_f32 v28, v28, v34
    v_mfma_f32_32x32x16_bf16 a[112:127], a[184:187], v[160:163], a[112:127]
    ds_read_b128 a[148:151], v15 offset:40960
    v_exp_f32 v33, v49
    v_add_f32 v29, v29, v35
    v_mfma_f32_32x32x16_bf16 a[0:15], a[164:167], v[156:159], a[0:15]
    v_cvt_pk_bf16_f32 v139, v34, v35
    v_exp_f32 v34, v50
    v_add_f32 v28, v28, v32
    v_exp_f32 v35, v51
    v_mfma_f32_32x32x16_bf16 a[64:79], a[164:167], v[164:167], a[64:79]
    ds_read_b128 a[152:155], v16 offset:40960
    v_add_f32 v29, v29, v33
    v_cvt_pk_bf16_f32 v140, v32, v33
    v_mfma_f32_32x32x16_bf16 a[16:31], a[172:175], v[156:159], a[16:31]
    ds_read_b128 a[156:159], v17 offset:40960
    v_exp_f32 v32, v52
    v_add_f32 v28, v28, v34
    v_exp_f32 v33, v53
    v_mfma_f32_32x32x16_bf16 a[80:95], a[172:175], v[164:167], a[80:95]
    v_add_f32 v29, v29, v35
    v_cvt_pk_bf16_f32 v141, v34, v35
    v_exp_f32 v34, v54
    v_mfma_f32_32x32x16_bf16 a[32:47], a[180:183], v[156:159], a[32:47]
    v_add_f32 v28, v28, v32
    v_exp_f32 v35, v55
    v_add_f32 v29, v29, v33
    v_mfma_f32_32x32x16_bf16 a[96:111], a[180:183], v[164:167], a[96:111]
    v_cvt_pk_bf16_f32 v142, v32, v33
    v_exp_f32 v32, v56
    v_add_f32 v28, v28, v34
    v_exp_f32 v33, v57
    v_mfma_f32_32x32x16_bf16 a[48:63], a[188:191], v[156:159], a[48:63]
    v_add_f32 v29, v29, v35
    v_cvt_pk_bf16_f32 v143, v34, v35
    v_exp_f32 v34, v58
    v_mfma_f32_32x32x16_bf16 a[112:127], a[188:191], v[164:167], a[112:127]
    v_add_f32 v30, v30, v32
    s_waitcnt lgkmcnt(0)
    s_waitcnt vmcnt(16)
    s_barrier
    v_mfma_f32_32x32x16_bf16 v[72:87], a[128:131], v[168:171], v[104:119]
    ds_read_b64_tr_b16 a[160:161], v18 offset:32768
    ds_read_b64_tr_b16 a[162:163], v18 offset:34816
    v_exp_f32 v35, v59
    v_add_f32 v31, v31, v33
    v_mfma_f32_32x32x16_bf16 v[72:87], a[132:135], v[172:175], v[72:87]
    ds_read_b64_tr_b16 a[168:169], v19 offset:32768
    s_add_u32 m0, s28, 32768
    v_cvt_pk_bf16_f32 v144, v32, v33
    v_exp_f32 v32, v60
    v_mfma_f32_32x32x16_bf16 v[72:87], a[136:139], v[176:179], v[72:87]
    ds_read_b64_tr_b16 a[170:171], v19 offset:34816
    buffer_load_dwordx4 v22, s[8:11], s29 offen offset:0 lds
    v_add_f32 v30, v30, v34
    v_exp_f32 v33, v61
    v_mfma_f32_32x32x16_bf16 v[72:87], a[140:143], v[180:183], v[72:87]
    ds_read_b64_tr_b16 a[176:177], v20 offset:32768
    v_add_f32 v31, v31, v35
    v_cvt_pk_bf16_f32 v145, v34, v35
    v_mfma_f32_32x32x16_bf16 v[72:87], a[144:147], v[184:187], v[72:87]
    ds_read_b64_tr_b16 a[178:179], v20 offset:34816
    ds_read_b64_tr_b16 a[184:185], v21 offset:32768
    v_exp_f32 v34, v62
    v_add_f32 v30, v30, v32
    v_mfma_f32_32x32x16_bf16 v[72:87], a[148:151], v[188:191], v[72:87]
    ds_read_b64_tr_b16 a[186:187], v21 offset:34816
    buffer_load_dwordx4 v23, s[8:11], s29 offen offset:1024 lds
    v_exp_f32 v35, v63
    v_add_f32 v31, v31, v33
    v_mfma_f32_32x32x16_bf16 v[72:87], a[152:155], v[192:195], v[72:87]
    ds_read_b64_tr_b16 a[164:165], v18 offset:36864
    v_cvt_pk_bf16_f32 v146, v32, v33
    v_exp_f32 v32, v64
    v_mfma_f32_32x32x16_bf16 v[72:87], a[156:159], v[196:199], v[72:87]
    ds_read_b64_tr_b16 a[166:167], v18 offset:38912
    v_add_f32 v30, v30, v34
    v_exp_f32 v33, v65
    v_add_f32 v31, v31, v35
    v_mfma_f32_32x32x16_bf16 v[88:103], a[128:131], v[200:203], v[120:135]
    ds_read_b64_tr_b16 a[172:173], v19 offset:36864
    ds_read_b64_tr_b16 a[174:175], v19 offset:38912
    buffer_load_dwordx4 v24, s[8:11], s29 offen offset:2048 lds
    v_cvt_pk_bf16_f32 v147, v34, v35
    v_mfma_f32_32x32x16_bf16 v[88:103], a[132:135], v[204:207], v[88:103]
    ds_read_b64_tr_b16 a[180:181], v20 offset:36864
    v_exp_f32 v34, v66
    v_add_f32 v30, v30, v32
    v_exp_f32 v35, v67
    v_mfma_f32_32x32x16_bf16 v[88:103], a[136:139], v[208:211], v[88:103]
    ds_read_b64_tr_b16 a[182:183], v20 offset:38912
    v_add_f32 v31, v31, v33
    v_cvt_pk_bf16_f32 v148, v32, v33
    v_exp_f32 v32, v68
    v_mfma_f32_32x32x16_bf16 v[88:103], a[140:143], v[212:215], v[88:103]
    ds_read_b64_tr_b16 a[188:189], v21 offset:36864
    buffer_load_dwordx4 v25, s[8:11], s29 offen offset:3072 lds
    v_add_f32 v30, v30, v34
    v_mfma_f32_32x32x16_bf16 v[88:103], a[144:147], v[216:219], v[88:103]
    ds_read_b64_tr_b16 a[190:191], v21 offset:38912
    v_exp_f32 v33, v69
    v_add_f32 v31, v31, v35
    v_cvt_pk_bf16_f32 v149, v34, v35
    v_mfma_f32_32x32x16_bf16 v[88:103], a[148:151], v[220:223], v[88:103]
    s_add_u32 s29, s29, 16384
    v_exp_f32 v34, v70
    v_add_f32 v30, v30, v32
    v_mfma_f32_32x32x16_bf16 v[88:103], a[152:155], v[224:227], v[88:103]
    s_min_u32 s29, s29, 507904
    v_exp_f32 v35, v71
    v_add_f32 v31, v31, v33
    v_cvt_pk_bf16_f32 v150, v32, v33
    v_mfma_f32_32x32x16_bf16 v[88:103], a[156:159], v[228:231], v[88:103]
    s_nop 0
    v_add_f32 v30, v30, v34
    v_add_f32 v31, v31, v35
    v_cvt_pk_bf16_f32 v151, v34, v35
    s_waitcnt lgkmcnt(0)
    v_mfma_f32_32x32x16_bf16 a[0:15], a[160:163], v[136:139], a[0:15]
    ds_read_b128 a[128:131], v10 offset:49152
    v_exp_f32 v32, v72
    v_exp_f32 v33, v73
    v_mfma_f32_32x32x16_bf16 a[64:79], a[160:163], v[144:147], a[64:79]
    ds_read_b128 a[132:135], v11 offset:49152
    s_add_u32 m0, s28, 81920
    v_exp_f32 v34, v74
    v_add_f32 v28, v28, v32
    v_mfma_f32_32x32x16_bf16 a[16:31], a[168:171], v[136:139], a[16:31]
    buffer_load_dwordx4 v26, s[12:15], s30 offen offset:0 lds
    v_exp_f32 v35, v75
    v_add_f32 v29, v29, v33
    v_mfma_f32_32x32x16_bf16 a[80:95], a[168:171], v[144:147], a[80:95]
    ds_read_b128 a[136:139], v12 offset:49152
    v_cvt_pk_bf16_f32 v152, v32, v33
    v_exp_f32 v32, v76
    v_add_f32 v28, v28, v34
    v_mfma_f32_32x32x16_bf16 a[32:47], a[176:179], v[136:139], a[32:47]
    ds_read_b128 a[140:143], v13 offset:49152
    v_exp_f32 v33, v77
    v_add_f32 v29, v29, v35
    v_mfma_f32_32x32x16_bf16 a[96:111], a[176:179], v[144:147], a[96:111]
    buffer_load_dwordx4 v26, s[12:15], s30 offen offset:1024 lds
    v_cvt_pk_bf16_f32 v153, v34, v35
    v_exp_f32 v34, v78
    v_add_f32 v28, v28, v32
    v_mfma_f32_32x32x16_bf16 a[48:63], a[184:187], v[136:139], a[48:63]
    ds_read_b128 a[144:147], v14 offset:49152
    v_exp_f32 v35, v79
    v_add_f32 v29, v29, v33
    v_mfma_f32_32x32x16_bf16 a[112:127], a[184:187], v[144:147], a[112:127]
    ds_read_b128 a[148:151], v15 offset:49152
    v_cvt_pk_bf16_f32 v154, v32, v33
    v_exp_f32 v32, v80
    v_add_f32 v28, v28, v34
    v_mfma_f32_32x32x16_bf16 a[0:15], a[164:167], v[140:143], a[0:15]
    buffer_load_dwordx4 v26, s[12:15], s30 offen offset:2048 lds
    v_exp_f32 v33, v81
    v_add_f32 v29, v29, v35
    v_mfma_f32_32x32x16_bf16 a[64:79], a[164:167], v[148:151], a[64:79]
    ds_read_b128 a[152:155], v16 offset:49152
    v_cvt_pk_bf16_f32 v155, v34, v35
    v_exp_f32 v34, v82
    v_add_f32 v28, v28, v32
    v_mfma_f32_32x32x16_bf16 a[16:31], a[172:175], v[140:143], a[16:31]
    ds_read_b128 a[156:159], v17 offset:49152
    v_exp_f32 v35, v83
    v_add_f32 v29, v29, v33
    v_mfma_f32_32x32x16_bf16 a[80:95], a[172:175], v[148:151], a[80:95]
    buffer_load_dwordx4 v26, s[12:15], s30 offen offset:3072 lds
    v_cvt_pk_bf16_f32 v156, v32, v33
    v_exp_f32 v32, v84
    v_add_f32 v28, v28, v34
    v_mfma_f32_32x32x16_bf16 a[32:47], a[180:183], v[140:143], a[32:47]
    v_exp_f32 v33, v85
    v_add_f32 v29, v29, v35
    v_cvt_pk_bf16_f32 v157, v34, v35
    v_mfma_f32_32x32x16_bf16 a[96:111], a[180:183], v[148:151], a[96:111]
    s_add_u32 s30, s30, 16384
    v_exp_f32 v34, v86
    v_add_f32 v28, v28, v32
    v_exp_f32 v35, v87
    v_mfma_f32_32x32x16_bf16 a[48:63], a[188:191], v[140:143], a[48:63]
    s_min_u32 s30, s30, 507904
    v_add_f32 v29, v29, v33
    v_cvt_pk_bf16_f32 v158, v32, v33
    v_mfma_f32_32x32x16_bf16 a[112:127], a[188:191], v[148:151], a[112:127]
    v_exp_f32 v32, v88
    v_add_f32 v28, v28, v34
    v_exp_f32 v33, v89
    s_waitcnt lgkmcnt(0)
    v_mfma_f32_32x32x16_bf16 v[40:55], a[128:131], v[168:171], v[104:119]
    ds_read_b64_tr_b16 a[160:161], v18 offset:40960
    ds_read_b64_tr_b16 a[162:163], v18 offset:43008
    v_add_f32 v29, v29, v35
    v_cvt_pk_bf16_f32 v159, v34, v35
    v_mfma_f32_32x32x16_bf16 v[40:55], a[132:135], v[172:175], v[40:55]
    ds_read_b64_tr_b16 a[168:169], v19 offset:40960
    v_exp_f32 v34, v90
    v_add_f32 v30, v30, v32
    v_mfma_f32_32x32x16_bf16 v[40:55], a[136:139], v[176:179], v[40:55]
    ds_read_b64_tr_b16 a[170:171], v19 offset:43008
    v_exp_f32 v35, v91
    v_add_f32 v31, v31, v33
    v_cvt_pk_bf16_f32 v160, v32, v33
    v_mfma_f32_32x32x16_bf16 v[40:55], a[140:143], v[180:183], v[40:55]
    ds_read_b64_tr_b16 a[176:177], v20 offset:40960
    v_exp_f32 v32, v92
    v_add_f32 v30, v30, v34
    v_mfma_f32_32x32x16_bf16 v[40:55], a[144:147], v[184:187], v[40:55]
    ds_read_b64_tr_b16 a[178:179], v20 offset:43008
    ds_read_b64_tr_b16 a[184:185], v21 offset:40960
    v_exp_f32 v33, v93
    v_add_f32 v31, v31, v35
    v_mfma_f32_32x32x16_bf16 v[40:55], a[148:151], v[188:191], v[40:55]
    ds_read_b64_tr_b16 a[186:187], v21 offset:43008
    v_cvt_pk_bf16_f32 v161, v34, v35
    v_exp_f32 v34, v94
    v_mfma_f32_32x32x16_bf16 v[40:55], a[152:155], v[192:195], v[40:55]
    ds_read_b64_tr_b16 a[164:165], v18 offset:45056
    v_add_f32 v30, v30, v32
    v_exp_f32 v35, v95
    v_add_f32 v31, v31, v33
    v_mfma_f32_32x32x16_bf16 v[40:55], a[156:159], v[196:199], v[40:55]
    ds_read_b64_tr_b16 a[166:167], v18 offset:47104
    v_cvt_pk_bf16_f32 v162, v32, v33
    v_exp_f32 v32, v96
    v_mfma_f32_32x32x16_bf16 v[56:71], a[128:131], v[200:203], v[120:135]
    ds_read_b64_tr_b16 a[172:173], v19 offset:45056
    ds_read_b64_tr_b16 a[174:175], v19 offset:47104
    v_add_f32 v30, v30, v34
    v_exp_f32 v33, v97
    v_mfma_f32_32x32x16_bf16 v[56:71], a[132:135], v[204:207], v[56:71]
    ds_read_b64_tr_b16 a[180:181], v20 offset:45056
    v_add_f32 v31, v31, v35
    v_cvt_pk_bf16_f32 v163, v34, v35
    v_exp_f32 v34, v98
    v_mfma_f32_32x32x16_bf16 v[56:71], a[136:139], v[208:211], v[56:71]
    ds_read_b64_tr_b16 a[182:183], v20 offset:47104
    v_add_f32 v30, v30, v32
    v_exp_f32 v35, v99
    v_mfma_f32_32x32x16_bf16 v[56:71], a[140:143], v[212:215], v[56:71]
    ds_read_b64_tr_b16 a[188:189], v21 offset:45056
    v_add_f32 v31, v31, v33
    v_cvt_pk_bf16_f32 v164, v32, v33
    v_exp_f32 v32, v100
    v_mfma_f32_32x32x16_bf16 v[56:71], a[144:147], v[216:219], v[56:71]
    ds_read_b64_tr_b16 a[190:191], v21 offset:47104
    v_add_f32 v30, v30, v34
    v_exp_f32 v33, v101
    v_mfma_f32_32x32x16_bf16 v[56:71], a[148:151], v[220:223], v[56:71]
    v_add_f32 v31, v31, v35
    v_cvt_pk_bf16_f32 v165, v34, v35
    v_exp_f32 v34, v102
    v_mfma_f32_32x32x16_bf16 v[56:71], a[152:155], v[224:227], v[56:71]
    v_add_f32 v30, v30, v32
    v_exp_f32 v35, v103
    v_add_f32 v31, v31, v33
    v_cvt_pk_bf16_f32 v166, v32, v33
    v_mfma_f32_32x32x16_bf16 v[56:71], a[156:159], v[228:231], v[56:71]
    s_nop 0
    v_add_f32 v30, v30, v34
    v_add_f32 v31, v31, v35
    v_cvt_pk_bf16_f32 v167, v34, v35
    s_waitcnt lgkmcnt(0)
    v_mfma_f32_32x32x16_bf16 a[0:15], a[160:163], v[152:155], a[0:15]
    ds_read_b128 a[128:131], v10 offset:57344
    v_exp_f32 v32, v40
    v_exp_f32 v33, v41
    v_mfma_f32_32x32x16_bf16 a[64:79], a[160:163], v[160:163], a[64:79]
    ds_read_b128 a[132:135], v11 offset:57344
    v_exp_f32 v34, v42
    v_add_f32 v28, v28, v32
    v_exp_f32 v35, v43
    v_mfma_f32_32x32x16_bf16 a[16:31], a[168:171], v[152:155], a[16:31]
    v_add_f32 v29, v29, v33
    v_cvt_pk_bf16_f32 v136, v32, v33
    v_exp_f32 v32, v44
    v_mfma_f32_32x32x16_bf16 a[80:95], a[168:171], v[160:163], a[80:95]
    ds_read_b128 a[136:139], v12 offset:57344
    v_add_f32 v28, v28, v34
    v_exp_f32 v33, v45
    v_mfma_f32_32x32x16_bf16 a[32:47], a[176:179], v[152:155], a[32:47]
    ds_read_b128 a[140:143], v13 offset:57344
    v_add_f32 v29, v29, v35
    v_cvt_pk_bf16_f32 v137, v34, v35
    v_exp_f32 v34, v46
    v_mfma_f32_32x32x16_bf16 a[96:111], a[176:179], v[160:163], a[96:111]
    v_add_f32 v28, v28, v32
    v_exp_f32 v35, v47
    v_add_f32 v29, v29, v33
    v_mfma_f32_32x32x16_bf16 a[48:63], a[184:187], v[152:155], a[48:63]
    ds_read_b128 a[144:147], v14 offset:57344
    v_cvt_pk_bf16_f32 v138, v32, v33
    v_exp_f32 v32, v48
    v_add_f32 v28, v28, v34
    v_mfma_f32_32x32x16_bf16 a[112:127], a[184:187], v[160:163], a[112:127]
    ds_read_b128 a[148:151], v15 offset:57344
    v_exp_f32 v33, v49
    v_add_f32 v29, v29, v35
    v_mfma_f32_32x32x16_bf16 a[0:15], a[164:167], v[156:159], a[0:15]
    v_cvt_pk_bf16_f32 v139, v34, v35
    v_exp_f32 v34, v50
    v_add_f32 v28, v28, v32
    v_exp_f32 v35, v51
    v_mfma_f32_32x32x16_bf16 a[64:79], a[164:167], v[164:167], a[64:79]
    ds_read_b128 a[152:155], v16 offset:57344
    v_add_f32 v29, v29, v33
    v_cvt_pk_bf16_f32 v140, v32, v33
    v_mfma_f32_32x32x16_bf16 a[16:31], a[172:175], v[156:159], a[16:31]
    ds_read_b128 a[156:159], v17 offset:57344
    v_exp_f32 v32, v52
    v_add_f32 v28, v28, v34
    v_exp_f32 v33, v53
    v_mfma_f32_32x32x16_bf16 a[80:95], a[172:175], v[164:167], a[80:95]
    v_add_f32 v29, v29, v35
    v_cvt_pk_bf16_f32 v141, v34, v35
    v_exp_f32 v34, v54
    v_mfma_f32_32x32x16_bf16 a[32:47], a[180:183], v[156:159], a[32:47]
    v_add_f32 v28, v28, v32
    v_exp_f32 v35, v55
    v_add_f32 v29, v29, v33
    v_mfma_f32_32x32x16_bf16 a[96:111], a[180:183], v[164:167], a[96:111]
    v_cvt_pk_bf16_f32 v142, v32, v33
    v_exp_f32 v32, v56
    v_add_f32 v28, v28, v34
    v_exp_f32 v33, v57
    v_mfma_f32_32x32x16_bf16 a[48:63], a[188:191], v[156:159], a[48:63]
    v_add_f32 v29, v29, v35
    v_cvt_pk_bf16_f32 v143, v34, v35
    v_exp_f32 v34, v58
    v_mfma_f32_32x32x16_bf16 a[112:127], a[188:191], v[164:167], a[112:127]
    v_add_f32 v30, v30, v32
    s_waitcnt lgkmcnt(0)
    s_waitcnt vmcnt(16)
    s_barrier
    v_mfma_f32_32x32x16_bf16 v[72:87], a[128:131], v[168:171], v[104:119]
    ds_read_b64_tr_b16 a[160:161], v18 offset:49152
    ds_read_b64_tr_b16 a[162:163], v18 offset:51200
    v_exp_f32 v35, v59
    v_add_f32 v31, v31, v33
    v_mfma_f32_32x32x16_bf16 v[72:87], a[132:135], v[172:175], v[72:87]
    ds_read_b64_tr_b16 a[168:169], v19 offset:49152
    s_add_u32 m0, s28, 49152
    v_cvt_pk_bf16_f32 v144, v32, v33
    v_exp_f32 v32, v60
    v_mfma_f32_32x32x16_bf16 v[72:87], a[136:139], v[176:179], v[72:87]
    ds_read_b64_tr_b16 a[170:171], v19 offset:51200
    buffer_load_dwordx4 v22, s[8:11], s29 offen offset:0 lds
    v_add_f32 v30, v30, v34
    v_exp_f32 v33, v61
    v_mfma_f32_32x32x16_bf16 v[72:87], a[140:143], v[180:183], v[72:87]
    ds_read_b64_tr_b16 a[176:177], v20 offset:49152
    v_add_f32 v31, v31, v35
    v_cvt_pk_bf16_f32 v145, v34, v35
    v_mfma_f32_32x32x16_bf16 v[72:87], a[144:147], v[184:187], v[72:87]
    ds_read_b64_tr_b16 a[178:179], v20 offset:51200
    ds_read_b64_tr_b16 a[184:185], v21 offset:49152
    v_exp_f32 v34, v62
    v_add_f32 v30, v30, v32
    v_mfma_f32_32x32x16_bf16 v[72:87], a[148:151], v[188:191], v[72:87]
    ds_read_b64_tr_b16 a[186:187], v21 offset:51200
    buffer_load_dwordx4 v23, s[8:11], s29 offen offset:1024 lds
    v_exp_f32 v35, v63
    v_add_f32 v31, v31, v33
    v_mfma_f32_32x32x16_bf16 v[72:87], a[152:155], v[192:195], v[72:87]
    ds_read_b64_tr_b16 a[164:165], v18 offset:53248
    v_cvt_pk_bf16_f32 v146, v32, v33
    v_exp_f32 v32, v64
    v_mfma_f32_32x32x16_bf16 v[72:87], a[156:159], v[196:199], v[72:87]
    ds_read_b64_tr_b16 a[166:167], v18 offset:55296
    v_add_f32 v30, v30, v34
    v_exp_f32 v33, v65
    v_add_f32 v31, v31, v35
    v_mfma_f32_32x32x16_bf16 v[88:103], a[128:131], v[200:203], v[120:135]
    ds_read_b64_tr_b16 a[172:173], v19 offset:53248
    ds_read_b64_tr_b16 a[174:175], v19 offset:55296
    buffer_load_dwordx4 v24, s[8:11], s29 offen offset:2048 lds
    v_cvt_pk_bf16_f32 v147, v34, v35
    v_mfma_f32_32x32x16_bf16 v[88:103], a[132:135], v[204:207], v[88:103]
    ds_read_b64_tr_b16 a[180:181], v20 offset:53248
    v_exp_f32 v34, v66
    v_add_f32 v30, v30, v32
    v_exp_f32 v35, v67
    v_mfma_f32_32x32x16_bf16 v[88:103], a[136:139], v[208:211], v[88:103]
    ds_read_b64_tr_b16 a[182:183], v20 offset:55296
    v_add_f32 v31, v31, v33
    v_cvt_pk_bf16_f32 v148, v32, v33
    v_exp_f32 v32, v68
    v_mfma_f32_32x32x16_bf16 v[88:103], a[140:143], v[212:215], v[88:103]
    ds_read_b64_tr_b16 a[188:189], v21 offset:53248
    buffer_load_dwordx4 v25, s[8:11], s29 offen offset:3072 lds
    v_add_f32 v30, v30, v34
    v_mfma_f32_32x32x16_bf16 v[88:103], a[144:147], v[216:219], v[88:103]
    ds_read_b64_tr_b16 a[190:191], v21 offset:55296
    v_exp_f32 v33, v69
    v_add_f32 v31, v31, v35
    v_cvt_pk_bf16_f32 v149, v34, v35
    v_mfma_f32_32x32x16_bf16 v[88:103], a[148:151], v[220:223], v[88:103]
    s_add_u32 s29, s29, 16384
    v_exp_f32 v34, v70
    v_add_f32 v30, v30, v32
    v_mfma_f32_32x32x16_bf16 v[88:103], a[152:155], v[224:227], v[88:103]
    s_min_u32 s29, s29, 507904
    v_exp_f32 v35, v71
    v_add_f32 v31, v31, v33
    v_cvt_pk_bf16_f32 v150, v32, v33
    v_mfma_f32_32x32x16_bf16 v[88:103], a[156:159], v[228:231], v[88:103]
    s_nop 0
    v_add_f32 v30, v30, v34
    v_add_f32 v31, v31, v35
    v_cvt_pk_bf16_f32 v151, v34, v35
    s_waitcnt lgkmcnt(0)
    v_mfma_f32_32x32x16_bf16 a[0:15], a[160:163], v[136:139], a[0:15]
    ds_read_b128 a[128:131], v10 offset:0
    v_exp_f32 v32, v72
    v_exp_f32 v33, v73
    v_mfma_f32_32x32x16_bf16 a[64:79], a[160:163], v[144:147], a[64:79]
    ds_read_b128 a[132:135], v11 offset:0
    s_add_u32 m0, s28, 98304
    v_exp_f32 v34, v74
    v_add_f32 v28, v28, v32
    v_mfma_f32_32x32x16_bf16 a[16:31], a[168:171], v[136:139], a[16:31]
    buffer_load_dwordx4 v26, s[12:15], s30 offen offset:0 lds
    v_exp_f32 v35, v75
    v_add_f32 v29, v29, v33
    v_mfma_f32_32x32x16_bf16 a[80:95], a[168:171], v[144:147], a[80:95]
    ds_read_b128 a[136:139], v12 offset:0
    v_cvt_pk_bf16_f32 v152, v32, v33
    v_exp_f32 v32, v76
    v_add_f32 v28, v28, v34
    v_mfma_f32_32x32x16_bf16 a[32:47], a[176:179], v[136:139], a[32:47]
    ds_read_b128 a[140:143], v13 offset:0
    v_exp_f32 v33, v77
    v_add_f32 v29, v29, v35
    v_mfma_f32_32x32x16_bf16 a[96:111], a[176:179], v[144:147], a[96:111]
    buffer_load_dwordx4 v26, s[12:15], s30 offen offset:1024 lds
    v_cvt_pk_bf16_f32 v153, v34, v35
    v_exp_f32 v34, v78
    v_add_f32 v28, v28, v32
    v_mfma_f32_32x32x16_bf16 a[48:63], a[184:187], v[136:139], a[48:63]
    ds_read_b128 a[144:147], v14 offset:0
    v_exp_f32 v35, v79
    v_add_f32 v29, v29, v33
    v_mfma_f32_32x32x16_bf16 a[112:127], a[184:187], v[144:147], a[112:127]
    ds_read_b128 a[148:151], v15 offset:0
    v_cvt_pk_bf16_f32 v154, v32, v33
    v_exp_f32 v32, v80
    v_add_f32 v28, v28, v34
    v_mfma_f32_32x32x16_bf16 a[0:15], a[164:167], v[140:143], a[0:15]
    buffer_load_dwordx4 v26, s[12:15], s30 offen offset:2048 lds
    v_exp_f32 v33, v81
    v_add_f32 v29, v29, v35
    v_mfma_f32_32x32x16_bf16 a[64:79], a[164:167], v[148:151], a[64:79]
    ds_read_b128 a[152:155], v16 offset:0
    v_cvt_pk_bf16_f32 v155, v34, v35
    v_exp_f32 v34, v82
    v_add_f32 v28, v28, v32
    v_mfma_f32_32x32x16_bf16 a[16:31], a[172:175], v[140:143], a[16:31]
    ds_read_b128 a[156:159], v17 offset:0
    v_exp_f32 v35, v83
    v_add_f32 v29, v29, v33
    v_mfma_f32_32x32x16_bf16 a[80:95], a[172:175], v[148:151], a[80:95]
    buffer_load_dwordx4 v26, s[12:15], s30 offen offset:3072 lds
    v_cvt_pk_bf16_f32 v156, v32, v33
    v_exp_f32 v32, v84
    v_add_f32 v28, v28, v34
    v_mfma_f32_32x32x16_bf16 a[32:47], a[180:183], v[140:143], a[32:47]
    v_exp_f32 v33, v85
    v_add_f32 v29, v29, v35
    v_cvt_pk_bf16_f32 v157, v34, v35
    v_mfma_f32_32x32x16_bf16 a[96:111], a[180:183], v[148:151], a[96:111]
    s_add_u32 s30, s30, 16384
    v_exp_f32 v34, v86
    v_add_f32 v28, v28, v32
    v_exp_f32 v35, v87
    v_mfma_f32_32x32x16_bf16 a[48:63], a[188:191], v[140:143], a[48:63]
    s_min_u32 s30, s30, 507904
    v_add_f32 v29, v29, v33
    v_cvt_pk_bf16_f32 v158, v32, v33
    v_mfma_f32_32x32x16_bf16 a[112:127], a[188:191], v[148:151], a[112:127]
    v_exp_f32 v32, v88
    v_add_f32 v28, v28, v34
    v_exp_f32 v33, v89
    s_waitcnt lgkmcnt(0)
    v_mfma_f32_32x32x16_bf16 v[40:55], a[128:131], v[168:171], v[104:119]
    ds_read_b64_tr_b16 a[160:161], v18 offset:57344
    ds_read_b64_tr_b16 a[162:163], v18 offset:59392
    v_add_f32 v29, v29, v35
    v_cvt_pk_bf16_f32 v159, v34, v35
    v_mfma_f32_32x32x16_bf16 v[40:55], a[132:135], v[172:175], v[40:55]
    ds_read_b64_tr_b16 a[168:169], v19 offset:57344
    v_exp_f32 v34, v90
    v_add_f32 v30, v30, v32
    v_mfma_f32_32x32x16_bf16 v[40:55], a[136:139], v[176:179], v[40:55]
    ds_read_b64_tr_b16 a[170:171], v19 offset:59392
    v_exp_f32 v35, v91
    v_add_f32 v31, v31, v33
    v_cvt_pk_bf16_f32 v160, v32, v33
    v_mfma_f32_32x32x16_bf16 v[40:55], a[140:143], v[180:183], v[40:55]
    ds_read_b64_tr_b16 a[176:177], v20 offset:57344
    v_exp_f32 v32, v92
    v_add_f32 v30, v30, v34
    v_mfma_f32_32x32x16_bf16 v[40:55], a[144:147], v[184:187], v[40:55]
    ds_read_b64_tr_b16 a[178:179], v20 offset:59392
    ds_read_b64_tr_b16 a[184:185], v21 offset:57344
    v_exp_f32 v33, v93
    v_add_f32 v31, v31, v35
    v_mfma_f32_32x32x16_bf16 v[40:55], a[148:151], v[188:191], v[40:55]
    ds_read_b64_tr_b16 a[186:187], v21 offset:59392
    v_cvt_pk_bf16_f32 v161, v34, v35
    v_exp_f32 v34, v94
    v_mfma_f32_32x32x16_bf16 v[40:55], a[152:155], v[192:195], v[40:55]
    ds_read_b64_tr_b16 a[164:165], v18 offset:61440
    v_add_f32 v30, v30, v32
    v_exp_f32 v35, v95
    v_add_f32 v31, v31, v33
    v_mfma_f32_32x32x16_bf16 v[40:55], a[156:159], v[196:199], v[40:55]
    ds_read_b64_tr_b16 a[166:167], v18 offset:63488
    v_cvt_pk_bf16_f32 v162, v32, v33
    v_exp_f32 v32, v96
    v_mfma_f32_32x32x16_bf16 v[56:71], a[128:131], v[200:203], v[120:135]
    ds_read_b64_tr_b16 a[172:173], v19 offset:61440
    ds_read_b64_tr_b16 a[174:175], v19 offset:63488
    v_add_f32 v30, v30, v34
    v_exp_f32 v33, v97
    v_mfma_f32_32x32x16_bf16 v[56:71], a[132:135], v[204:207], v[56:71]
    ds_read_b64_tr_b16 a[180:181], v20 offset:61440
    v_add_f32 v31, v31, v35
    v_cvt_pk_bf16_f32 v163, v34, v35
    v_exp_f32 v34, v98
    v_mfma_f32_32x32x16_bf16 v[56:71], a[136:139], v[208:211], v[56:71]
    ds_read_b64_tr_b16 a[182:183], v20 offset:63488
    v_add_f32 v30, v30, v32
    v_exp_f32 v35, v99
    v_mfma_f32_32x32x16_bf16 v[56:71], a[140:143], v[212:215], v[56:71]
    ds_read_b64_tr_b16 a[188:189], v21 offset:61440
    v_add_f32 v31, v31, v33
    v_cvt_pk_bf16_f32 v164, v32, v33
    v_exp_f32 v32, v100
    v_mfma_f32_32x32x16_bf16 v[56:71], a[144:147], v[216:219], v[56:71]
    ds_read_b64_tr_b16 a[190:191], v21 offset:63488
    v_add_f32 v30, v30, v34
    v_exp_f32 v33, v101
    v_mfma_f32_32x32x16_bf16 v[56:71], a[148:151], v[220:223], v[56:71]
    v_add_f32 v31, v31, v35
    v_cvt_pk_bf16_f32 v165, v34, v35
    v_exp_f32 v34, v102
    v_mfma_f32_32x32x16_bf16 v[56:71], a[152:155], v[224:227], v[56:71]
    v_add_f32 v30, v30, v32
    v_exp_f32 v35, v103
    v_add_f32 v31, v31, v33
    v_cvt_pk_bf16_f32 v166, v32, v33
    v_mfma_f32_32x32x16_bf16 v[56:71], a[156:159], v[228:231], v[56:71]
    s_nop 0
    v_add_f32 v30, v30, v34
    v_add_f32 v31, v31, v35
    v_cvt_pk_bf16_f32 v167, v34, v35
    s_waitcnt lgkmcnt(0)
    v_mfma_f32_32x32x16_bf16 a[0:15], a[160:163], v[152:155], a[0:15]
    ds_read_b128 a[128:131], v10 offset:8192
    v_exp_f32 v32, v40
    v_exp_f32 v33, v41
    v_mfma_f32_32x32x16_bf16 a[64:79], a[160:163], v[160:163], a[64:79]
    ds_read_b128 a[132:135], v11 offset:8192
    v_exp_f32 v34, v42
    v_add_f32 v28, v28, v32
    v_exp_f32 v35, v43
    v_mfma_f32_32x32x16_bf16 a[16:31], a[168:171], v[152:155], a[16:31]
    v_add_f32 v29, v29, v33
    v_cvt_pk_bf16_f32 v136, v32, v33
    v_exp_f32 v32, v44
    v_mfma_f32_32x32x16_bf16 a[80:95], a[168:171], v[160:163], a[80:95]
    ds_read_b128 a[136:139], v12 offset:8192
    v_add_f32 v28, v28, v34
    v_exp_f32 v33, v45
    v_mfma_f32_32x32x16_bf16 a[32:47], a[176:179], v[152:155], a[32:47]
    ds_read_b128 a[140:143], v13 offset:8192
    v_add_f32 v29, v29, v35
    v_cvt_pk_bf16_f32 v137, v34, v35
    v_exp_f32 v34, v46
    v_mfma_f32_32x32x16_bf16 a[96:111], a[176:179], v[160:163], a[96:111]
    v_add_f32 v28, v28, v32
    v_exp_f32 v35, v47
    v_add_f32 v29, v29, v33
    v_mfma_f32_32x32x16_bf16 a[48:63], a[184:187], v[152:155], a[48:63]
    ds_read_b128 a[144:147], v14 offset:8192
    v_cvt_pk_bf16_f32 v138, v32, v33
    v_exp_f32 v32, v48
    v_add_f32 v28, v28, v34
    v_mfma_f32_32x32x16_bf16 a[112:127], a[184:187], v[160:163], a[112:127]
    ds_read_b128 a[148:151], v15 offset:8192
    v_exp_f32 v33, v49
    v_add_f32 v29, v29, v35
    v_mfma_f32_32x32x16_bf16 a[0:15], a[164:167], v[156:159], a[0:15]
    v_cvt_pk_bf16_f32 v139, v34, v35
    v_exp_f32 v34, v50
    v_add_f32 v28, v28, v32
    v_exp_f32 v35, v51
    v_mfma_f32_32x32x16_bf16 a[64:79], a[164:167], v[164:167], a[64:79]
    ds_read_b128 a[152:155], v16 offset:8192
    v_add_f32 v29, v29, v33
    v_cvt_pk_bf16_f32 v140, v32, v33
    v_mfma_f32_32x32x16_bf16 a[16:31], a[172:175], v[156:159], a[16:31]
    ds_read_b128 a[156:159], v17 offset:8192
    v_exp_f32 v32, v52
    v_add_f32 v28, v28, v34
    v_exp_f32 v33, v53
    v_mfma_f32_32x32x16_bf16 a[80:95], a[172:175], v[164:167], a[80:95]
    v_add_f32 v29, v29, v35
    v_cvt_pk_bf16_f32 v141, v34, v35
    v_exp_f32 v34, v54
    v_mfma_f32_32x32x16_bf16 a[32:47], a[180:183], v[156:159], a[32:47]
    v_add_f32 v28, v28, v32
    v_exp_f32 v35, v55
    v_add_f32 v29, v29, v33
    v_mfma_f32_32x32x16_bf16 a[96:111], a[180:183], v[164:167], a[96:111]
    v_cvt_pk_bf16_f32 v142, v32, v33
    v_exp_f32 v32, v56
    v_add_f32 v28, v28, v34
    v_exp_f32 v33, v57
    v_mfma_f32_32x32x16_bf16 a[48:63], a[188:191], v[156:159], a[48:63]
    v_add_f32 v29, v29, v35
    v_cvt_pk_bf16_f32 v143, v34, v35
    v_exp_f32 v34, v58
    v_mfma_f32_32x32x16_bf16 a[112:127], a[188:191], v[164:167], a[112:127]
    v_add_f32 v30, v30, v32
    s_waitcnt lgkmcnt(0)
    s_waitcnt vmcnt(16)
    s_barrier
    v_mfma_f32_32x32x16_bf16 v[72:87], a[128:131], v[168:171], v[104:119]
    ds_read_b64_tr_b16 a[160:161], v18 offset:0
    ds_read_b64_tr_b16 a[162:163], v18 offset:2048
    v_exp_f32 v35, v59
    v_add_f32 v31, v31, v33
    v_mfma_f32_32x32x16_bf16 v[72:87], a[132:135], v[172:175], v[72:87]
    ds_read_b64_tr_b16 a[168:169], v19 offset:0
    s_add_u32 m0, s28, 0
    v_cvt_pk_bf16_f32 v144, v32, v33
    v_exp_f32 v32, v60
    v_mfma_f32_32x32x16_bf16 v[72:87], a[136:139], v[176:179], v[72:87]
    ds_read_b64_tr_b16 a[170:171], v19 offset:2048
    buffer_load_dwordx4 v22, s[8:11], s29 offen offset:0 lds
    v_add_f32 v30, v30, v34
    v_exp_f32 v33, v61
    v_mfma_f32_32x32x16_bf16 v[72:87], a[140:143], v[180:183], v[72:87]
    ds_read_b64_tr_b16 a[176:177], v20 offset:0
    v_add_f32 v31, v31, v35
    v_cvt_pk_bf16_f32 v145, v34, v35
    v_mfma_f32_32x32x16_bf16 v[72:87], a[144:147], v[184:187], v[72:87]
    ds_read_b64_tr_b16 a[178:179], v20 offset:2048
    ds_read_b64_tr_b16 a[184:185], v21 offset:0
    v_exp_f32 v34, v62
    v_add_f32 v30, v30, v32
    v_mfma_f32_32x32x16_bf16 v[72:87], a[148:151], v[188:191], v[72:87]
    ds_read_b64_tr_b16 a[186:187], v21 offset:2048
    buffer_load_dwordx4 v23, s[8:11], s29 offen offset:1024 lds
    v_exp_f32 v35, v63
    v_add_f32 v31, v31, v33
    v_mfma_f32_32x32x16_bf16 v[72:87], a[152:155], v[192:195], v[72:87]
    ds_read_b64_tr_b16 a[164:165], v18 offset:4096
    v_cvt_pk_bf16_f32 v146, v32, v33
    v_exp_f32 v32, v64
    v_mfma_f32_32x32x16_bf16 v[72:87], a[156:159], v[196:199], v[72:87]
    ds_read_b64_tr_b16 a[166:167], v18 offset:6144
    v_add_f32 v30, v30, v34
    v_exp_f32 v33, v65
    v_add_f32 v31, v31, v35
    v_mfma_f32_32x32x16_bf16 v[88:103], a[128:131], v[200:203], v[120:135]
    ds_read_b64_tr_b16 a[172:173], v19 offset:4096
    ds_read_b64_tr_b16 a[174:175], v19 offset:6144
    buffer_load_dwordx4 v24, s[8:11], s29 offen offset:2048 lds
    v_cvt_pk_bf16_f32 v147, v34, v35
    v_mfma_f32_32x32x16_bf16 v[88:103], a[132:135], v[204:207], v[88:103]
    ds_read_b64_tr_b16 a[180:181], v20 offset:4096
    v_exp_f32 v34, v66
    v_add_f32 v30, v30, v32
    v_exp_f32 v35, v67
    v_mfma_f32_32x32x16_bf16 v[88:103], a[136:139], v[208:211], v[88:103]
    ds_read_b64_tr_b16 a[182:183], v20 offset:6144
    v_add_f32 v31, v31, v33
    v_cvt_pk_bf16_f32 v148, v32, v33
    v_exp_f32 v32, v68
    v_mfma_f32_32x32x16_bf16 v[88:103], a[140:143], v[212:215], v[88:103]
    ds_read_b64_tr_b16 a[188:189], v21 offset:4096
    buffer_load_dwordx4 v25, s[8:11], s29 offen offset:3072 lds
    v_add_f32 v30, v30, v34
    v_mfma_f32_32x32x16_bf16 v[88:103], a[144:147], v[216:219], v[88:103]
    ds_read_b64_tr_b16 a[190:191], v21 offset:6144
    v_exp_f32 v33, v69
    v_add_f32 v31, v31, v35
    v_cvt_pk_bf16_f32 v149, v34, v35
    v_mfma_f32_32x32x16_bf16 v[88:103], a[148:151], v[220:223], v[88:103]
    s_add_u32 s29, s29, 16384
    v_exp_f32 v34, v70
    v_add_f32 v30, v30, v32
    v_mfma_f32_32x32x16_bf16 v[88:103], a[152:155], v[224:227], v[88:103]
    s_min_u32 s29, s29, 507904
    v_exp_f32 v35, v71
    v_add_f32 v31, v31, v33
    v_cvt_pk_bf16_f32 v150, v32, v33
    v_mfma_f32_32x32x16_bf16 v[88:103], a[156:159], v[228:231], v[88:103]
    s_nop 0
    v_add_f32 v30, v30, v34
    v_add_f32 v31, v31, v35
    v_cvt_pk_bf16_f32 v151, v34, v35
    s_sub_u32 s32, s32, 1
    s_cmp_lg_u32 s32, 0
    s_cbranch_scc1 L_at_loop
L_at_loopend:
    s_waitcnt lgkmcnt(0)
    v_mfma_f32_32x32x16_bf16 a[0:15], a[160:163], v[136:139], a[0:15]
    ds_read_b128 a[128:131], v10 offset:16384
    v_exp_f32 v32, v72
    v_exp_f32 v33, v73
    v_mfma_f32_32x32x16_bf16 a[64:79], a[160:163], v[144:147], a[64:79]
    ds_read_b128 a[132:135], v11 offset:16384
    s_add_u32 m0, s28, 114688
    v_exp_f32 v34, v74
    v_add_f32 v28, v28, v32
    v_mfma_f32_32x32x16_bf16 a[16:31], a[168:171], v[136:139], a[16:31]
    buffer_load_dwordx4 v26, s[12:15], s30 offen offset:0 lds
    v_exp_f32 v35, v75
    v_add_f32 v29, v29, v33
    v_mfma_f32_32x32x16_bf16 a[80:95], a[168:171], v[144:147], a[80:95]
    ds_read_b128 a[136:139], v12 offset:16384
    v_cvt_pk_bf16_f32 v152, v32, v33
    v_exp_f32 v32, v76
    v_add_f32 v28, v28, v34
    v_mfma_f32_32x32x16_bf16 a[32:47], a[176:179], v[136:139], a[32:47]
    ds_read_b128 a[140:143], v13 offset:16384
    v_exp_f32 v33, v77
    v_add_f32 v29, v29, v35
    v_mfma_f32_32x32x16_bf16 a[96:111], a[176:179], v[144:147], a[96:111]
    buffer_load_dwordx4 v26, s[12:15], s30 offen offset:1024 lds
    v_cvt_pk_bf16_f32 v153, v34, v35
    v_exp_f32 v34, v78
    v_add_f32 v28, v28, v32
    v_mfma_f32_32x32x16_bf16 a[48:63], a[184:187], v[136:139], a[48:63]
    ds_read_b128 a[144:147], v14 offset:16384
    v_exp_f32 v35, v79
    v_add_f32 v29, v29, v33
    v_mfma_f32_32x32x16_bf16 a[112:127], a[184:187], v[144:147], a[112:127]
    ds_read_b128 a[148:151], v15 offset:16384
    v_cvt_pk_bf16_f32 v154, v32, v33
    v_exp_f32 v32, v80
    v_add_f32 v28, v28, v34
    v_mfma_f32_32x32x16_bf16 a[0:15], a[164:167], v[140:143], a[0:15]
    buffer_load_dwordx4 v26, s[12:15], s30 offen offset:2048 lds
    v_exp_f32 v33, v81
    v_add_f32 v29, v29, v35
    v_mfma_f32_32x32x16_bf16 a[64:79], a[164:167], v[148:151], a[64:79]
    ds_read_b128 a[152:155], v16 offset:16384
    v_cvt_pk_bf16_f32 v155, v34, v35
    v_exp_f32 v34, v82
    v_add_f32 v28, v28, v32
    v_mfma_f32_32x32x16_bf16 a[16:31], a[172:175], v[140:143], a[16:31]
    ds_read_b128 a[156:159], v17 offset:16384
    v_exp_f32 v35, v83
    v_add_f32 v29, v29, v33
    v_mfma_f32_32x32x16_bf16 a[80:95], a[172:175], v[148:151], a[80:95]
    buffer_load_dwordx4 v26, s[12:15], s30 offen offset:3072 lds
    v_cvt_pk_bf16_f32 v156, v32, v33
    v_exp_f32 v32, v84
    v_add_f32 v28, v28, v34
    v_mfma_f32_32x32x16_bf16 a[32:47], a[180:183], v[140:143], a[32:47]
    v_exp_f32 v33, v85
    v_add_f32 v29, v29, v35
    v_cvt_pk_bf16_f32 v157, v34, v35
    v_mfma_f32_32x32x16_bf16 a[96:111], a[180:183], v[148:151], a[96:111]
    s_add_u32 s30, s30, 16384
    v_exp_f32 v34, v86
    v_add_f32 v28, v28, v32
    v_exp_f32 v35, v87
    v_mfma_f32_32x32x16_bf16 a[48:63], a[188:191], v[140:143], a[48:63]
    s_min_u32 s30, s30, 507904
    v_add_f32 v29, v29, v33
    v_cvt_pk_bf16_f32 v158, v32, v33
    v_mfma_f32_32x32x16_bf16 a[112:127], a[188:191], v[148:151], a[112:127]
    v_exp_f32 v32, v88
    v_add_f32 v28, v28, v34
    v_exp_f32 v33, v89
    s_waitcnt lgkmcnt(0)
    v_mfma_f32_32x32x16_bf16 v[40:55], a[128:131], v[168:171], v[104:119]
    ds_read_b64_tr_b16 a[160:161], v18 offset:8192
    ds_read_b64_tr_b16 a[162:163], v18 offset:10240
    v_add_f32 v29, v29, v35
    v_cvt_pk_bf16_f32 v159, v34, v35
    v_mfma_f32_32x32x16_bf16 v[40:55], a[132:135], v[172:175], v[40:55]
    ds_read_b64_tr_b16 a[168:169], v19 offset:8192
    v_exp_f32 v34, v90
    v_add_f32 v30, v30, v32
    v_mfma_f32_32x32x16_bf16 v[40:55], a[136:139], v[176:179], v[40:55]
    ds_read_b64_tr_b16 a[170:171], v19 offset:10240
    v_exp_f32 v35, v91
    v_add_f32 v31, v31, v33
    v_cvt_pk_bf16_f32 v160, v32, v33
    v_mfma_f32_32x32x16_bf16 v[40:55], a[140:143], v[180:183], v[40:55]
    ds_read_b64_tr_b16 a[176:177], v20 offset:8192
    v_exp_f32 v32, v92
    v_add_f32 v30, v30, v34
    v_mfma_f32_32x32x16_bf16 v[40:55], a[144:147], v[184:187], v[40:55]
    ds_read_b64_tr_b16 a[178:179], v20 offset:10240
    ds_read_b64_tr_b16 a[184:185], v21 offset:8192
    v_exp_f32 v33, v93
    v_add_f32 v31, v31, v35
    v_mfma_f32_32x32x16_bf16 v[40:55], a[148:151], v[188:191], v[40:55]
    ds_read_b64_tr_b16 a[186:187], v21 offset:10240
    v_cvt_pk_bf16_f32 v161, v34, v35
    v_exp_f32 v34, v94
    v_mfma_f32_32x32x16_bf16 v[40:55], a[152:155], v[192:195], v[40:55]
    ds_read_b64_tr_b16 a[164:165], v18 offset:12288
    v_add_f32 v30, v30, v32
    v_exp_f32 v35, v95
    v_add_f32 v31, v31, v33
    v_mfma_f32_32x32x16_bf16 v[40:55], a[156:159], v[196:199], v[40:55]
    ds_read_b64_tr_b16 a[166:167], v18 offset:14336
    v_cvt_pk_bf16_f32 v162, v32, v33
    v_exp_f32 v32, v96
    v_mfma_f32_32x32x16_bf16 v[56:71], a[128:131], v[200:203], v[120:135]
    ds_read_b64_tr_b16 a[172:173], v19 offset:12288
    ds_read_b64_tr_b16 a[174:175], v19 offset:14336
    v_add_f32 v30, v30, v34
    v_exp_f32 v33, v97
    v_mfma_f32_32x32x16_bf16 v[56:71], a[132:135], v[204:207], v[56:71]
    ds_read_b64_tr_b16 a[180:181], v20 offset:12288
    v_add_f32 v31, v31, v35
    v_cvt_pk_bf16_f32 v163, v34, v35
    v_exp_f32 v34, v98
    v_mfma_f32_32x32x16_bf16 v[56:71], a[136:139], v[208:211], v[56:71]
    ds_read_b64_tr_b16 a[182:183], v20 offset:14336
    v_add_f32 v30, v30, v32
    v_exp_f32 v35, v99
    v_mfma_f32_32x32x16_bf16 v[56:71], a[140:143], v[212:215], v[56:71]
    ds_read_b64_tr_b16 a[188:189], v21 offset:12288
    v_add_f32 v31, v31, v33
    v_cvt_pk_bf16_f32 v164, v32, v33
    v_exp_f32 v32, v100
    v_mfma_f32_32x32x16_bf16 v[56:71], a[144:147], v[216:219], v[56:71]
    ds_read_b64_tr_b16 a[190:191], v21 offset:14336
    v_add_f32 v30, v30, v34
    v_exp_f32 v33, v101
    v_mfma_f32_32x32x16_bf16 v[56:71], a[148:151], v[220:223], v[56:71]
    v_add_f32 v31, v31, v35
    v_cvt_pk_bf16_f32 v165, v34, v35
    v_exp_f32 v34, v102
    v_mfma_f32_32x32x16_bf16 v[56:71], a[152:155], v[224:227], v[56:71]
    v_add_f32 v30, v30, v32
    v_exp_f32 v35, v103
    v_add_f32 v31, v31, v33
    v_cvt_pk_bf16_f32 v166, v32, v33
    v_mfma_f32_32x32x16_bf16 v[56:71], a[156:159], v[228:231], v[56:71]
    s_nop 0
    v_add_f32 v30, v30, v34
    v_add_f32 v31, v31, v35
    v_cvt_pk_bf16_f32 v167, v34, v35
    s_waitcnt lgkmcnt(0)
    v_mfma_f32_32x32x16_bf16 a[0:15], a[160:163], v[152:155], a[0:15]
    ds_read_b128 a[128:131], v10 offset:24576
    v_exp_f32 v32, v40
    v_exp_f32 v33, v41
    v_mfma_f32_32x32x16_bf16 a[64:79], a[160:163], v[160:163], a[64:79]
    ds_read_b128 a[132:135], v11 offset:24576
    v_exp_f32 v34, v42
    v_add_f32 v28, v28, v32
    v_exp_f32 v35, v43
    v_mfma_f32_32x32x16_bf16 a[16:31], a[168:171], v[152:155], a[16:31]
    v_add_f32 v29, v29, v33
    v_cvt_pk_bf16_f32 v136, v32, v33
    v_exp_f32 v32, v44
    v_mfma_f32_32x32x16_bf16 a[80:95], a[168:171], v[160:163], a[80:95]
    ds_read_b128 a[136:139], v12 offset:24576
    v_add_f32 v28, v28, v34
    v_exp_f32 v33, v45
    v_mfma_f32_32x32x16_bf16 a[32:47], a[176:179], v[152:155], a[32:47]
    ds_read_b128 a[140:143], v13 offset:24576
    v_add_f32 v29, v29, v35
    v_cvt_pk_bf16_f32 v137, v34, v35
    v_exp_f32 v34, v46
    v_mfma_f32_32x32x16_bf16 a[96:111], a[176:179], v[160:163], a[96:111]
    v_add_f32 v28, v28, v32
    v_exp_f32 v35, v47
    v_add_f32 v29, v29, v33
    v_mfma_f32_32x32x16_bf16 a[48:63], a[184:187], v[152:155], a[48:63]
    ds_read_b128 a[144:147], v14 offset:24576
    v_cvt_pk_bf16_f32 v138, v32, v33
    v_exp_f32 v32, v48
    v_add_f32 v28, v28, v34
    v_mfma_f32_32x32x16_bf16 a[112:127], a[184:187], v[160:163], a[112:127]
    ds_read_b128 a[148:151], v15 offset:24576
    v_exp_f32 v33, v49
    v_add_f32 v29, v29, v35
    v_mfma_f32_32x32x16_bf16 a[0:15], a[164:167], v[156:159], a[0:15]
    v_cvt_pk_bf16_f32 v139, v34, v35
    v_exp_f32 v34, v50
    v_add_f32 v28, v28, v32
    v_exp_f32 v35, v51
    v_mfma_f32_32x32x16_bf16 a[64:79], a[164:167], v[164:167], a[64:79]
    ds_read_b128 a[152:155], v16 offset:24576
    v_add_f32 v29, v29, v33
    v_cvt_pk_bf16_f32 v140, v32, v33
    v_mfma_f32_32x32x16_bf16 a[16:31], a[172:175], v[156:159], a[16:31]
    ds_read_b128 a[156:159], v17 offset:24576
    v_exp_f32 v32, v52
    v_add_f32 v28, v28, v34
    v_exp_f32 v33, v53
    v_mfma_f32_32x32x16_bf16 a[80:95], a[172:175], v[164:167], a[80:95]
    v_add_f32 v29, v29, v35
    v_cvt_pk_bf16_f32 v141, v34, v35
    v_exp_f32 v34, v54
    v_mfma_f32_32x32x16_bf16 a[32:47], a[180:183], v[156:159], a[32:47]
    v_add_f32 v28, v28, v32
    v_exp_f32 v35, v55
    v_add_f32 v29, v29, v33
    v_mfma_f32_32x32x16_bf16 a[96:111], a[180:183], v[164:167], a[96:111]
    v_cvt_pk_bf16_f32 v142, v32, v33
    v_exp_f32 v32, v56
    v_add_f32 v28, v28, v34
    v_exp_f32 v33, v57
    v_mfma_f32_32x32x16_bf16 a[48:63], a[188:191], v[156:159], a[48:63]
    v_add_f32 v29, v29, v35
    v_cvt_pk_bf16_f32 v143, v34, v35
    v_exp_f32 v34, v58
    v_mfma_f32_32x32x16_bf16 a[112:127], a[188:191], v[164:167], a[112:127]
    v_add_f32 v30, v30, v32
    s_waitcnt lgkmcnt(0)
    s_waitcnt vmcnt(16)
    s_barrier
    v_mfma_f32_32x32x16_bf16 v[72:87], a[128:131], v[168:171], v[104:119]
    ds_read_b64_tr_b16 a[160:161], v18 offset:16384
    ds_read_b64_tr_b16 a[162:163], v18 offset:18432
    v_exp_f32 v35, v59
    v_add_f32 v31, v31, v33
    v_mfma_f32_32x32x16_bf16 v[72:87], a[132:135], v[172:175], v[72:87]
    ds_read_b64_tr_b16 a[168:169], v19 offset:16384
    s_add_u32 m0, s28, 16384
    v_cvt_pk_bf16_f32 v144, v32, v33
    v_exp_f32 v32, v60
    v_mfma_f32_32x32x16_bf16 v[72:87], a[136:139], v[176:179], v[72:87]
    ds_read_b64_tr_b16 a[170:171], v19 offset:18432
    buffer_load_dword v243, v242, s[84:87], 0 offen
    v_add_f32 v30, v30, v34
    v_exp_f32 v33, v61
    v_mfma_f32_32x32x16_bf16 v[72:87], a[140:143], v[180:183], v[72:87]
    ds_read_b64_tr_b16 a[176:177], v20 offset:16384
    v_add_f32 v31, v31, v35
    v_cvt_pk_bf16_f32 v145, v34, v35
    v_mfma_f32_32x32x16_bf16 v[72:87], a[144:147], v[184:187], v[72:87]
    ds_read_b64_tr_b16 a[178:179], v20 offset:18432
    ds_read_b64_tr_b16 a[184:185], v21 offset:16384
    v_exp_f32 v34, v62
    v_add_f32 v30, v30, v32
    v_mfma_f32_32x32x16_bf16 v[72:87], a[148:151], v[188:191], v[72:87]
    ds_read_b64_tr_b16 a[186:187], v21 offset:18432
    buffer_load_dword v244, v242, s[88:91], 0 offen
    v_exp_f32 v35, v63
    v_add_f32 v31, v31, v33
    v_mfma_f32_32x32x16_bf16 v[72:87], a[152:155], v[192:195], v[72:87]
    ds_read_b64_tr_b16 a[164:165], v18 offset:20480
    v_cvt_pk_bf16_f32 v146, v32, v33
    v_exp_f32 v32, v64
    v_mfma_f32_32x32x16_bf16 v[72:87], a[156:159], v[196:199], v[72:87]
    ds_read_b64_tr_b16 a[166:167], v18 offset:22528
    v_add_f32 v30, v30, v34
    v_exp_f32 v33, v65
    v_add_f32 v31, v31, v35
    v_mfma_f32_32x32x16_bf16 v[88:103], a[128:131], v[200:203], v[120:135]
    ds_read_b64_tr_b16 a[172:173], v19 offset:20480
    ds_read_b64_tr_b16 a[174:175], v19 offset:22528
    global_load_dword v248, v[246:247], off
    v_cvt_pk_bf16_f32 v147, v34, v35
    v_mfma_f32_32x32x16_bf16 v[88:103], a[132:135], v[204:207], v[88:103]
    ds_read_b64_tr_b16 a[180:181], v20 offset:20480
    v_exp_f32 v34, v66
    v_add_f32 v30, v30, v32
    v_exp_f32 v35, v67
    v_mfma_f32_32x32x16_bf16 v[88:103], a[136:139], v[208:211], v[88:103]
    ds_read_b64_tr_b16 a[182:183], v20 offset:22528
    v_add_f32 v31, v31, v33
    v_cvt_pk_bf16_f32 v148, v32, v33
    v_exp_f32 v32, v68
    v_mfma_f32_32x32x16_bf16 v[88:103], a[140:143], v[212:215], v[88:103]
    ds_read_b64_tr_b16 a[188:189], v21 offset:20480
    buffer_load_dwordx4 v25, s[8:11], s29 offen offset:3072 lds
    v_add_f32 v30, v30, v34
    v_mfma_f32_32x32x16_bf16 v[88:103], a[144:147], v[216:219], v[88:103]
    ds_read_b64_tr_b16 a[190:191], v21 offset:22528
    v_exp_f32 v33, v69
    v_add_f32 v31, v31, v35
    v_cvt_pk_bf16_f32 v149, v34, v35
    v_mfma_f32_32x32x16_bf16 v[88:103], a[148:151], v[220:223], v[88:103]
    s_add_u32 s29, s29, 16384
    v_exp_f32 v34, v70
    v_add_f32 v30, v30, v32
    v_mfma_f32_32x32x16_bf16 v[88:103], a[152:155], v[224:227], v[88:103]
    s_min_u32 s29, s29, 507904
    v_exp_f32 v35, v71
    v_add_f32 v31, v31, v33
    v_cvt_pk_bf16_f32 v150, v32, v33
    v_mfma_f32_32x32x16_bf16 v[88:103], a[156:159], v[228:231], v[88:103]
    s_nop 0
    v_add_f32 v30, v30, v34
    v_add_f32 v31, v31, v35
    v_cvt_pk_bf16_f32 v151, v34, v35
    s_waitcnt lgkmcnt(0)
    v_mfma_f32_32x32x16_bf16 a[0:15], a[160:163], v[136:139], a[0:15]
    ds_read_b128 a[128:131], v10 offset:32768
    v_exp_f32 v32, v72
    v_exp_f32 v33, v73
    v_mfma_f32_32x32x16_bf16 a[64:79], a[160:163], v[144:147], a[64:79]
    ds_read_b128 a[132:135], v11 offset:32768
    s_add_u32 m0, s28, 65536
    v_exp_f32 v34, v74
    v_add_f32 v28, v28, v32
    v_mfma_f32_32x32x16_bf16 a[16:31], a[168:171], v[136:139], a[16:31]
    buffer_load_dwordx4 v26, s[12:15], s30 offen offset:0 lds
    v_exp_f32 v35, v75
    v_add_f32 v29, v29, v33
    v_mfma_f32_32x32x16_bf16 a[80:95], a[168:171], v[144:147], a[80:95]
    ds_read_b128 a[136:139], v12 offset:32768
    v_cvt_pk_bf16_f32 v152, v32, v33
    v_exp_f32 v32, v76
    v_add_f32 v28, v28, v34
    v_mfma_f32_32x32x16_bf16 a[32:47], a[176:179], v[136:139], a[32:47]
    ds_read_b128 a[140:143], v13 offset:32768
    v_exp_f32 v33, v77
    v_add_f32 v29, v29, v35
    v_mfma_f32_32x32x16_bf16 a[96:111], a[176:179], v[144:147], a[96:111]
    buffer_load_dwordx4 v26, s[12:15], s30 offen offset:1024 lds
    v_cvt_pk_bf16_f32 v153, v34, v35
    v_exp_f32 v34, v78
    v_add_f32 v28, v28, v32
    v_mfma_f32_32x32x16_bf16 a[48:63], a[184:187], v[136:139], a[48:63]
    ds_read_b128 a[144:147], v14 offset:32768
    v_exp_f32 v35, v79
    v_add_f32 v29, v29, v33
    v_mfma_f32_32x32x16_bf16 a[112:127], a[184:187], v[144:147], a[112:127]
    ds_read_b128 a[148:151], v15 offset:32768
    v_cvt_pk_bf16_f32 v154, v32, v33
    v_exp_f32 v32, v80
    v_add_f32 v28, v28, v34
    v_mfma_f32_32x32x16_bf16 a[0:15], a[164:167], v[140:143], a[0:15]
    buffer_load_dwordx4 v26, s[12:15], s30 offen offset:2048 lds
    v_exp_f32 v33, v81
    v_add_f32 v29, v29, v35
    v_mfma_f32_32x32x16_bf16 a[64:79], a[164:167], v[148:151], a[64:79]
    ds_read_b128 a[152:155], v16 offset:32768
    v_cvt_pk_bf16_f32 v155, v34, v35
    v_exp_f32 v34, v82
    v_add_f32 v28, v28, v32
    v_mfma_f32_32x32x16_bf16 a[16:31], a[172:175], v[140:143], a[16:31]
    ds_read_b128 a[156:159], v17 offset:32768
    v_exp_f32 v35, v83
    v_add_f32 v29, v29, v33
    v_mfma_f32_32x32x16_bf16 a[80:95], a[172:175], v[148:151], a[80:95]
    buffer_load_dwordx4 v26, s[12:15], s30 offen offset:3072 lds
    v_cvt_pk_bf16_f32 v156, v32, v33
    v_exp_f32 v32, v84
    v_add_f32 v28, v28, v34
    v_mfma_f32_32x32x16_bf16 a[32:47], a[180:183], v[140:143], a[32:47]
    v_exp_f32 v33, v85
    v_add_f32 v29, v29, v35
    v_cvt_pk_bf16_f32 v157, v34, v35
    v_mfma_f32_32x32x16_bf16 a[96:111], a[180:183], v[148:151], a[96:111]
    s_add_u32 s30, s30, 16384
    v_exp_f32 v34, v86
    v_add_f32 v28, v28, v32
    v_exp_f32 v35, v87
    v_mfma_f32_32x32x16_bf16 a[48:63], a[188:191], v[140:143], a[48:63]
    s_min_u32 s30, s30, 507904
    v_add_f32 v29, v29, v33
    v_cvt_pk_bf16_f32 v158, v32, v33
    v_mfma_f32_32x32x16_bf16 a[112:127], a[188:191], v[148:151], a[112:127]
    v_exp_f32 v32, v88
    v_add_f32 v28, v28, v34
    v_exp_f32 v33, v89
    s_waitcnt lgkmcnt(0)
    v_mfma_f32_32x32x16_bf16 v[40:55], a[128:131], v[168:171], v[104:119]
    ds_read_b64_tr_b16 a[160:161], v18 offset:24576
    ds_read_b64_tr_b16 a[162:163], v18 offset:26624
    v_add_f32 v29, v29, v35
    v_cvt_pk_bf16_f32 v159, v34, v35
    v_mfma_f32_32x32x16_bf16 v[40:55], a[132:135], v[172:175], v[40:55]
    ds_read_b64_tr_b16 a[168:169], v19 offset:24576
    v_exp_f32 v34, v90
    v_add_f32 v30, v30, v32
    v_mfma_f32_32x32x16_bf16 v[40:55], a[136:139], v[176:179], v[40:55]
    ds_read_b64_tr_b16 a[170:171], v19 offset:26624
    v_exp_f32 v35, v91
    v_add_f32 v31, v31, v33
    v_cvt_pk_bf16_f32 v160, v32, v33
    v_mfma_f32_32x32x16_bf16 v[40:55], a[140:143], v[180:183], v[40:55]
    ds_read_b64_tr_b16 a[176:177], v20 offset:24576
    v_exp_f32 v32, v92
    v_add_f32 v30, v30, v34
    v_mfma_f32_32x32x16_bf16 v[40:55], a[144:147], v[184:187], v[40:55]
    ds_read_b64_tr_b16 a[178:179], v20 offset:26624
    ds_read_b64_tr_b16 a[184:185], v21 offset:24576
    v_exp_f32 v33, v93
    v_add_f32 v31, v31, v35
    v_mfma_f32_32x32x16_bf16 v[40:55], a[148:151], v[188:191], v[40:55]
    ds_read_b64_tr_b16 a[186:187], v21 offset:26624
    v_cvt_pk_bf16_f32 v161, v34, v35
    v_exp_f32 v34, v94
    v_mfma_f32_32x32x16_bf16 v[40:55], a[152:155], v[192:195], v[40:55]
    ds_read_b64_tr_b16 a[164:165], v18 offset:28672
    v_add_f32 v30, v30, v32
    v_exp_f32 v35, v95
    v_add_f32 v31, v31, v33
    v_mfma_f32_32x32x16_bf16 v[40:55], a[156:159], v[196:199], v[40:55]
    ds_read_b64_tr_b16 a[166:167], v18 offset:30720
    v_cvt_pk_bf16_f32 v162, v32, v33
    v_exp_f32 v32, v96
    v_mfma_f32_32x32x16_bf16 v[56:71], a[128:131], v[200:203], v[120:135]
    ds_read_b64_tr_b16 a[172:173], v19 offset:28672
    ds_read_b64_tr_b16 a[174:175], v19 offset:30720
    v_add_f32 v30, v30, v34
    v_exp_f32 v33, v97
    v_mfma_f32_32x32x16_bf16 v[56:71], a[132:135], v[204:207], v[56:71]
    ds_read_b64_tr_b16 a[180:181], v20 offset:28672
    v_add_f32 v31, v31, v35
    v_cvt_pk_bf16_f32 v163, v34, v35
    v_exp_f32 v34, v98
    v_mfma_f32_32x32x16_bf16 v[56:71], a[136:139], v[208:211], v[56:71]
    ds_read_b64_tr_b16 a[182:183], v20 offset:30720
    v_add_f32 v30, v30, v32
    v_exp_f32 v35, v99
    v_mfma_f32_32x32x16_bf16 v[56:71], a[140:143], v[212:215], v[56:71]
    ds_read_b64_tr_b16 a[188:189], v21 offset:28672
    v_add_f32 v31, v31, v33
    v_cvt_pk_bf16_f32 v164, v32, v33
    v_exp_f32 v32, v100
    v_mfma_f32_32x32x16_bf16 v[56:71], a[144:147], v[216:219], v[56:71]
    ds_read_b64_tr_b16 a[190:191], v21 offset:30720
    v_add_f32 v30, v30, v34
    v_exp_f32 v33, v101
    v_mfma_f32_32x32x16_bf16 v[56:71], a[148:151], v[220:223], v[56:71]
    v_add_f32 v31, v31, v35
    v_cvt_pk_bf16_f32 v165, v34, v35
    v_exp_f32 v34, v102
    v_mfma_f32_32x32x16_bf16 v[56:71], a[152:155], v[224:227], v[56:71]
    v_add_f32 v30, v30, v32
    v_exp_f32 v35, v103
    v_add_f32 v31, v31, v33
    v_cvt_pk_bf16_f32 v166, v32, v33
    v_mfma_f32_32x32x16_bf16 v[56:71], a[156:159], v[228:231], v[56:71]
    s_nop 0
    v_add_f32 v30, v30, v34
    v_add_f32 v31, v31, v35
    v_cvt_pk_bf16_f32 v167, v34, v35
    s_waitcnt lgkmcnt(0)
    v_mfma_f32_32x32x16_bf16 a[0:15], a[160:163], v[152:155], a[0:15]
    ds_read_b128 a[128:131], v10 offset:40960
    v_exp_f32 v32, v40
    v_exp_f32 v33, v41
    v_mfma_f32_32x32x16_bf16 a[64:79], a[160:163], v[160:163], a[64:79]
    ds_read_b128 a[132:135], v11 offset:40960
    v_exp_f32 v34, v42
    v_add_f32 v28, v28, v32
    v_exp_f32 v35, v43
    v_mfma_f32_32x32x16_bf16 a[16:31], a[168:171], v[152:155], a[16:31]
    v_add_f32 v29, v29, v33
    v_cvt_pk_bf16_f32 v136, v32, v33
    v_exp_f32 v32, v44
    v_mfma_f32_32x32x16_bf16 a[80:95], a[168:171], v[160:163], a[80:95]
    ds_read_b128 a[136:139], v12 offset:40960
    v_add_f32 v28, v28, v34
    v_exp_f32 v33, v45
    v_mfma_f32_32x32x16_bf16 a[32:47], a[176:179], v[152:155], a[32:47]
    ds_read_b128 a[140:143], v13 offset:40960
    v_add_f32 v29, v29, v35
    v_cvt_pk_bf16_f32 v137, v34, v35
    v_exp_f32 v34, v46
    v_mfma_f32_32x32x16_bf16 a[96:111], a[176:179], v[160:163], a[96:111]
    v_add_f32 v28, v28, v32
    v_exp_f32 v35, v47
    v_add_f32 v29, v29, v33
    v_mfma_f32_32x32x16_bf16 a[48:63], a[184:187], v[152:155], a[48:63]
    ds_read_b128 a[144:147], v14 offset:40960
    v_cvt_pk_bf16_f32 v138, v32, v33
    v_exp_f32 v32, v48
    v_add_f32 v28, v28, v34
    v_mfma_f32_32x32x16_bf16 a[112:127], a[184:187], v[160:163], a[112:127]
    ds_read_b128 a[148:151], v15 offset:40960
    v_exp_f32 v33, v49
    v_add_f32 v29, v29, v35
    v_mfma_f32_32x32x16_bf16 a[0:15], a[164:167], v[156:159], a[0:15]
    v_cvt_pk_bf16_f32 v139, v34, v35
    v_exp_f32 v34, v50
    v_add_f32 v28, v28, v32
    v_exp_f32 v35, v51
    v_mfma_f32_32x32x16_bf16 a[64:79], a[164:167], v[164:167], a[64:79]
    ds_read_b128 a[152:155], v16 offset:40960
    v_add_f32 v29, v29, v33
    v_cvt_pk_bf16_f32 v140, v32, v33
    v_mfma_f32_32x32x16_bf16 a[16:31], a[172:175], v[156:159], a[16:31]
    ds_read_b128 a[156:159], v17 offset:40960
    v_exp_f32 v32, v52
    v_add_f32 v28, v28, v34
    v_exp_f32 v33, v53
    v_mfma_f32_32x32x16_bf16 a[80:95], a[172:175], v[164:167], a[80:95]
    v_add_f32 v29, v29, v35
    v_cvt_pk_bf16_f32 v141, v34, v35
    v_exp_f32 v34, v54
    v_mfma_f32_32x32x16_bf16 a[32:47], a[180:183], v[156:159], a[32:47]
    v_add_f32 v28, v28, v32
    v_exp_f32 v35, v55
    v_add_f32 v29, v29, v33
    v_mfma_f32_32x32x16_bf16 a[96:111], a[180:183], v[164:167], a[96:111]
    v_cvt_pk_bf16_f32 v142, v32, v33
    v_exp_f32 v32, v56
    v_add_f32 v28, v28, v34
    v_exp_f32 v33, v57
    v_mfma_f32_32x32x16_bf16 a[48:63], a[188:191], v[156:159], a[48:63]
    v_add_f32 v29, v29, v35
    v_cvt_pk_bf16_f32 v143, v34, v35
    v_exp_f32 v34, v58
    v_mfma_f32_32x32x16_bf16 a[112:127], a[188:191], v[164:167], a[112:127]
    v_add_f32 v30, v30, v32
    s_waitcnt lgkmcnt(0)
    s_waitcnt vmcnt(16)
    s_barrier
    v_mfma_f32_32x32x16_bf16 v[72:87], a[128:131], v[168:171], v[104:119]
    ds_read_b64_tr_b16 a[160:161], v18 offset:32768
    ds_read_b64_tr_b16 a[162:163], v18 offset:34816
    v_exp_f32 v35, v59
    v_add_f32 v31, v31, v33
    v_mfma_f32_32x32x16_bf16 v[72:87], a[132:135], v[172:175], v[72:87]
    ds_read_b64_tr_b16 a[168:169], v19 offset:32768
    s_add_u32 m0, s28, 32768
    v_cvt_pk_bf16_f32 v144, v32, v33
    v_exp_f32 v32, v60
    v_mfma_f32_32x32x16_bf16 v[72:87], a[136:139], v[176:179], v[72:87]
    ds_read_b64_tr_b16 a[170:171], v19 offset:34816
    buffer_load_dwordx4 v22, s[8:11], s29 offen offset:0 lds
    v_add_f32 v30, v30, v34
    v_exp_f32 v33, v61
    v_mfma_f32_32x32x16_bf16 v[72:87], a[140:143], v[180:183], v[72:87]
    ds_read_b64_tr_b16 a[176:177], v20 offset:32768
    v_add_f32 v31, v31, v35
    v_cvt_pk_bf16_f32 v145, v34, v35
    v_mfma_f32_32x32x16_bf16 v[72:87], a[144:147], v[184:187], v[72:87]
    ds_read_b64_tr_b16 a[178:179], v20 offset:34816
    ds_read_b64_tr_b16 a[184:185], v21 offset:32768
    v_exp_f32 v34, v62
    v_add_f32 v30, v30, v32
    v_mfma_f32_32x32x16_bf16 v[72:87], a[148:151], v[188:191], v[72:87]
    ds_read_b64_tr_b16 a[186:187], v21 offset:34816
    buffer_load_dwordx4 v23, s[8:11], s29 offen offset:1024 lds
    v_exp_f32 v35, v63
    v_add_f32 v31, v31, v33
    v_mfma_f32_32x32x16_bf16 v[72:87], a[152:155], v[192:195], v[72:87]
    ds_read_b64_tr_b16 a[164:165], v18 offset:36864
    v_cvt_pk_bf16_f32 v146, v32, v33
    v_exp_f32 v32, v64
    v_mfma_f32_32x32x16_bf16 v[72:87], a[156:159], v[196:199], v[72:87]
    ds_read_b64_tr_b16 a[166:167], v18 offset:38912
    v_add_f32 v30, v30, v34
    v_exp_f32 v33, v65
    v_add_f32 v31, v31, v35
    v_mfma_f32_32x32x16_bf16 v[88:103], a[128:131], v[200:203], v[120:135]
    ds_read_b64_tr_b16 a[172:173], v19 offset:36864
    ds_read_b64_tr_b16 a[174:175], v19 offset:38912
    buffer_load_dwordx4 v24, s[8:11], s29 offen offset:2048 lds
    v_cvt_pk_bf16_f32 v147, v34, v35
    v_mfma_f32_32x32x16_bf16 v[88:103], a[132:135], v[204:207], v[88:103]
    ds_read_b64_tr_b16 a[180:181], v20 offset:36864
    v_exp_f32 v34, v66
    v_add_f32 v30, v30, v32
    v_exp_f32 v35, v67
    v_mfma_f32_32x32x16_bf16 v[88:103], a[136:139], v[208:211], v[88:103]
    ds_read_b64_tr_b16 a[182:183], v20 offset:38912
    v_add_f32 v31, v31, v33
    v_cvt_pk_bf16_f32 v148, v32, v33
    v_exp_f32 v32, v68
    v_mfma_f32_32x32x16_bf16 v[88:103], a[140:143], v[212:215], v[88:103]
    ds_read_b64_tr_b16 a[188:189], v21 offset:36864
    buffer_load_dwordx4 v25, s[8:11], s29 offen offset:3072 lds
    v_add_f32 v30, v30, v34
    v_mfma_f32_32x32x16_bf16 v[88:103], a[144:147], v[216:219], v[88:103]
    ds_read_b64_tr_b16 a[190:191], v21 offset:38912
    v_exp_f32 v33, v69
    v_add_f32 v31, v31, v35
    v_cvt_pk_bf16_f32 v149, v34, v35
    v_mfma_f32_32x32x16_bf16 v[88:103], a[148:151], v[220:223], v[88:103]
    s_add_u32 s29, s29, 16384
    v_exp_f32 v34, v70
    v_add_f32 v30, v30, v32
    v_mfma_f32_32x32x16_bf16 v[88:103], a[152:155], v[224:227], v[88:103]
    s_min_u32 s29, s29, 507904
    v_exp_f32 v35, v71
    v_add_f32 v31, v31, v33
    v_cvt_pk_bf16_f32 v150, v32, v33
    v_mfma_f32_32x32x16_bf16 v[88:103], a[156:159], v[228:231], v[88:103]
    s_nop 0
    v_add_f32 v30, v30, v34
    v_add_f32 v31, v31, v35
    v_cvt_pk_bf16_f32 v151, v34, v35
    s_waitcnt lgkmcnt(0)
    v_mfma_f32_32x32x16_bf16 a[0:15], a[160:163], v[136:139], a[0:15]
    ds_read_b128 a[128:131], v10 offset:49152
    v_exp_f32 v32, v72
    v_exp_f32 v33, v73
    v_mfma_f32_32x32x16_bf16 a[64:79], a[160:163], v[144:147], a[64:79]
    ds_read_b128 a[132:135], v11 offset:49152
    s_add_u32 m0, s28, 81920
    v_exp_f32 v34, v74
    v_add_f32 v28, v28, v32
    v_mfma_f32_32x32x16_bf16 a[16:31], a[168:171], v[136:139], a[16:31]
    buffer_load_dwordx4 v26, s[12:15], s30 offen offset:0 lds
    v_exp_f32 v35, v75
    v_add_f32 v29, v29, v33
    v_mfma_f32_32x32x16_bf16 a[80:95], a[168:171], v[144:147], a[80:95]
    ds_read_b128 a[136:139], v12 offset:49152
    v_cvt_pk_bf16_f32 v152, v32, v33
    v_exp_f32 v32, v76
    v_add_f32 v28, v28, v34
    v_mfma_f32_32x32x16_bf16 a[32:47], a[176:179], v[136:139], a[32:47]
    ds_read_b128 a[140:143], v13 offset:49152
    v_exp_f32 v33, v77
    v_add_f32 v29, v29, v35
    v_mfma_f32_32x32x16_bf16 a[96:111], a[176:179], v[144:147], a[96:111]
    buffer_load_dwordx4 v26, s[12:15], s30 offen offset:1024 lds
    v_cvt_pk_bf16_f32 v153, v34, v35
    v_exp_f32 v34, v78
    v_add_f32 v28, v28, v32
    v_mfma_f32_32x32x16_bf16 a[48:63], a[184:187], v[136:139], a[48:63]
    ds_read_b128 a[144:147], v14 offset:49152
    v_exp_f32 v35, v79
    v_add_f32 v29, v29, v33
    v_mfma_f32_32x32x16_bf16 a[112:127], a[184:187], v[144:147], a[112:127]
    ds_read_b128 a[148:151], v15 offset:49152
    v_cvt_pk_bf16_f32 v154, v32, v33
    v_exp_f32 v32, v80
    v_add_f32 v28, v28, v34
    v_mfma_f32_32x32x16_bf16 a[0:15], a[164:167], v[140:143], a[0:15]
    buffer_load_dwordx4 v26, s[12:15], s30 offen offset:2048 lds
    v_exp_f32 v33, v81
    v_add_f32 v29, v29, v35
    v_mfma_f32_32x32x16_bf16 a[64:79], a[164:167], v[148:151], a[64:79]
    ds_read_b128 a[152:155], v16 offset:49152
    v_cvt_pk_bf16_f32 v155, v34, v35
    v_exp_f32 v34, v82
    v_add_f32 v28, v28, v32
    v_mfma_f32_32x32x16_bf16 a[16:31], a[172:175], v[140:143], a[16:31]
    ds_read_b128 a[156:159], v17 offset:49152
    v_exp_f32 v35, v83
    v_add_f32 v29, v29, v33
    v_mfma_f32_32x32x16_bf16 a[80:95], a[172:175], v[148:151], a[80:95]
    buffer_load_dwordx4 v26, s[12:15], s30 offen offset:3072 lds
    v_cvt_pk_bf16_f32 v156, v32, v33
    v_exp_f32 v32, v84
    v_add_f32 v28, v28, v34
    v_mfma_f32_32x32x16_bf16 a[32:47], a[180:183], v[140:143], a[32:47]
    v_exp_f32 v33, v85
    v_add_f32 v29, v29, v35
    v_cvt_pk_bf16_f32 v157, v34, v35
    v_mfma_f32_32x32x16_bf16 a[96:111], a[180:183], v[148:151], a[96:111]
    s_add_u32 s30, s30, 16384
    v_exp_f32 v34, v86
    v_add_f32 v28, v28, v32
    v_exp_f32 v35, v87
    v_mfma_f32_32x32x16_bf16 a[48:63], a[188:191], v[140:143], a[48:63]
    s_min_u32 s30, s30, 507904
    v_add_f32 v29, v29, v33
    v_cvt_pk_bf16_f32 v158, v32, v33
    v_mfma_f32_32x32x16_bf16 a[112:127], a[188:191], v[148:151], a[112:127]
    v_exp_f32 v32, v88
    v_add_f32 v28, v28, v34
    v_exp_f32 v33, v89
    s_waitcnt lgkmcnt(0)
    v_mfma_f32_32x32x16_bf16 v[40:55], a[128:131], v[168:171], v[104:119]
    ds_read_b64_tr_b16 a[160:161], v18 offset:40960
    ds_read_b64_tr_b16 a[162:163], v18 offset:43008
    v_add_f32 v29, v29, v35
    v_cvt_pk_bf16_f32 v159, v34, v35
    v_mfma_f32_32x32x16_bf16 v[40:55], a[132:135], v[172:175], v[40:55]
    ds_read_b64_tr_b16 a[168:169], v19 offset:40960
    v_exp_f32 v34, v90
    v_add_f32 v30, v30, v32
    v_mfma_f32_32x32x16_bf16 v[40:55], a[136:139], v[176:179], v[40:55]
    ds_read_b64_tr_b16 a[170:171], v19 offset:43008
    v_exp_f32 v35, v91
    v_add_f32 v31, v31, v33
    v_cvt_pk_bf16_f32 v160, v32, v33
    v_mfma_f32_32x32x16_bf16 v[40:55], a[140:143], v[180:183], v[40:55]
    ds_read_b64_tr_b16 a[176:177], v20 offset:40960
    v_exp_f32 v32, v92
    v_add_f32 v30, v30, v34
    v_mfma_f32_32x32x16_bf16 v[40:55], a[144:147], v[184:187], v[40:55]
    ds_read_b64_tr_b16 a[178:179], v20 offset:43008
    ds_read_b64_tr_b16 a[184:185], v21 offset:40960
    v_exp_f32 v33, v93
    v_add_f32 v31, v31, v35
    v_mfma_f32_32x32x16_bf16 v[40:55], a[148:151], v[188:191], v[40:55]
    ds_read_b64_tr_b16 a[186:187], v21 offset:43008
    v_cvt_pk_bf16_f32 v161, v34, v35
    v_exp_f32 v34, v94
    v_mfma_f32_32x32x16_bf16 v[40:55], a[152:155], v[192:195], v[40:55]
    ds_read_b64_tr_b16 a[164:165], v18 offset:45056
    v_add_f32 v30, v30, v32
    v_exp_f32 v35, v95
    v_add_f32 v31, v31, v33
    v_mfma_f32_32x32x16_bf16 v[40:55], a[156:159], v[196:199], v[40:55]
    ds_read_b64_tr_b16 a[166:167], v18 offset:47104
    v_cvt_pk_bf16_f32 v162, v32, v33
    v_exp_f32 v32, v96
    v_mfma_f32_32x32x16_bf16 v[56:71], a[128:131], v[200:203], v[120:135]
    ds_read_b64_tr_b16 a[172:173], v19 offset:45056
    ds_read_b64_tr_b16 a[174:175], v19 offset:47104
    v_add_f32 v30, v30, v34
    v_exp_f32 v33, v97
    v_mfma_f32_32x32x16_bf16 v[56:71], a[132:135], v[204:207], v[56:71]
    ds_read_b64_tr_b16 a[180:181], v20 offset:45056
    v_add_f32 v31, v31, v35
    v_cvt_pk_bf16_f32 v163, v34, v35
    v_exp_f32 v34, v98
    v_mfma_f32_32x32x16_bf16 v[56:71], a[136:139], v[208:211], v[56:71]
    ds_read_b64_tr_b16 a[182:183], v20 offset:47104
    v_add_f32 v30, v30, v32
    v_exp_f32 v35, v99
    v_mfma_f32_32x32x16_bf16 v[56:71], a[140:143], v[212:215], v[56:71]
    ds_read_b64_tr_b16 a[188:189], v21 offset:45056
    v_add_f32 v31, v31, v33
    v_cvt_pk_bf16_f32 v164, v32, v33
    v_exp_f32 v32, v100
    v_mfma_f32_32x32x16_bf16 v[56:71], a[144:147], v[216:219], v[56:71]
    ds_read_b64_tr_b16 a[190:191], v21 offset:47104
    v_add_f32 v30, v30, v34
    v_exp_f32 v33, v101
    v_mfma_f32_32x32x16_bf16 v[56:71], a[148:151], v[220:223], v[56:71]
    v_add_f32 v31, v31, v35
    v_cvt_pk_bf16_f32 v165, v34, v35
    v_exp_f32 v34, v102
    v_mfma_f32_32x32x16_bf16 v[56:71], a[152:155], v[224:227], v[56:71]
    v_add_f32 v30, v30, v32
    v_exp_f32 v35, v103
    v_add_f32 v31, v31, v33
    v_cvt_pk_bf16_f32 v166, v32, v33
    v_mfma_f32_32x32x16_bf16 v[56:71], a[156:159], v[228:231], v[56:71]
    s_nop 0
    v_add_f32 v30, v30, v34
    v_add_f32 v31, v31, v35
    v_cvt_pk_bf16_f32 v167, v34, v35
    s_waitcnt lgkmcnt(0)
    v_mfma_f32_32x32x16_bf16 a[0:15], a[160:163], v[152:155], a[0:15]
    ds_read_b128 a[128:131], v10 offset:57344
    v_exp_f32 v32, v40
    v_exp_f32 v33, v41
    v_mfma_f32_32x32x16_bf16 a[64:79], a[160:163], v[160:163], a[64:79]
    ds_read_b128 a[132:135], v11 offset:57344
    v_exp_f32 v34, v42
    v_add_f32 v28, v28, v32
    v_exp_f32 v35, v43
    v_mfma_f32_32x32x16_bf16 a[16:31], a[168:171], v[152:155], a[16:31]
    v_add_f32 v29, v29, v33
    v_cvt_pk_bf16_f32 v136, v32, v33
    v_exp_f32 v32, v44
    v_mfma_f32_32x32x16_bf16 a[80:95], a[168:171], v[160:163], a[80:95]
    ds_read_b128 a[136:139], v12 offset:57344
    v_add_f32 v28, v28, v34
    v_exp_f32 v33, v45
    v_mfma_f32_32x32x16_bf16 a[32:47], a[176:179], v[152:155], a[32:47]
    ds_read_b128 a[140:143], v13 offset:57344
    v_add_f32 v29, v29, v35
    v_cvt_pk_bf16_f32 v137, v34, v35
    v_exp_f32 v34, v46
    v_mfma_f32_32x32x16_bf16 a[96:111], a[176:179], v[160:163], a[96:111]
    v_add_f32 v28, v28, v32
    v_exp_f32 v35, v47
    v_add_f32 v29, v29, v33
    v_mfma_f32_32x32x16_bf16 a[48:63], a[184:187], v[152:155], a[48:63]
    ds_read_b128 a[144:147], v14 offset:57344
    v_cvt_pk_bf16_f32 v138, v32, v33
    v_exp_f32 v32, v48
    v_add_f32 v28, v28, v34
    v_mfma_f32_32x32x16_bf16 a[112:127], a[184:187], v[160:163], a[112:127]
    ds_read_b128 a[148:151], v15 offset:57344
    v_exp_f32 v33, v49
    v_add_f32 v29, v29, v35
    v_mfma_f32_32x32x16_bf16 a[0:15], a[164:167], v[156:159], a[0:15]
    v_cvt_pk_bf16_f32 v139, v34, v35
    v_exp_f32 v34, v50
    v_add_f32 v28, v28, v32
    v_exp_f32 v35, v51
    v_mfma_f32_32x32x16_bf16 a[64:79], a[164:167], v[164:167], a[64:79]
    ds_read_b128 a[152:155], v16 offset:57344
    v_add_f32 v29, v29, v33
    v_cvt_pk_bf16_f32 v140, v32, v33
    v_mfma_f32_32x32x16_bf16 a[16:31], a[172:175], v[156:159], a[16:31]
    ds_read_b128 a[156:159], v17 offset:57344
    v_exp_f32 v32, v52
    v_add_f32 v28, v28, v34
    v_exp_f32 v33, v53
    v_mfma_f32_32x32x16_bf16 a[80:95], a[172:175], v[164:167], a[80:95]
    v_add_f32 v29, v29, v35
    v_cvt_pk_bf16_f32 v141, v34, v35
    v_exp_f32 v34, v54
    v_mfma_f32_32x32x16_bf16 a[32:47], a[180:183], v[156:159], a[32:47]
    v_add_f32 v28, v28, v32
    v_exp_f32 v35, v55
    v_add_f32 v29, v29, v33
    v_mfma_f32_32x32x16_bf16 a[96:111], a[180:183], v[164:167], a[96:111]
    v_cvt_pk_bf16_f32 v142, v32, v33
    v_exp_f32 v32, v56
    v_add_f32 v28, v28, v34
    v_exp_f32 v33, v57
    v_mfma_f32_32x32x16_bf16 a[48:63], a[188:191], v[156:159], a[48:63]
    v_add_f32 v29, v29, v35
    v_cvt_pk_bf16_f32 v143, v34, v35
    v_exp_f32 v34, v58
    v_mfma_f32_32x32x16_bf16 a[112:127], a[188:191], v[164:167], a[112:127]
    v_add_f32 v30, v30, v32
    s_waitcnt lgkmcnt(0)
    s_waitcnt vmcnt(16)
    s_barrier
    v_mfma_f32_32x32x16_bf16 v[72:87], a[128:131], v[168:171], v[104:119]
    ds_read_b64_tr_b16 a[160:161], v18 offset:49152
    ds_read_b64_tr_b16 a[162:163], v18 offset:51200
    v_exp_f32 v35, v59
    v_add_f32 v31, v31, v33
    v_mfma_f32_32x32x16_bf16 v[72:87], a[132:135], v[172:175], v[72:87]
    ds_read_b64_tr_b16 a[168:169], v19 offset:49152
    s_add_u32 m0, s28, 49152
    v_cvt_pk_bf16_f32 v144, v32, v33
    v_exp_f32 v32, v60
    v_mfma_f32_32x32x16_bf16 v[72:87], a[136:139], v[176:179], v[72:87]
    ds_read_b64_tr_b16 a[170:171], v19 offset:51200
    buffer_load_dwordx4 v22, s[8:11], s29 offen offset:0 lds
    v_add_f32 v30, v30, v34
    v_exp_f32 v33, v61
    v_mfma_f32_32x32x16_bf16 v[72:87], a[140:143], v[180:183], v[72:87]
    ds_read_b64_tr_b16 a[176:177], v20 offset:49152
    v_add_f32 v31, v31, v35
    v_cvt_pk_bf16_f32 v145, v34, v35
    v_mfma_f32_32x32x16_bf16 v[72:87], a[144:147], v[184:187], v[72:87]
    ds_read_b64_tr_b16 a[178:179], v20 offset:51200
    ds_read_b64_tr_b16 a[184:185], v21 offset:49152
    v_exp_f32 v34, v62
    v_add_f32 v30, v30, v32
    v_mfma_f32_32x32x16_bf16 v[72:87], a[148:151], v[188:191], v[72:87]
    ds_read_b64_tr_b16 a[186:187], v21 offset:51200
    buffer_load_dwordx4 v23, s[8:11], s29 offen offset:1024 lds
    v_exp_f32 v35, v63
    v_add_f32 v31, v31, v33
    v_mfma_f32_32x32x16_bf16 v[72:87], a[152:155], v[192:195], v[72:87]
    ds_read_b64_tr_b16 a[164:165], v18 offset:53248
    v_cvt_pk_bf16_f32 v146, v32, v33
    v_exp_f32 v32, v64
    v_mfma_f32_32x32x16_bf16 v[72:87], a[156:159], v[196:199], v[72:87]
    ds_read_b64_tr_b16 a[166:167], v18 offset:55296
    v_add_f32 v30, v30, v34
    v_exp_f32 v33, v65
    v_add_f32 v31, v31, v35
    v_mfma_f32_32x32x16_bf16 v[88:103], a[128:131], v[200:203], v[120:135]
    ds_read_b64_tr_b16 a[172:173], v19 offset:53248
    ds_read_b64_tr_b16 a[174:175], v19 offset:55296
    buffer_load_dwordx4 v24, s[8:11], s29 offen offset:2048 lds
    v_cvt_pk_bf16_f32 v147, v34, v35
    v_mfma_f32_32x32x16_bf16 v[88:103], a[132:135], v[204:207], v[88:103]
    ds_read_b64_tr_b16 a[180:181], v20 offset:53248
    v_exp_f32 v34, v66
    v_add_f32 v30, v30, v32
    v_exp_f32 v35, v67
    v_mfma_f32_32x32x16_bf16 v[88:103], a[136:139], v[208:211], v[88:103]
    ds_read_b64_tr_b16 a[182:183], v20 offset:55296
    v_add_f32 v31, v31, v33
    v_cvt_pk_bf16_f32 v148, v32, v33
    v_exp_f32 v32, v68
    v_mfma_f32_32x32x16_bf16 v[88:103], a[140:143], v[212:215], v[88:103]
    ds_read_b64_tr_b16 a[188:189], v21 offset:53248
    buffer_load_dwordx4 v25, s[8:11], s29 offen offset:3072 lds
    v_add_f32 v30, v30, v34
    v_mfma_f32_32x32x16_bf16 v[88:103], a[144:147], v[216:219], v[88:103]
    ds_read_b64_tr_b16 a[190:191], v21 offset:55296
    v_exp_f32 v33, v69
    v_add_f32 v31, v31, v35
    v_cvt_pk_bf16_f32 v149, v34, v35
    v_mfma_f32_32x32x16_bf16 v[88:103], a[148:151], v[220:223], v[88:103]
    s_add_u32 s29, s29, 16384
    v_exp_f32 v34, v70
    v_add_f32 v30, v30, v32
    v_mfma_f32_32x32x16_bf16 v[88:103], a[152:155], v[224:227], v[88:103]
    s_min_u32 s29, s29, 507904
    v_exp_f32 v35, v71
    v_add_f32 v31, v31, v33
    v_cvt_pk_bf16_f32 v150, v32, v33
    v_mfma_f32_32x32x16_bf16 v[88:103], a[156:159], v[228:231], v[88:103]
    s_nop 0
    v_add_f32 v30, v30, v34
    v_add_f32 v31, v31, v35
    v_cvt_pk_bf16_f32 v151, v34, v35
    s_waitcnt lgkmcnt(0)
    v_mfma_f32_32x32x16_bf16 a[0:15], a[160:163], v[136:139], a[0:15]
    v_exp_f32 v32, v72
    v_exp_f32 v33, v73
    v_exp_f32 v34, v74
    v_add_f32 v28, v28, v32
    v_exp_f32 v35, v75
    v_mfma_f32_32x32x16_bf16 a[64:79], a[160:163], v[144:147], a[64:79]
    v_add_f32 v29, v29, v33
    v_cvt_pk_bf16_f32 v152, v32, v33
    v_exp_f32 v32, v76
    v_add_f32 v28, v28, v34
    v_exp_f32 v33, v77
    v_add_f32 v29, v29, v35
    v_mfma_f32_32x32x16_bf16 a[16:31], a[168:171], v[136:139], a[16:31]
    v_cvt_pk_bf16_f32 v153, v34, v35
    v_exp_f32 v34, v78
    v_add_f32 v28, v28, v32
    v_exp_f32 v35, v79
    v_add_f32 v29, v29, v33
    v_cvt_pk_bf16_f32 v154, v32, v33
    v_mfma_f32_32x32x16_bf16 a[80:95], a[168:171], v[144:147], a[80:95]
    v_exp_f32 v32, v80
    v_add_f32 v28, v28, v34
    v_exp_f32 v33, v81
    v_add_f32 v29, v29, v35
    v_cvt_pk_bf16_f32 v155, v34, v35
    v_exp_f32 v34, v82
    v_mfma_f32_32x32x16_bf16 a[32:47], a[176:179], v[136:139], a[32:47]
    v_add_f32 v28, v28, v32
    v_exp_f32 v35, v83
    v_add_f32 v29, v29, v33
    v_cvt_pk_bf16_f32 v156, v32, v33
    v_exp_f32 v32, v84
    v_mfma_f32_32x32x16_bf16 a[96:111], a[176:179], v[144:147], a[96:111]
    v_add_f32 v28, v28, v34
    v_exp_f32 v33, v85
    v_add_f32 v29, v29, v35
    v_cvt_pk_bf16_f32 v157, v34, v35
    v_exp_f32 v34, v86
    v_add_f32 v28, v28, v32
    v_mfma_f32_32x32x16_bf16 a[48:63], a[184:187], v[136:139], a[48:63]
    v_exp_f32 v35, v87
    v_add_f32 v29, v29, v33
    v_cvt_pk_bf16_f32 v158, v32, v33
    v_exp_f32 v32, v88
    v_add_f32 v28, v28, v34
    v_exp_f32 v33, v89
    v_mfma_f32_32x32x16_bf16 a[112:127], a[184:187], v[144:147], a[112:127]
    v_add_f32 v29, v29, v35
    v_cvt_pk_bf16_f32 v159, v34, v35
    v_exp_f32 v34, v90
    v_add_f32 v30, v30, v32
    v_exp_f32 v35, v91
    v_mfma_f32_32x32x16_bf16 a[0:15], a[164:167], v[140:143], a[0:15]
    v_add_f32 v31, v31, v33
    v_cvt_pk_bf16_f32 v160, v32, v33
    v_exp_f32 v32, v92
    v_add_f32 v30, v30, v34
    v_exp_f32 v33, v93
    v_add_f32 v31, v31, v35
    v_mfma_f32_32x32x16_bf16 a[64:79], a[164:167], v[148:151], a[64:79]
    v_cvt_pk_bf16_f32 v161, v34, v35
    v_exp_f32 v34, v94
    v_add_f32 v30, v30, v32
    v_exp_f32 v35, v95
    v_add_f32 v31, v31, v33
    v_cvt_pk_bf16_f32 v162, v32, v33
    v_mfma_f32_32x32x16_bf16 a[16:31], a[172:175], v[140:143], a[16:31]
    v_exp_f32 v32, v96
    v_add_f32 v30, v30, v34
    v_exp_f32 v33, v97
    v_add_f32 v31, v31, v35
    v_cvt_pk_bf16_f32 v163, v34, v35
    v_exp_f32 v34, v98
    v_mfma_f32_32x32x16_bf16 a[80:95], a[172:175], v[148:151], a[80:95]
    v_add_f32 v30, v30, v32
    v_exp_f32 v35, v99
    v_add_f32 v31, v31, v33
    v_cvt_pk_bf16_f32 v164, v32, v33
    v_exp_f32 v32, v100
    v_mfma_f32_32x32x16_bf16 a[32:47], a[180:183], v[140:143], a[32:47]
    v_add_f32 v30, v30, v34
    v_exp_f32 v33, v101
    v_add_f32 v31, v31, v35
    v_cvt_pk_bf16_f32 v165, v34, v35
    v_exp_f32 v34, v102
    v_add_f32 v30, v30, v32
    v_mfma_f32_32x32x16_bf16 a[96:111], a[180:183], v[148:151], a[96:111]
    v_exp_f32 v35, v103
    v_add_f32 v31, v31, v33
    v_cvt_pk_bf16_f32 v166, v32, v33
    s_nop 0
    v_add_f32 v30, v30, v34
    v_add_f32 v31, v31, v35
    v_cvt_pk_bf16_f32 v167, v34, v35
    v_mfma_f32_32x32x16_bf16 a[48:63], a[188:191], v[140:143], a[48:63]
    v_mfma_f32_32x32x16_bf16 a[112:127], a[188:191], v[148:151], a[112:127]
    ds_read_b64_tr_b16 a[160:161], v18 offset:57344
    ds_read_b64_tr_b16 a[162:163], v18 offset:59392
    ds_read_b64_tr_b16 a[168:169], v19 offset:57344
    ds_read_b64_tr_b16 a[170:171], v19 offset:59392
    ds_read_b64_tr_b16 a[176:177], v20 offset:57344
    ds_read_b64_tr_b16 a[178:179], v20 offset:59392
    ds_read_b64_tr_b16 a[184:185], v21 offset:57344
    ds_read_b64_tr_b16 a[186:187], v21 offset:59392
    ds_read_b64_tr_b16 a[164:165], v18 offset:61440
    ds_read_b64_tr_b16 a[166:167], v18 offset:63488
    ds_read_b64_tr_b16 a[172:173], v19 offset:61440
    ds_read_b64_tr_b16 a[174:175], v19 offset:63488
    ds_read_b64_tr_b16 a[180:181], v20 offset:61440
    ds_read_b64_tr_b16 a[182:183], v20 offset:63488
    ds_read_b64_tr_b16 a[188:189], v21 offset:61440
    ds_read_b64_tr_b16 a[190:191], v21 offset:63488
    s_waitcnt lgkmcnt(0)
    v_mfma_f32_32x32x16_bf16 a[0:15], a[160:163], v[152:155], a[0:15]
    v_mfma_f32_32x32x16_bf16 a[64:79], a[160:163], v[160:163], a[64:79]
    v_mfma_f32_32x32x16_bf16 a[16:31], a[168:171], v[152:155], a[16:31]
    v_mfma_f32_32x32x16_bf16 a[80:95], a[168:171], v[160:163], a[80:95]
    v_mfma_f32_32x32x16_bf16 a[32:47], a[176:179], v[152:155], a[32:47]
    v_mfma_f32_32x32x16_bf16 a[96:111], a[176:179], v[160:163], a[96:111]
    v_mfma_f32_32x32x16_bf16 a[48:63], a[184:187], v[152:155], a[48:63]
    v_mfma_f32_32x32x16_bf16 a[112:127], a[184:187], v[160:163], a[112:127]
    v_mfma_f32_32x32x16_bf16 a[0:15], a[164:167], v[156:159], a[0:15]
    v_mfma_f32_32x32x16_bf16 a[64:79], a[164:167], v[164:167], a[64:79]
    v_mfma_f32_32x32x16_bf16 a[16:31], a[172:175], v[156:159], a[16:31]
    v_mfma_f32_32x32x16_bf16 a[80:95], a[172:175], v[164:167], a[80:95]
    v_mfma_f32_32x32x16_bf16 a[32:47], a[180:183], v[156:159], a[32:47]
    v_mfma_f32_32x32x16_bf16 a[96:111], a[180:183], v[164:167], a[96:111]
    v_mfma_f32_32x32x16_bf16 a[48:63], a[188:191], v[156:159], a[48:63]
    v_mfma_f32_32x32x16_bf16 a[112:127], a[188:191], v[164:167], a[112:127]
    v_add_f32 v28, v28, v29
    v_add_f32 v30, v30, v31
    v_mov_b32 v29, v28
    v_mov_b32 v31, v30
    s_nop 1
    v_permlane32_swap_b32 v28, v29
    v_permlane32_swap_b32 v30, v31
    s_nop 1
    v_add_f32 v28, v28, v29
    v_add_f32 v30, v30, v31
    v_max_f32 v2, v28, v30
    v_mov_b32 v3, 0x53800000
    v_cmp_nlt_f32 vcc, v2, v3
    v_cmp_u_f32 s[50:51], v28, v30
    s_nop 1
    s_or_b64 vcc, vcc, s[50:51]
    s_cbranch_vccz L_at_ok
    v_mov_b32 v2, 1
    v_mov_b32 v3, 131072
    ds_write_b32 v3, v2
L_at_ok:
    s_waitcnt lgkmcnt(0) vmcnt(0)
    s_barrier
    v_mov_b32 v3, 131072
    ds_read_b32 v2, v3
    s_waitcnt lgkmcnt(0)
    v_readfirstlane_b32 s50, v2
    s_xor_b32 s51, s33, 1
    s_and_b32 s50, s50, s51
    s_cmp_eq_u32 s50, 1
    s_cbranch_scc1 L_at_redo
    v_rcp_f32 v28, v28
    v_rcp_f32 v30, v30
    v_accvgpr_read_b32 v40, a0
    v_accvgpr_read_b32 v41, a1
    v_accvgpr_read_b32 v42, a2
    v_accvgpr_read_b32 v43, a3
    v_accvgpr_read_b32 v44, a4
    v_accvgpr_read_b32 v45, a5
    v_accvgpr_read_b32 v46, a6
    v_accvgpr_read_b32 v47, a7
    v_pk_mul_f32 v[40:41], v[40:41], v[28:29] op_sel_hi:[1,0]
    v_pk_mul_f32 v[42:43], v[42:43], v[28:29] op_sel_hi:[1,0]
    v_pk_mul_f32 v[44:45], v[44:45], v[28:29] op_sel_hi:[1,0]
    v_pk_mul_f32 v[46:47], v[46:47], v[28:29] op_sel_hi:[1,0]
    v_cvt_pk_bf16_f32 v48, v40, v41
    v_cvt_pk_bf16_f32 v49, v42, v43
    v_cvt_pk_bf16_f32 v50, v44, v45
    v_cvt_pk_bf16_f32 v51, v46, v47
    s_mov_b32 s31, 0
    buffer_store_dwordx4 v[48:51], v240, s[24:27], s31 offen offset:0 sc1
    v_accvgpr_read_b32 v52, a8
    v_accvgpr_read_b32 v53, a9
    v_accvgpr_read_b32 v54, a10
    v_accvgpr_read_b32 v55, a11
    v_accvgpr_read_b32 v56, a12
    v_accvgpr_read_b32 v57, a13
    v_accvgpr_read_b32 v58, a14
    v_accvgpr_read_b32 v59, a15
    v_pk_mul_f32 v[52:53], v[52:53], v[28:29] op_sel_hi:[1,0]
    v_pk_mul_f32 v[54:55], v[54:55], v[28:29] op_sel_hi:[1,0]
    v_pk_mul_f32 v[56:57], v[56:57], v[28:29] op_sel_hi:[1,0]
    v_pk_mul_f32 v[58:59], v[58:59], v[28:29] op_sel_hi:[1,0]
    v_cvt_pk_bf16_f32 v60, v52, v53
    v_cvt_pk_bf16_f32 v61, v54, v55
    v_cvt_pk_bf16_f32 v62, v56, v57
    v_cvt_pk_bf16_f32 v63, v58, v59
    buffer_store_dwordx4 v[60:63], v240, s[24:27], s31 offen offset:1024 sc1
    v_accvgpr_read_b32 v64, a16
    v_accvgpr_read_b32 v65, a17
    v_accvgpr_read_b32 v66, a18
    v_accvgpr_read_b32 v67, a19
    v_accvgpr_read_b32 v68, a20
    v_accvgpr_read_b32 v69, a21
    v_accvgpr_read_b32 v70, a22
    v_accvgpr_read_b32 v71, a23
    v_pk_mul_f32 v[64:65], v[64:65], v[28:29] op_sel_hi:[1,0]
    v_pk_mul_f32 v[66:67], v[66:67], v[28:29] op_sel_hi:[1,0]
    v_pk_mul_f32 v[68:69], v[68:69], v[28:29] op_sel_hi:[1,0]
    v_pk_mul_f32 v[70:71], v[70:71], v[28:29] op_sel_hi:[1,0]
    v_cvt_pk_bf16_f32 v72, v64, v65
    v_cvt_pk_bf16_f32 v73, v66, v67
    v_cvt_pk_bf16_f32 v74, v68, v69
    v_cvt_pk_bf16_f32 v75, v70, v71
    buffer_store_dwordx4 v[72:75], v240, s[24:27], s31 offen offset:2048 sc1
    v_accvgpr_read_b32 v76, a24
    v_accvgpr_read_b32 v77, a25
    v_accvgpr_read_b32 v78, a26
    v_accvgpr_read_b32 v79, a27
    v_accvgpr_read_b32 v80, a28
    v_accvgpr_read_b32 v81, a29
    v_accvgpr_read_b32 v82, a30
    v_accvgpr_read_b32 v83, a31
    v_pk_mul_f32 v[76:77], v[76:77], v[28:29] op_sel_hi:[1,0]
    v_pk_mul_f32 v[78:79], v[78:79], v[28:29] op_sel_hi:[1,0]
    v_pk_mul_f32 v[80:81], v[80:81], v[28:29] op_sel_hi:[1,0]
    v_pk_mul_f32 v[82:83], v[82:83], v[28:29] op_sel_hi:[1,0]
    v_cvt_pk_bf16_f32 v84, v76, v77
    v_cvt_pk_bf16_f32 v85, v78, v79
    v_cvt_pk_bf16_f32 v86, v80, v81
    v_cvt_pk_bf16_f32 v87, v82, v83
    buffer_store_dwordx4 v[84:87], v240, s[24:27], s31 offen offset:3072 sc1
    v_accvgpr_read_b32 v40, a32
    v_accvgpr_read_b32 v41, a33
    v_accvgpr_read_b32 v42, a34
    v_accvgpr_read_b32 v43, a35
    v_accvgpr_read_b32 v44, a36
    v_accvgpr_read_b32 v45, a37
    v_accvgpr_read_b32 v46, a38
    v_accvgpr_read_b32 v47, a39
    v_pk_mul_f32 v[40:41], v[40:41], v[28:29] op_sel_hi:[1,0]
    v_pk_mul_f32 v[42:43], v[42:43], v[28:29] op_sel_hi:[1,0]
    v_pk_mul_f32 v[44:45], v[44:45], v[28:29] op_sel_hi:[1,0]
    v_pk_mul_f32 v[46:47], v[46:47], v[28:29] op_sel_hi:[1,0]
    v_cvt_pk_bf16_f32 v48, v40, v41
    v_cvt_pk_bf16_f32 v49, v42, v43
    v_cvt_pk_bf16_f32 v50, v44, v45
    v_cvt_pk_bf16_f32 v51, v46, v47
    s_mov_b32 s31, 4096
    buffer_store_dwordx4 v[48:51], v240, s[24:27], s31 offen offset:0 sc1
    v_accvgpr_read_b32 v52, a40
    v_accvgpr_read_b32 v53, a41
    v_accvgpr_read_b32 v54, a42
    v_accvgpr_read_b32 v55, a43
    v_accvgpr_read_b32 v56, a44
    v_accvgpr_read_b32 v57, a45
    v_accvgpr_read_b32 v58, a46
    v_accvgpr_read_b32 v59, a47
    v_pk_mul_f32 v[52:53], v[52:53], v[28:29] op_sel_hi:[1,0]
    v_pk_mul_f32 v[54:55], v[54:55], v[28:29] op_sel_hi:[1,0]
    v_pk_mul_f32 v[56:57], v[56:57], v[28:29] op_sel_hi:[1,0]
    v_pk_mul_f32 v[58:59], v[58:59], v[28:29] op_sel_hi:[1,0]
    v_cvt_pk_bf16_f32 v60, v52, v53
    v_cvt_pk_bf16_f32 v61, v54, v55
    v_cvt_pk_bf16_f32 v62, v56, v57
    v_cvt_pk_bf16_f32 v63, v58, v59
    buffer_store_dwordx4 v[60:63], v240, s[24:27], s31 offen offset:1024 sc1
    v_accvgpr_read_b32 v64, a48
    v_accvgpr_read_b32 v65, a49
    v_accvgpr_read_b32 v66, a50
    v_accvgpr_read_b32 v67, a51
    v_accvgpr_read_b32 v68, a52
    v_accvgpr_read_b32 v69, a53
    v_accvgpr_read_b32 v70, a54
    v_accvgpr_read_b32 v71, a55
    v_pk_mul_f32 v[64:65], v[64:65], v[28:29] op_sel_hi:[1,0]
    v_pk_mul_f32 v[66:67], v[66:67], v[28:29] op_sel_hi:[1,0]
    v_pk_mul_f32 v[68:69], v[68:69], v[28:29] op_sel_hi:[1,0]
    v_pk_mul_f32 v[70:71], v[70:71], v[28:29] op_sel_hi:[1,0]
    v_cvt_pk_bf16_f32 v72, v64, v65
    v_cvt_pk_bf16_f32 v73, v66, v67
    v_cvt_pk_bf16_f32 v74, v68, v69
    v_cvt_pk_bf16_f32 v75, v70, v71
    buffer_store_dwordx4 v[72:75], v240, s[24:27], s31 offen offset:2048 sc1
    v_accvgpr_read_b32 v76, a56
    v_accvgpr_read_b32 v77, a57
    v_accvgpr_read_b32 v78, a58
    v_accvgpr_read_b32 v79, a59
    v_accvgpr_read_b32 v80, a60
    v_accvgpr_read_b32 v81, a61
    v_accvgpr_read_b32 v82, a62
    v_accvgpr_read_b32 v83, a63
    v_pk_mul_f32 v[76:77], v[76:77], v[28:29] op_sel_hi:[1,0]
    v_pk_mul_f32 v[78:79], v[78:79], v[28:29] op_sel_hi:[1,0]
    v_pk_mul_f32 v[80:81], v[80:81], v[28:29] op_sel_hi:[1,0]
    v_pk_mul_f32 v[82:83], v[82:83], v[28:29] op_sel_hi:[1,0]
    v_cvt_pk_bf16_f32 v84, v76, v77
    v_cvt_pk_bf16_f32 v85, v78, v79
    v_cvt_pk_bf16_f32 v86, v80, v81
    v_cvt_pk_bf16_f32 v87, v82, v83
    buffer_store_dwordx4 v[84:87], v240, s[24:27], s31 offen offset:3072 sc1
    v_accvgpr_read_b32 v40, a64
    v_accvgpr_read_b32 v41, a65
    v_accvgpr_read_b32 v42, a66
    v_accvgpr_read_b32 v43, a67
    v_accvgpr_read_b32 v44, a68
    v_accvgpr_read_b32 v45, a69
    v_accvgpr_read_b32 v46, a70
    v_accvgpr_read_b32 v47, a71
    v_pk_mul_f32 v[40:41], v[40:41], v[30:31] op_sel_hi:[1,0]
    v_pk_mul_f32 v[42:43], v[42:43], v[30:31] op_sel_hi:[1,0]
    v_pk_mul_f32 v[44:45], v[44:45], v[30:31] op_sel_hi:[1,0]
    v_pk_mul_f32 v[46:47], v[46:47], v[30:31] op_sel_hi:[1,0]
    v_cvt_pk_bf16_f32 v48, v40, v41
    v_cvt_pk_bf16_f32 v49, v42, v43
    v_cvt_pk_bf16_f32 v50, v44, v45
    v_cvt_pk_bf16_f32 v51, v46, v47
    s_mov_b32 s31, 262144
    buffer_store_dwordx4 v[48:51], v240, s[24:27], s31 offen offset:0 sc1
    v_accvgpr_read_b32 v52, a72
    v_accvgpr_read_b32 v53, a73
    v_accvgpr_read_b32 v54, a74
    v_accvgpr_read_b32 v55, a75
    v_accvgpr_read_b32 v56, a76
    v_accvgpr_read_b32 v57, a77
    v_accvgpr_read_b32 v58, a78
    v_accvgpr_read_b32 v59, a79
    v_pk_mul_f32 v[52:53], v[52:53], v[30:31] op_sel_hi:[1,0]
    v_pk_mul_f32 v[54:55], v[54:55], v[30:31] op_sel_hi:[1,0]
    v_pk_mul_f32 v[56:57], v[56:57], v[30:31] op_sel_hi:[1,0]
    v_pk_mul_f32 v[58:59], v[58:59], v[30:31] op_sel_hi:[1,0]
    v_cvt_pk_bf16_f32 v60, v52, v53
    v_cvt_pk_bf16_f32 v61, v54, v55
    v_cvt_pk_bf16_f32 v62, v56, v57
    v_cvt_pk_bf16_f32 v63, v58, v59
    buffer_store_dwordx4 v[60:63], v240, s[24:27], s31 offen offset:1024 sc1
    v_accvgpr_read_b32 v64, a80
    v_accvgpr_read_b32 v65, a81
    v_accvgpr_read_b32 v66, a82
    v_accvgpr_read_b32 v67, a83
    v_accvgpr_read_b32 v68, a84
    v_accvgpr_read_b32 v69, a85
    v_accvgpr_read_b32 v70, a86
    v_accvgpr_read_b32 v71, a87
    v_pk_mul_f32 v[64:65], v[64:65], v[30:31] op_sel_hi:[1,0]
    v_pk_mul_f32 v[66:67], v[66:67], v[30:31] op_sel_hi:[1,0]
    v_pk_mul_f32 v[68:69], v[68:69], v[30:31] op_sel_hi:[1,0]
    v_pk_mul_f32 v[70:71], v[70:71], v[30:31] op_sel_hi:[1,0]
    v_cvt_pk_bf16_f32 v72, v64, v65
    v_cvt_pk_bf16_f32 v73, v66, v67
    v_cvt_pk_bf16_f32 v74, v68, v69
    v_cvt_pk_bf16_f32 v75, v70, v71
    buffer_store_dwordx4 v[72:75], v240, s[24:27], s31 offen offset:2048 sc1
    v_accvgpr_read_b32 v76, a88
    v_accvgpr_read_b32 v77, a89
    v_accvgpr_read_b32 v78, a90
    v_accvgpr_read_b32 v79, a91
    v_accvgpr_read_b32 v80, a92
    v_accvgpr_read_b32 v81, a93
    v_accvgpr_read_b32 v82, a94
    v_accvgpr_read_b32 v83, a95
    v_pk_mul_f32 v[76:77], v[76:77], v[30:31] op_sel_hi:[1,0]
    v_pk_mul_f32 v[78:79], v[78:79], v[30:31] op_sel_hi:[1,0]
    v_pk_mul_f32 v[80:81], v[80:81], v[30:31] op_sel_hi:[1,0]
    v_pk_mul_f32 v[82:83], v[82:83], v[30:31] op_sel_hi:[1,0]
    v_cvt_pk_bf16_f32 v84, v76, v77
    v_cvt_pk_bf16_f32 v85, v78, v79
    v_cvt_pk_bf16_f32 v86, v80, v81
    v_cvt_pk_bf16_f32 v87, v82, v83
    buffer_store_dwordx4 v[84:87], v240, s[24:27], s31 offen offset:3072 sc1
    v_accvgpr_read_b32 v40, a96
    v_accvgpr_read_b32 v41, a97
    v_accvgpr_read_b32 v42, a98
    v_accvgpr_read_b32 v43, a99
    v_accvgpr_read_b32 v44, a100
    v_accvgpr_read_b32 v45, a101
    v_accvgpr_read_b32 v46, a102
    v_accvgpr_read_b32 v47, a103
    v_pk_mul_f32 v[40:41], v[40:41], v[30:31] op_sel_hi:[1,0]
    v_pk_mul_f32 v[42:43], v[42:43], v[30:31] op_sel_hi:[1,0]
    v_pk_mul_f32 v[44:45], v[44:45], v[30:31] op_sel_hi:[1,0]
    v_pk_mul_f32 v[46:47], v[46:47], v[30:31] op_sel_hi:[1,0]
    v_cvt_pk_bf16_f32 v48, v40, v41
    v_cvt_pk_bf16_f32 v49, v42, v43
    v_cvt_pk_bf16_f32 v50, v44, v45
    v_cvt_pk_bf16_f32 v51, v46, v47
    s_mov_b32 s31, 266240
    buffer_store_dwordx4 v[48:51], v240, s[24:27], s31 offen offset:0 sc1
    v_accvgpr_read_b32 v52, a104
    v_accvgpr_read_b32 v53, a105
    v_accvgpr_read_b32 v54, a106
    v_accvgpr_read_b32 v55, a107
    v_accvgpr_read_b32 v56, a108
    v_accvgpr_read_b32 v57, a109
    v_accvgpr_read_b32 v58, a110
    v_accvgpr_read_b32 v59, a111
    v_pk_mul_f32 v[52:53], v[52:53], v[30:31] op_sel_hi:[1,0]
    v_pk_mul_f32 v[54:55], v[54:55], v[30:31] op_sel_hi:[1,0]
    v_pk_mul_f32 v[56:57], v[56:57], v[30:31] op_sel_hi:[1,0]
    v_pk_mul_f32 v[58:59], v[58:59], v[30:31] op_sel_hi:[1,0]
    v_cvt_pk_bf16_f32 v60, v52, v53
    v_cvt_pk_bf16_f32 v61, v54, v55
    v_cvt_pk_bf16_f32 v62, v56, v57
    v_cvt_pk_bf16_f32 v63, v58, v59
    buffer_store_dwordx4 v[60:63], v240, s[24:27], s31 offen offset:1024 sc1
    v_accvgpr_read_b32 v64, a112
    v_accvgpr_read_b32 v65, a113
    v_accvgpr_read_b32 v66, a114
    v_accvgpr_read_b32 v67, a115
    v_accvgpr_read_b32 v68, a116
    v_accvgpr_read_b32 v69, a117
    v_accvgpr_read_b32 v70, a118
    v_accvgpr_read_b32 v71, a119
    v_pk_mul_f32 v[64:65], v[64:65], v[30:31] op_sel_hi:[1,0]
    v_pk_mul_f32 v[66:67], v[66:67], v[30:31] op_sel_hi:[1,0]
    v_pk_mul_f32 v[68:69], v[68:69], v[30:31] op_sel_hi:[1,0]
    v_pk_mul_f32 v[70:71], v[70:71], v[30:31] op_sel_hi:[1,0]
    v_cvt_pk_bf16_f32 v72, v64, v65
    v_cvt_pk_bf16_f32 v73, v66, v67
    v_cvt_pk_bf16_f32 v74, v68, v69
    v_cvt_pk_bf16_f32 v75, v70, v71
    buffer_store_dwordx4 v[72:75], v240, s[24:27], s31 offen offset:2048 sc1
    v_accvgpr_read_b32 v76, a120
    v_accvgpr_read_b32 v77, a121
    v_accvgpr_read_b32 v78, a122
    v_accvgpr_read_b32 v79, a123
    v_accvgpr_read_b32 v80, a124
    v_accvgpr_read_b32 v81, a125
    v_accvgpr_read_b32 v82, a126
    v_accvgpr_read_b32 v83, a127
    v_pk_mul_f32 v[76:77], v[76:77], v[30:31] op_sel_hi:[1,0]
    v_pk_mul_f32 v[78:79], v[78:79], v[30:31] op_sel_hi:[1,0]
    v_pk_mul_f32 v[80:81], v[80:81], v[30:31] op_sel_hi:[1,0]
    v_pk_mul_f32 v[82:83], v[82:83], v[30:31] op_sel_hi:[1,0]
    v_cvt_pk_bf16_f32 v84, v76, v77
    v_cvt_pk_bf16_f32 v85, v78, v79
    v_cvt_pk_bf16_f32 v86, v80, v81
    v_cvt_pk_bf16_f32 v87, v82, v83
    buffer_store_dwordx4 v[84:87], v240, s[24:27], s31 offen offset:3072 sc1
    s_load_dwordx2 s[44:45], s[0:1], 32
    s_load_dwordx2 s[46:47], s[0:1], 112
    v_lshrrev_b32 v2, 6, v0
    s_nop 0
    v_readfirstlane_b32 s32, v2
    s_lshr_b32 s33, s32, 1
    s_and_b32 s34, s32, 1
    s_lshl_b32 s64, s92, 3
    s_add_u32 s64, s64, s93
    s_add_u32 s64, s64, 320
    s_lshl_b32 s64, s64, 7
    s_and_b32 s48, s2, 7
    s_lshr_b32 s49, s2, 3
    s_and_b32 s40, s48, 3
    s_lshr_b32 s48, s48, 2
    s_lshl_b32 s48, s48, 3
    s_lshr_b32 s50, s49, 2
    s_add_u32 s48, s48, s50
    s_lshl_b32 s38, s48, 7
    s_and_b32 s49, s49, 3
    s_lshl_b32 s39, s49, 7
    s_waitcnt lgkmcnt(0)
    s_add_u32 s8, s44, 0
    s_addc_u32 s9, s45, 0
    s_mov_b32 s10, 4194304
    s_mov_b32 s11, 0x00020000
    s_add_u32 s12, s46, 4194304
    s_addc_u32 s13, s47, 0
    s_mov_b32 s14, 16777216
    s_mov_b32 s15, 0x00020000
    s_lshl_b32 s37, s32, 12
    v_lshrrev_b32 v16, 4, v1
    v_and_b32 v17, 15, v1
    v_lshlrev_b32 v18, 2, v16
    v_xor_b32 v18, v18, v17
    v_lshlrev_b32 v18, 4, v18
    s_mov_b32 s41, 1024
    v_mul_lo_u32 v19, v16, s41
    v_add_u32 v18, v18, v19
    s_mul_i32 s41, s32, 16384
    v_add_u32 v18, s41, v18
    v_add_u32 v2, 0, v18
    v_add_u32 v3, 3072, v18
    v_add_u32 v4, 6144, v18
    v_add_u32 v5, 9216, v18
    s_mul_i32 s41, s32, 262144
    v_lshlrev_b32 v16, 4, v1
    v_add_u32 v6, s41, v16
    v_and_b32 v16, 15, v1
    v_lshrrev_b32 v16, 2, v16
    v_and_b32 v17, 3, v1
    v_lshrrev_b32 v18, 4, v1
    v_and_b32 v18, 1, v18
    v_lshrrev_b32 v19, 5, v1
    v_and_b32 v20, 1, v17
    v_lshl_add_u32 v20, v18, 1, v20
    v_lshlrev_b32 v20, 4, v20
    v_lshrrev_b32 v17, 1, v17
    v_lshl_add_u32 v20, v17, 3, v20
    v_lshl_add_u32 v20, v16, 8, v20
    v_lshl_add_u32 v20, v19, 11, v20
    s_mul_i32 s41, s34, 2
    s_add_u32 s41, s41, 0
    v_xor_b32 v21, s41, v16
    v_lshl_add_u32 v10, v21, 6, v20
    v_add_u32 v12, 65536, v10
    s_mul_i32 s41, s34, 2
    s_add_u32 s41, s41, 1
    v_xor_b32 v21, s41, v16
    v_lshl_add_u32 v11, v21, 6, v20
    v_add_u32 v13, 65536, v11
    s_mul_i32 s41, s33, 8192
    s_add_u32 s41, s41, 16384
    v_lshlrev_b32 v16, 4, v1
    v_add_u32 v14, s41, v16
    v_add_u32 v15, 65536, v14
    s_lshl_b32 s35, s40, 20
    s_lshl_b32 s48, s39, 1
    s_add_u32 s35, s35, s48
    s_lshl_b32 s36, s38, 13
    s_lshl_b32 s48, s40, 16
    s_add_u32 s36, s36, s48
    s_lshr_b32 s48, s39, 5
    s_add_u32 s48, s48, s32
    s_lshr_b32 s50, s48, 2
    s_and_b32 s48, s48, 3
    s_mul_i32 s50, s50, 262144
    s_lshl_b32 s48, s48, 10
    s_add_u32 s48, s48, s50
    v_and_b32 v27, 7, v1
    v_lshlrev_b32 v27, 7, v27
    v_add_u32 v27, s48, v27
    s_lshl_b32 s48, s40, 21
    s_add_u32 s16, s46, 20971520
    s_addc_u32 s17, s47, 0
    s_add_u32 s16, s16, s48
    s_addc_u32 s17, s17, 0
    s_mov_b32 s18, 2097152
    s_mov_b32 s19, 0x00020000
    s_lshr_b32 s48, s38, 5
    s_mul_i32 s49, s33, 2
    s_add_u32 s48, s48, s49
    s_mul_i32 s48, s48, 32
    s_lshr_b32 s49, s39, 4
    s_add_u32 s48, s48, s49
    s_mul_i32 s49, s34, 4
    s_add_u32 s48, s48, s49
    s_lshl_b32 s48, s48, 10
    v_lshlrev_b32 v16, 4, v1
    v_add_u32 v16, s48, v16
    s_add_u32 s68, s46, 49283072
    s_addc_u32 s69, s47, 0
    s_mov_b32 s70, 237568
    s_mov_b32 s71, 0x00020000
    s_waitcnt vmcnt(0)
    s_barrier
    s_cmp_lg_u32 s32, 0
    s_cbranch_scc1 L_sig1
    v_mov_b32 v216, 0
    v_mov_b32 v217, s100
    s_mov_b64 exec, 1
    buffer_store_dword v217, v216, s[68:71], s64 offen sc1
    s_mov_b64 exec, -1
L_sig1:
    s_lshr_b32 s65, s38, 8
    s_lshl_b32 s65, s65, 2
    s_add_u32 s65, s65, s40
    s_lshl_b32 s65, s65, 3
    s_add_u32 s65, s65, 320
    s_lshl_b32 s65, s65, 7
    s_cmp_eq_u32 s32, 1
    s_cbranch_scc1 L_wp2
    s_add_u32 m0, s37, 0
    s_nop 0
    buffer_load_dwordx4 v2, s[8:11], s35 offen offset:0 lds
    buffer_load_dwordx4 v3, s[8:11], s35 offen offset:1024 lds
    buffer_load_dwordx4 v4, s[8:11], s35 offen offset:2048 lds
    buffer_load_dwordx4 v5, s[8:11], s35 offen offset:3072 lds
    s_add_u32 s35, s35, 65536
    s_add_u32 m0, s37, 32768
    s_nop 0
    buffer_load_dwordx4 v2, s[8:11], s35 offen offset:0 lds
    buffer_load_dwordx4 v3, s[8:11], s35 offen offset:1024 lds
    buffer_load_dwordx4 v4, s[8:11], s35 offen offset:2048 lds
    buffer_load_dwordx4 v5, s[8:11], s35 offen offset:3072 lds
    s_add_u32 s35, s35, 65536
    s_add_u32 m0, s37, 65536
    s_nop 0
    buffer_load_dwordx4 v2, s[8:11], s35 offen offset:0 lds
    buffer_load_dwordx4 v3, s[8:11], s35 offen offset:1024 lds
    buffer_load_dwordx4 v4, s[8:11], s35 offen offset:2048 lds
    buffer_load_dwordx4 v5, s[8:11], s35 offen offset:3072 lds
    s_add_u32 s35, s35, 65536
    s_add_u32 m0, s37, 98304
    s_nop 0
    buffer_load_dwordx4 v2, s[8:11], s35 offen offset:0 lds
    buffer_load_dwordx4 v3, s[8:11], s35 offen offset:1024 lds
    buffer_load_dwordx4 v4, s[8:11], s35 offen offset:2048 lds
    buffer_load_dwordx4 v5, s[8:11], s35 offen offset:3072 lds
    s_add_u32 s35, s35, 65536
    s_branch L_wdone2
L_wp2:
    s_mov_b32 s61, 24576
    s_mov_b32 s62, 524288
    v_min_u32 v216, 63, v1
    v_lshlrev_b32 v216, 7, v216
L_fp5:
    buffer_load_dword v217, v216, s[68:71], s61 offen sc1
    s_waitcnt vmcnt(0)
    v_cmp_ne_u32 vcc, s100, v217
    s_cbranch_vccz L_wside3
    s_sleep 1
    s_sub_u32 s62, s62, 1
    s_cmp_lg_u32 s62, 0
    s_cbranch_scc1 L_fp5
L_wside3:
    s_mov_b32 s61, 32768
    s_mov_b32 s62, 524288
    v_min_u32 v216, 63, v1
    v_lshlrev_b32 v216, 7, v216
L_fp6:
    buffer_load_dword v217, v216, s[68:71], s61 offen sc1
    s_waitcnt vmcnt(0)
    v_cmp_ne_u32 vcc, s100, v217
    s_cbranch_vccz L_wside4
    s_sleep 1
    s_sub_u32 s62, s62, 1
    s_cmp_lg_u32 s62, 0
    s_cbranch_scc1 L_fp6
L_wside4:
    s_mov_b32 s62, 524288
    v_min_u32 v216, 7, v1
    v_lshlrev_b32 v216, 7, v216
L_fp7:
    buffer_load_dword v217, v216, s[68:71], s65 offen sc1
    s_waitcnt vmcnt(0)
    v_cmp_ne_u32 vcc, s100, v217
    s_cbranch_vccz L_wgo2
    s_sleep 1
    s_sub_u32 s62, s62, 1
    s_cmp_lg_u32 s62, 0
    s_cbranch_scc1 L_fp7
L_wgo2:
    s_add_u32 m0, s37, 0
    s_nop 0
    buffer_load_dwordx4 v2, s[8:11], s35 offen offset:0 lds
    buffer_load_dwordx4 v3, s[8:11], s35 offen offset:1024 lds
    buffer_load_dwordx4 v4, s[8:11], s35 offen offset:2048 lds
    buffer_load_dwordx4 v5, s[8:11], s35 offen offset:3072 lds
    s_add_u32 s35, s35, 65536
    s_add_u32 m0, s37, 32768
    s_nop 0
    buffer_load_dwordx4 v2, s[8:11], s35 offen offset:0 lds
    buffer_load_dwordx4 v3, s[8:11], s35 offen offset:1024 lds
    buffer_load_dwordx4 v4, s[8:11], s35 offen offset:2048 lds
    buffer_load_dwordx4 v5, s[8:11], s35 offen offset:3072 lds
    s_add_u32 s35, s35, 65536
    s_add_u32 m0, s37, 65536
    s_nop 0
    buffer_load_dwordx4 v2, s[8:11], s35 offen offset:0 lds
    buffer_load_dwordx4 v3, s[8:11], s35 offen offset:1024 lds
    buffer_load_dwordx4 v4, s[8:11], s35 offen offset:2048 lds
    buffer_load_dwordx4 v5, s[8:11], s35 offen offset:3072 lds
    s_add_u32 s35, s35, 65536
    s_add_u32 m0, s37, 98304
    s_nop 0
    buffer_load_dwordx4 v2, s[8:11], s35 offen offset:0 lds
    buffer_load_dwordx4 v3, s[8:11], s35 offen offset:1024 lds
    buffer_load_dwordx4 v4, s[8:11], s35 offen offset:2048 lds
    buffer_load_dwordx4 v5, s[8:11], s35 offen offset:3072 lds
    s_add_u32 s35, s35, 65536
L_wdone2:
    s_barrier
    s_add_u32 m0, s37, 16384
    s_nop 0
    buffer_load_dwordx4 v6, s[12:15], s36 offen offset:0 sc1 lds
    buffer_load_dwordx4 v6, s[12:15], s36 offen offset:1024 sc1 lds
    buffer_load_dwordx4 v6, s[12:15], s36 offen offset:2048 sc1 lds
    buffer_load_dwordx4 v6, s[12:15], s36 offen offset:3072 sc1 lds
    s_add_u32 s36, s36, 4096
    s_add_u32 m0, s37, 49152
    s_nop 0
    buffer_load_dwordx4 v6, s[12:15], s36 offen offset:0 sc1 lds
    buffer_load_dwordx4 v6, s[12:15], s36 offen offset:1024 sc1 lds
    buffer_load_dwordx4 v6, s[12:15], s36 offen offset:2048 sc1 lds
    buffer_load_dwordx4 v6, s[12:15], s36 offen offset:3072 sc1 lds
    s_add_u32 s36, s36, 4096
    s_add_u32 m0, s37, 81920
    s_nop 0
    buffer_load_dwordx4 v6, s[12:15], s36 offen offset:0 sc1 lds
    buffer_load_dwordx4 v6, s[12:15], s36 offen offset:1024 sc1 lds
    buffer_load_dwordx4 v6, s[12:15], s36 offen offset:2048 sc1 lds
    buffer_load_dwordx4 v6, s[12:15], s36 offen offset:3072 sc1 lds
    s_add_u32 s36, s36, 4096
    s_add_u32 m0, s37, 114688
    s_nop 0
    buffer_load_dwordx4 v6, s[12:15], s36 offen offset:0 sc1 lds
    buffer_load_dwordx4 v6, s[12:15], s36 offen offset:1024 sc1 lds
    buffer_load_dwordx4 v6, s[12:15], s36 offen offset:2048 sc1 lds
    buffer_load_dwordx4 v6, s[12:15], s36 offen offset:3072 sc1 lds
    s_add_u32 s36, s36, 4096
    s_mov_b32 s63, s36
    buffer_load_dword v223, v27, s[12:15], s63 offen sc1
    s_add_u32 s63, s63, 4096
    buffer_load_dword v223, v27, s[12:15], s63 offen sc1
    s_add_u32 s63, s63, 4096
    s_lshr_b32 s64, s38, 3
    s_lshr_b32 s48, s39, 5
    s_add_u32 s64, s64, s48
    s_add_u32 s64, s64, s40
    s_add_u32 s64, s64, 576
    s_lshl_b32 s64, s64, 7
    s_waitcnt vmcnt(14)
    s_barrier
    ds_read_b128 a[64:67], v14 offset:0
    ds_read_b128 a[68:71], v14 offset:4096
    ds_read_b64_tr_b16 a[0:1], v10 offset:0
    ds_read_b64_tr_b16 a[2:3], v10 offset:1024
    ds_read_b64_tr_b16 a[4:5], v11 offset:0
    ds_read_b64_tr_b16 a[6:7], v11 offset:1024
    ds_read_b128 a[72:75], v14 offset:1024
    ds_read_b128 a[76:79], v14 offset:5120
    ds_read_b64_tr_b16 a[8:9], v10 offset:4096
    ds_read_b64_tr_b16 a[10:11], v10 offset:5120
    ds_read_b64_tr_b16 a[12:13], v11 offset:4096
    ds_read_b64_tr_b16 a[14:15], v11 offset:5120
    ds_read_b128 a[80:83], v14 offset:2048
    ds_read_b128 a[84:87], v14 offset:6144
    ds_read_b64_tr_b16 a[16:17], v10 offset:8192
    ds_read_b64_tr_b16 a[18:19], v10 offset:9216
    ds_read_b64_tr_b16 a[20:21], v11 offset:8192
    ds_read_b64_tr_b16 a[22:23], v11 offset:9216
    ds_read_b128 a[88:91], v14 offset:3072
    ds_read_b128 a[92:95], v14 offset:7168
    ds_read_b64_tr_b16 a[24:25], v10 offset:12288
    ds_read_b64_tr_b16 a[26:27], v10 offset:13312
    ds_read_b64_tr_b16 a[28:29], v11 offset:12288
    ds_read_b64_tr_b16 a[30:31], v11 offset:13312
    s_waitcnt lgkmcnt(0)
    s_waitcnt vmcnt(10)
    s_barrier
    v_mfma_f32_32x32x16_bf16 v[32:47], a[0:3], a[64:67], 0
    ds_read_b128 a[96:99], v14 offset:32768
    s_add_u32 m0, s37, 0
    ds_read_b128 a[100:103], v14 offset:36864
    v_mfma_f32_32x32x16_bf16 v[48:63], a[0:3], a[68:71], 0
    buffer_load_dwordx4 v2, s[8:11], s35 offen offset:0 lds
    ds_read_b64_tr_b16 a[32:33], v10 offset:32768
    ds_read_b64_tr_b16 a[34:35], v10 offset:33792
    v_mfma_f32_32x32x16_bf16 v[64:79], a[4:7], a[64:67], 0
    buffer_load_dwordx4 v3, s[8:11], s35 offen offset:1024 lds
    ds_read_b64_tr_b16 a[36:37], v11 offset:32768
    ds_read_b64_tr_b16 a[38:39], v11 offset:33792
    v_mfma_f32_32x32x16_bf16 v[80:95], a[4:7], a[68:71], 0
    buffer_load_dwordx4 v4, s[8:11], s35 offen offset:2048 lds
    ds_read_b128 a[104:107], v14 offset:33792
    v_mfma_f32_32x32x16_bf16 v[32:47], a[8:11], a[72:75], v[32:47]
    buffer_load_dwordx4 v5, s[8:11], s35 offen offset:3072 lds
    ds_read_b128 a[108:111], v14 offset:37888
    ds_read_b64_tr_b16 a[40:41], v10 offset:36864
    v_mfma_f32_32x32x16_bf16 v[48:63], a[8:11], a[76:79], v[48:63]
    s_add_u32 s35, s35, 65536
    ds_read_b64_tr_b16 a[42:43], v10 offset:37888
    ds_read_b64_tr_b16 a[44:45], v11 offset:36864
    v_mfma_f32_32x32x16_bf16 v[64:79], a[12:15], a[72:75], v[64:79]
    s_add_u32 m0, s37, 16384
    ds_read_b64_tr_b16 a[46:47], v11 offset:37888
    v_mfma_f32_32x32x16_bf16 v[80:95], a[12:15], a[76:79], v[80:95]
    ds_read_b128 a[112:115], v14 offset:34816
    buffer_load_dwordx4 v6, s[12:15], s36 offen offset:0 sc1 lds
    ds_read_b128 a[116:119], v14 offset:38912
    v_mfma_f32_32x32x16_bf16 v[32:47], a[16:19], a[80:83], v[32:47]
    buffer_load_dwordx4 v6, s[12:15], s36 offen offset:1024 sc1 lds
    ds_read_b64_tr_b16 a[48:49], v10 offset:40960
    ds_read_b64_tr_b16 a[50:51], v10 offset:41984
    v_mfma_f32_32x32x16_bf16 v[48:63], a[16:19], a[84:87], v[48:63]
    buffer_load_dwordx4 v6, s[12:15], s36 offen offset:2048 sc1 lds
    ds_read_b64_tr_b16 a[52:53], v11 offset:40960
    ds_read_b64_tr_b16 a[54:55], v11 offset:41984
    v_mfma_f32_32x32x16_bf16 v[64:79], a[20:23], a[80:83], v[64:79]
    buffer_load_dwordx4 v6, s[12:15], s36 offen offset:3072 sc1 lds
    ds_read_b128 a[120:123], v14 offset:35840
    v_mfma_f32_32x32x16_bf16 v[80:95], a[20:23], a[84:87], v[80:95]
    s_add_u32 s36, s36, 4096
    ds_read_b128 a[124:127], v14 offset:39936
    ds_read_b64_tr_b16 a[56:57], v10 offset:45056
    v_mfma_f32_32x32x16_bf16 v[32:47], a[24:27], a[88:91], v[32:47]
    buffer_load_dword v223, v27, s[12:15], s63 offen sc1
    ds_read_b64_tr_b16 a[58:59], v10 offset:46080
    ds_read_b64_tr_b16 a[60:61], v11 offset:45056
    v_mfma_f32_32x32x16_bf16 v[48:63], a[24:27], a[92:95], v[48:63]
    s_add_u32 s63, s63, 4096
    ds_read_b64_tr_b16 a[62:63], v11 offset:46080
    v_mfma_f32_32x32x16_bf16 v[64:79], a[28:31], a[88:91], v[64:79]
    v_mfma_f32_32x32x16_bf16 v[80:95], a[28:31], a[92:95], v[80:95]
    s_waitcnt lgkmcnt(0)
    s_waitcnt vmcnt(15)
    s_barrier
    v_mfma_f32_32x32x16_bf16 v[32:47], a[32:35], a[96:99], v[32:47]
    ds_read_b128 a[64:67], v15 offset:0
    s_add_u32 m0, s37, 32768
    ds_read_b128 a[68:71], v15 offset:4096
    v_mfma_f32_32x32x16_bf16 v[48:63], a[32:35], a[100:103], v[48:63]
    buffer_load_dwordx4 v2, s[8:11], s35 offen offset:0 lds
    ds_read_b64_tr_b16 a[0:1], v12 offset:0
    ds_read_b64_tr_b16 a[2:3], v12 offset:1024
    v_mfma_f32_32x32x16_bf16 v[64:79], a[36:39], a[96:99], v[64:79]
    buffer_load_dwordx4 v3, s[8:11], s35 offen offset:1024 lds
    ds_read_b64_tr_b16 a[4:5], v13 offset:0
    ds_read_b64_tr_b16 a[6:7], v13 offset:1024
    v_mfma_f32_32x32x16_bf16 v[80:95], a[36:39], a[100:103], v[80:95]
    buffer_load_dwordx4 v4, s[8:11], s35 offen offset:2048 lds
    ds_read_b128 a[72:75], v15 offset:1024
    v_mfma_f32_32x32x16_bf16 v[32:47], a[40:43], a[104:107], v[32:47]
    buffer_load_dwordx4 v5, s[8:11], s35 offen offset:3072 lds
    ds_read_b128 a[76:79], v15 offset:5120
    ds_read_b64_tr_b16 a[8:9], v12 offset:4096
    v_mfma_f32_32x32x16_bf16 v[48:63], a[40:43], a[108:111], v[48:63]
    s_add_u32 s35, s35, 65536
    ds_read_b64_tr_b16 a[10:11], v12 offset:5120
    ds_read_b64_tr_b16 a[12:13], v13 offset:4096
    v_mfma_f32_32x32x16_bf16 v[64:79], a[44:47], a[104:107], v[64:79]
    s_add_u32 m0, s37, 49152
    ds_read_b64_tr_b16 a[14:15], v13 offset:5120
    v_mfma_f32_32x32x16_bf16 v[80:95], a[44:47], a[108:111], v[80:95]
    ds_read_b128 a[80:83], v15 offset:2048
    buffer_load_dwordx4 v6, s[12:15], s36 offen offset:0 sc1 lds
    ds_read_b128 a[84:87], v15 offset:6144
    v_mfma_f32_32x32x16_bf16 v[32:47], a[48:51], a[112:115], v[32:47]
    buffer_load_dwordx4 v6, s[12:15], s36 offen offset:1024 sc1 lds
    ds_read_b64_tr_b16 a[16:17], v12 offset:8192
    ds_read_b64_tr_b16 a[18:19], v12 offset:9216
    v_mfma_f32_32x32x16_bf16 v[48:63], a[48:51], a[116:119], v[48:63]
    buffer_load_dwordx4 v6, s[12:15], s36 offen offset:2048 sc1 lds
    ds_read_b64_tr_b16 a[20:21], v13 offset:8192
    ds_read_b64_tr_b16 a[22:23], v13 offset:9216
    v_mfma_f32_32x32x16_bf16 v[64:79], a[52:55], a[112:115], v[64:79]
    buffer_load_dwordx4 v6, s[12:15], s36 offen offset:3072 sc1 lds
    ds_read_b128 a[88:91], v15 offset:3072
    v_mfma_f32_32x32x16_bf16 v[80:95], a[52:55], a[116:119], v[80:95]
    s_add_u32 s36, s36, 4096
    ds_read_b128 a[92:95], v15 offset:7168
    ds_read_b64_tr_b16 a[24:25], v12 offset:12288
    v_mfma_f32_32x32x16_bf16 v[32:47], a[56:59], a[120:123], v[32:47]
    buffer_load_dword v223, v27, s[12:15], s63 offen sc1
    ds_read_b64_tr_b16 a[26:27], v12 offset:13312
    ds_read_b64_tr_b16 a[28:29], v13 offset:12288
    v_mfma_f32_32x32x16_bf16 v[48:63], a[56:59], a[124:127], v[48:63]
    s_add_u32 s63, s63, 4096
    ds_read_b64_tr_b16 a[30:31], v13 offset:13312
    v_mfma_f32_32x32x16_bf16 v[64:79], a[60:63], a[120:123], v[64:79]
    v_mfma_f32_32x32x16_bf16 v[80:95], a[60:63], a[124:127], v[80:95]
    s_waitcnt lgkmcnt(0)
    s_waitcnt vmcnt(20)
    s_barrier
    v_mfma_f32_32x32x16_bf16 v[32:47], a[0:3], a[64:67], v[32:47]
    ds_read_b128 a[96:99], v15 offset:32768
    s_add_u32 m0, s37, 65536
    ds_read_b128 a[100:103], v15 offset:36864
    v_mfma_f32_32x32x16_bf16 v[48:63], a[0:3], a[68:71], v[48:63]
    buffer_load_dwordx4 v2, s[8:11], s35 offen offset:0 lds
    ds_read_b64_tr_b16 a[32:33], v12 offset:32768
    ds_read_b64_tr_b16 a[34:35], v12 offset:33792
    v_mfma_f32_32x32x16_bf16 v[64:79], a[4:7], a[64:67], v[64:79]
    buffer_load_dwordx4 v3, s[8:11], s35 offen offset:1024 lds
    ds_read_b64_tr_b16 a[36:37], v13 offset:32768
    ds_read_b64_tr_b16 a[38:39], v13 offset:33792
    v_mfma_f32_32x32x16_bf16 v[80:95], a[4:7], a[68:71], v[80:95]
    buffer_load_dwordx4 v4, s[8:11], s35 offen offset:2048 lds
    ds_read_b128 a[104:107], v15 offset:33792
    v_mfma_f32_32x32x16_bf16 v[32:47], a[8:11], a[72:75], v[32:47]
    buffer_load_dwordx4 v5, s[8:11], s35 offen offset:3072 lds
    ds_read_b128 a[108:111], v15 offset:37888
    ds_read_b64_tr_b16 a[40:41], v12 offset:36864
    v_mfma_f32_32x32x16_bf16 v[48:63], a[8:11], a[76:79], v[48:63]
    s_add_u32 s35, s35, 65536
    ds_read_b64_tr_b16 a[42:43], v12 offset:37888
    ds_read_b64_tr_b16 a[44:45], v13 offset:36864
    v_mfma_f32_32x32x16_bf16 v[64:79], a[12:15], a[72:75], v[64:79]
    s_add_u32 m0, s37, 81920
    ds_read_b64_tr_b16 a[46:47], v13 offset:37888
    v_mfma_f32_32x32x16_bf16 v[80:95], a[12:15], a[76:79], v[80:95]
    ds_read_b128 a[112:115], v15 offset:34816
    buffer_load_dwordx4 v6, s[12:15], s36 offen offset:0 sc1 lds
    ds_read_b128 a[116:119], v15 offset:38912
    v_mfma_f32_32x32x16_bf16 v[32:47], a[16:19], a[80:83], v[32:47]
    buffer_load_dwordx4 v6, s[12:15], s36 offen offset:1024 sc1 lds
    ds_read_b64_tr_b16 a[48:49], v12 offset:40960
    ds_read_b64_tr_b16 a[50:51], v12 offset:41984
    v_mfma_f32_32x32x16_bf16 v[48:63], a[16:19], a[84:87], v[48:63]
    buffer_load_dwordx4 v6, s[12:15], s36 offen offset:2048 sc1 lds
    ds_read_b64_tr_b16 a[52:53], v13 offset:40960
    ds_read_b64_tr_b16 a[54:55], v13 offset:41984
    v_mfma_f32_32x32x16_bf16 v[64:79], a[20:23], a[80:83], v[64:79]
    buffer_load_dwordx4 v6, s[12:15], s36 offen offset:3072 sc1 lds
    ds_read_b128 a[120:123], v15 offset:35840
    v_mfma_f32_32x32x16_bf16 v[80:95], a[20:23], a[84:87], v[80:95]
    s_add_u32 s36, s36, 4096
    ds_read_b128 a[124:127], v15 offset:39936
    ds_read_b64_tr_b16 a[56:57], v12 offset:45056
    v_mfma_f32_32x32x16_bf16 v[32:47], a[24:27], a[88:91], v[32:47]
    buffer_load_dword v223, v27, s[12:15], s63 offen sc1
    ds_read_b64_tr_b16 a[58:59], v12 offset:46080
    ds_read_b64_tr_b16 a[60:61], v13 offset:45056
    v_mfma_f32_32x32x16_bf16 v[48:63], a[24:27], a[92:95], v[48:63]
    s_add_u32 s63, s63, 4096
    ds_read_b64_tr_b16 a[62:63], v13 offset:46080
    v_mfma_f32_32x32x16_bf16 v[64:79], a[28:31], a[88:91], v[64:79]
    v_mfma_f32_32x32x16_bf16 v[80:95], a[28:31], a[92:95], v[80:95]
    s_waitcnt lgkmcnt(0)
    s_waitcnt vmcnt(19)
    s_barrier
    v_mfma_f32_32x32x16_bf16 v[32:47], a[32:35], a[96:99], v[32:47]
    ds_read_b128 a[64:67], v14 offset:0
    s_add_u32 m0, s37, 98304
    ds_read_b128 a[68:71], v14 offset:4096
    v_mfma_f32_32x32x16_bf16 v[48:63], a[32:35], a[100:103], v[48:63]
    buffer_load_dwordx4 v2, s[8:11], s35 offen offset:0 lds
    ds_read_b64_tr_b16 a[0:1], v10 offset:0
    ds_read_b64_tr_b16 a[2:3], v10 offset:1024
    v_mfma_f32_32x32x16_bf16 v[64:79], a[36:39], a[96:99], v[64:79]
    buffer_load_dwordx4 v3, s[8:11], s35 offen offset:1024 lds
    ds_read_b64_tr_b16 a[4:5], v11 offset:0
    ds_read_b64_tr_b16 a[6:7], v11 offset:1024
    v_mfma_f32_32x32x16_bf16 v[80:95], a[36:39], a[100:103], v[80:95]
    buffer_load_dwordx4 v4, s[8:11], s35 offen offset:2048 lds
    ds_read_b128 a[72:75], v14 offset:1024
    v_mfma_f32_32x32x16_bf16 v[32:47], a[40:43], a[104:107], v[32:47]
    buffer_load_dwordx4 v5, s[8:11], s35 offen offset:3072 lds
    ds_read_b128 a[76:79], v14 offset:5120
    ds_read_b64_tr_b16 a[8:9], v10 offset:4096
    v_mfma_f32_32x32x16_bf16 v[48:63], a[40:43], a[108:111], v[48:63]
    s_add_u32 s35, s35, 65536
    ds_read_b64_tr_b16 a[10:11], v10 offset:5120
    ds_read_b64_tr_b16 a[12:13], v11 offset:4096
    v_mfma_f32_32x32x16_bf16 v[64:79], a[44:47], a[104:107], v[64:79]
    s_add_u32 m0, s37, 114688
    ds_read_b64_tr_b16 a[14:15], v11 offset:5120
    v_mfma_f32_32x32x16_bf16 v[80:95], a[44:47], a[108:111], v[80:95]
    ds_read_b128 a[80:83], v14 offset:2048
    buffer_load_dwordx4 v6, s[12:15], s36 offen offset:0 sc1 lds
    ds_read_b128 a[84:87], v14 offset:6144
    v_mfma_f32_32x32x16_bf16 v[32:47], a[48:51], a[112:115], v[32:47]
    buffer_load_dwordx4 v6, s[12:15], s36 offen offset:1024 sc1 lds
    ds_read_b64_tr_b16 a[16:17], v10 offset:8192
    ds_read_b64_tr_b16 a[18:19], v10 offset:9216
    v_mfma_f32_32x32x16_bf16 v[48:63], a[48:51], a[116:119], v[48:63]
    buffer_load_dwordx4 v6, s[12:15], s36 offen offset:2048 sc1 lds
    ds_read_b64_tr_b16 a[20:21], v11 offset:8192
    ds_read_b64_tr_b16 a[22:23], v11 offset:9216
    v_mfma_f32_32x32x16_bf16 v[64:79], a[52:55], a[112:115], v[64:79]
    buffer_load_dwordx4 v6, s[12:15], s36 offen offset:3072 sc1 lds
    ds_read_b128 a[88:91], v14 offset:3072
    v_mfma_f32_32x32x16_bf16 v[80:95], a[52:55], a[116:119], v[80:95]
    s_add_u32 s36, s36, 4096
    ds_read_b128 a[92:95], v14 offset:7168
    ds_read_b64_tr_b16 a[24:25], v10 offset:12288
    v_mfma_f32_32x32x16_bf16 v[32:47], a[56:59], a[120:123], v[32:47]
    buffer_load_dword v223, v27, s[12:15], s63 offen sc1
    ds_read_b64_tr_b16 a[26:27], v10 offset:13312
    ds_read_b64_tr_b16 a[28:29], v11 offset:12288
    v_mfma_f32_32x32x16_bf16 v[48:63], a[56:59], a[124:127], v[48:63]
    s_add_u32 s63, s63, 4096
    ds_read_b64_tr_b16 a[30:31], v11 offset:13312
    v_mfma_f32_32x32x16_bf16 v[64:79], a[60:63], a[120:123], v[64:79]
    v_mfma_f32_32x32x16_bf16 v[80:95], a[60:63], a[124:127], v[80:95]
    s_waitcnt lgkmcnt(0)
    s_waitcnt vmcnt(19)
    s_barrier
    v_mfma_f32_32x32x16_bf16 v[32:47], a[0:3], a[64:67], v[32:47]
    ds_read_b128 a[96:99], v14 offset:32768
    s_add_u32 m0, s37, 0
    ds_read_b128 a[100:103], v14 offset:36864
    v_mfma_f32_32x32x16_bf16 v[48:63], a[0:3], a[68:71], v[48:63]
    buffer_load_dwordx4 v2, s[8:11], s35 offen offset:0 lds
    ds_read_b64_tr_b16 a[32:33], v10 offset:32768
    ds_read_b64_tr_b16 a[34:35], v10 offset:33792
    v_mfma_f32_32x32x16_bf16 v[64:79], a[4:7], a[64:67], v[64:79]
    buffer_load_dwordx4 v3, s[8:11], s35 offen offset:1024 lds
    ds_read_b64_tr_b16 a[36:37], v11 offset:32768
    ds_read_b64_tr_b16 a[38:39], v11 offset:33792
    v_mfma_f32_32x32x16_bf16 v[80:95], a[4:7], a[68:71], v[80:95]
    buffer_load_dwordx4 v4, s[8:11], s35 offen offset:2048 lds
    ds_read_b128 a[104:107], v14 offset:33792
    v_mfma_f32_32x32x16_bf16 v[32:47], a[8:11], a[72:75], v[32:47]
    buffer_load_dwordx4 v5, s[8:11], s35 offen offset:3072 lds
    ds_read_b128 a[108:111], v14 offset:37888
    ds_read_b64_tr_b16 a[40:41], v10 offset:36864
    v_mfma_f32_32x32x16_bf16 v[48:63], a[8:11], a[76:79], v[48:63]
    s_add_u32 s35, s35, 65536
    ds_read_b64_tr_b16 a[42:43], v10 offset:37888
    ds_read_b64_tr_b16 a[44:45], v11 offset:36864
    v_mfma_f32_32x32x16_bf16 v[64:79], a[12:15], a[72:75], v[64:79]
    s_add_u32 m0, s37, 16384
    ds_read_b64_tr_b16 a[46:47], v11 offset:37888
    v_mfma_f32_32x32x16_bf16 v[80:95], a[12:15], a[76:79], v[80:95]
    ds_read_b128 a[112:115], v14 offset:34816
    buffer_load_dwordx4 v6, s[12:15], s36 offen offset:0 sc1 lds
    ds_read_b128 a[116:119], v14 offset:38912
    v_mfma_f32_32x32x16_bf16 v[32:47], a[16:19], a[80:83], v[32:47]
    buffer_load_dwordx4 v6, s[12:15], s36 offen offset:1024 sc1 lds
    ds_read_b64_tr_b16 a[48:49], v10 offset:40960
    ds_read_b64_tr_b16 a[50:51], v10 offset:41984
    v_mfma_f32_32x32x16_bf16 v[48:63], a[16:19], a[84:87], v[48:63]
    buffer_load_dwordx4 v6, s[12:15], s36 offen offset:2048 sc1 lds
    ds_read_b64_tr_b16 a[52:53], v11 offset:40960
    ds_read_b64_tr_b16 a[54:55], v11 offset:41984
    v_mfma_f32_32x32x16_bf16 v[64:79], a[20:23], a[80:83], v[64:79]
    buffer_load_dwordx4 v6, s[12:15], s36 offen offset:3072 sc1 lds
    ds_read_b128 a[120:123], v14 offset:35840
    v_mfma_f32_32x32x16_bf16 v[80:95], a[20:23], a[84:87], v[80:95]
    s_add_u32 s36, s36, 4096
    ds_read_b128 a[124:127], v14 offset:39936
    ds_read_b64_tr_b16 a[56:57], v10 offset:45056
    v_mfma_f32_32x32x16_bf16 v[32:47], a[24:27], a[88:91], v[32:47]
    buffer_load_dword v223, v27, s[12:15], s63 offen sc1
    ds_read_b64_tr_b16 a[58:59], v10 offset:46080
    ds_read_b64_tr_b16 a[60:61], v11 offset:45056
    v_mfma_f32_32x32x16_bf16 v[48:63], a[24:27], a[92:95], v[48:63]
    s_add_u32 s63, s63, 4096
    ds_read_b64_tr_b16 a[62:63], v11 offset:46080
    v_mfma_f32_32x32x16_bf16 v[64:79], a[28:31], a[88:91], v[64:79]
    v_mfma_f32_32x32x16_bf16 v[80:95], a[28:31], a[92:95], v[80:95]
    s_waitcnt lgkmcnt(0)
    s_waitcnt vmcnt(19)
    s_barrier
    v_mfma_f32_32x32x16_bf16 v[32:47], a[32:35], a[96:99], v[32:47]
    ds_read_b128 a[64:67], v15 offset:0
    s_add_u32 m0, s37, 32768
    ds_read_b128 a[68:71], v15 offset:4096
    v_mfma_f32_32x32x16_bf16 v[48:63], a[32:35], a[100:103], v[48:63]
    buffer_load_dwordx4 v2, s[8:11], s35 offen offset:0 lds
    ds_read_b64_tr_b16 a[0:1], v12 offset:0
    ds_read_b64_tr_b16 a[2:3], v12 offset:1024
    v_mfma_f32_32x32x16_bf16 v[64:79], a[36:39], a[96:99], v[64:79]
    buffer_load_dwordx4 v3, s[8:11], s35 offen offset:1024 lds
    ds_read_b64_tr_b16 a[4:5], v13 offset:0
    ds_read_b64_tr_b16 a[6:7], v13 offset:1024
    v_mfma_f32_32x32x16_bf16 v[80:95], a[36:39], a[100:103], v[80:95]
    buffer_load_dwordx4 v4, s[8:11], s35 offen offset:2048 lds
    ds_read_b128 a[72:75], v15 offset:1024
    v_mfma_f32_32x32x16_bf16 v[32:47], a[40:43], a[104:107], v[32:47]
    buffer_load_dwordx4 v5, s[8:11], s35 offen offset:3072 lds
    ds_read_b128 a[76:79], v15 offset:5120
    ds_read_b64_tr_b16 a[8:9], v12 offset:4096
    v_mfma_f32_32x32x16_bf16 v[48:63], a[40:43], a[108:111], v[48:63]
    s_add_u32 s35, s35, 65536
    ds_read_b64_tr_b16 a[10:11], v12 offset:5120
    ds_read_b64_tr_b16 a[12:13], v13 offset:4096
    v_mfma_f32_32x32x16_bf16 v[64:79], a[44:47], a[104:107], v[64:79]
    s_add_u32 m0, s37, 49152
    ds_read_b64_tr_b16 a[14:15], v13 offset:5120
    v_mfma_f32_32x32x16_bf16 v[80:95], a[44:47], a[108:111], v[80:95]
    ds_read_b128 a[80:83], v15 offset:2048
    buffer_load_dwordx4 v6, s[12:15], s36 offen offset:0 sc1 lds
    ds_read_b128 a[84:87], v15 offset:6144
    v_mfma_f32_32x32x16_bf16 v[32:47], a[48:51], a[112:115], v[32:47]
    buffer_load_dwordx4 v6, s[12:15], s36 offen offset:1024 sc1 lds
    ds_read_b64_tr_b16 a[16:17], v12 offset:8192
    ds_read_b64_tr_b16 a[18:19], v12 offset:9216
    v_mfma_f32_32x32x16_bf16 v[48:63], a[48:51], a[116:119], v[48:63]
    buffer_load_dwordx4 v6, s[12:15], s36 offen offset:2048 sc1 lds
    ds_read_b64_tr_b16 a[20:21], v13 offset:8192
    ds_read_b64_tr_b16 a[22:23], v13 offset:9216
    v_mfma_f32_32x32x16_bf16 v[64:79], a[52:55], a[112:115], v[64:79]
    buffer_load_dwordx4 v6, s[12:15], s36 offen offset:3072 sc1 lds
    ds_read_b128 a[88:91], v15 offset:3072
    v_mfma_f32_32x32x16_bf16 v[80:95], a[52:55], a[116:119], v[80:95]
    s_add_u32 s36, s36, 4096
    ds_read_b128 a[92:95], v15 offset:7168
    ds_read_b64_tr_b16 a[24:25], v12 offset:12288
    v_mfma_f32_32x32x16_bf16 v[32:47], a[56:59], a[120:123], v[32:47]
    buffer_load_dword v223, v27, s[12:15], s63 offen sc1
    ds_read_b64_tr_b16 a[26:27], v12 offset:13312
    ds_read_b64_tr_b16 a[28:29], v13 offset:12288
    v_mfma_f32_32x32x16_bf16 v[48:63], a[56:59], a[124:127], v[48:63]
    s_add_u32 s63, s63, 4096
    ds_read_b64_tr_b16 a[30:31], v13 offset:13312
    v_mfma_f32_32x32x16_bf16 v[64:79], a[60:63], a[120:123], v[64:79]
    v_mfma_f32_32x32x16_bf16 v[80:95], a[60:63], a[124:127], v[80:95]
    s_waitcnt lgkmcnt(0)
    s_waitcnt vmcnt(19)
    s_barrier
    v_mfma_f32_32x32x16_bf16 v[32:47], a[0:3], a[64:67], v[32:47]
    ds_read_b128 a[96:99], v15 offset:32768
    s_add_u32 m0, s37, 65536
    ds_read_b128 a[100:103], v15 offset:36864
    v_mfma_f32_32x32x16_bf16 v[48:63], a[0:3], a[68:71], v[48:63]
    buffer_load_dwordx4 v2, s[8:11], s35 offen offset:0 lds
    ds_read_b64_tr_b16 a[32:33], v12 offset:32768
    ds_read_b64_tr_b16 a[34:35], v12 offset:33792
    v_mfma_f32_32x32x16_bf16 v[64:79], a[4:7], a[64:67], v[64:79]
    buffer_load_dwordx4 v3, s[8:11], s35 offen offset:1024 lds
    ds_read_b64_tr_b16 a[36:37], v13 offset:32768
    ds_read_b64_tr_b16 a[38:39], v13 offset:33792
    v_mfma_f32_32x32x16_bf16 v[80:95], a[4:7], a[68:71], v[80:95]
    buffer_load_dwordx4 v4, s[8:11], s35 offen offset:2048 lds
    ds_read_b128 a[104:107], v15 offset:33792
    v_mfma_f32_32x32x16_bf16 v[32:47], a[8:11], a[72:75], v[32:47]
    buffer_load_dwordx4 v5, s[8:11], s35 offen offset:3072 lds
    ds_read_b128 a[108:111], v15 offset:37888
    ds_read_b64_tr_b16 a[40:41], v12 offset:36864
    v_mfma_f32_32x32x16_bf16 v[48:63], a[8:11], a[76:79], v[48:63]
    s_add_u32 s35, s35, 65536
    ds_read_b64_tr_b16 a[42:43], v12 offset:37888
    ds_read_b64_tr_b16 a[44:45], v13 offset:36864
    v_mfma_f32_32x32x16_bf16 v[64:79], a[12:15], a[72:75], v[64:79]
    s_add_u32 m0, s37, 81920
    ds_read_b64_tr_b16 a[46:47], v13 offset:37888
    v_mfma_f32_32x32x16_bf16 v[80:95], a[12:15], a[76:79], v[80:95]
    ds_read_b128 a[112:115], v15 offset:34816
    buffer_load_dwordx4 v6, s[12:15], s36 offen offset:0 sc1 lds
    ds_read_b128 a[116:119], v15 offset:38912
    v_mfma_f32_32x32x16_bf16 v[32:47], a[16:19], a[80:83], v[32:47]
    buffer_load_dwordx4 v6, s[12:15], s36 offen offset:1024 sc1 lds
    ds_read_b64_tr_b16 a[48:49], v12 offset:40960
    ds_read_b64_tr_b16 a[50:51], v12 offset:41984
    v_mfma_f32_32x32x16_bf16 v[48:63], a[16:19], a[84:87], v[48:63]
    buffer_load_dwordx4 v6, s[12:15], s36 offen offset:2048 sc1 lds
    ds_read_b64_tr_b16 a[52:53], v13 offset:40960
    ds_read_b64_tr_b16 a[54:55], v13 offset:41984
    v_mfma_f32_32x32x16_bf16 v[64:79], a[20:23], a[80:83], v[64:79]
    buffer_load_dwordx4 v6, s[12:15], s36 offen offset:3072 sc1 lds
    ds_read_b128 a[120:123], v15 offset:35840
    v_mfma_f32_32x32x16_bf16 v[80:95], a[20:23], a[84:87], v[80:95]
    s_add_u32 s36, s36, 4096
    ds_read_b128 a[124:127], v15 offset:39936
    ds_read_b64_tr_b16 a[56:57], v12 offset:45056
    v_mfma_f32_32x32x16_bf16 v[32:47], a[24:27], a[88:91], v[32:47]
    buffer_load_dword v223, v27, s[12:15], s63 offen sc1
    ds_read_b64_tr_b16 a[58:59], v12 offset:46080
    ds_read_b64_tr_b16 a[60:61], v13 offset:45056
    v_mfma_f32_32x32x16_bf16 v[48:63], a[24:27], a[92:95], v[48:63]
    s_add_u32 s63, s63, 4096
    ds_read_b64_tr_b16 a[62:63], v13 offset:46080
    v_mfma_f32_32x32x16_bf16 v[64:79], a[28:31], a[88:91], v[64:79]
    v_mfma_f32_32x32x16_bf16 v[80:95], a[28:31], a[92:95], v[80:95]
    s_waitcnt lgkmcnt(0)
    s_waitcnt vmcnt(19)
    s_barrier
    v_mfma_f32_32x32x16_bf16 v[32:47], a[32:35], a[96:99], v[32:47]
    ds_read_b128 a[64:67], v14 offset:0
    s_add_u32 m0, s37, 98304
    ds_read_b128 a[68:71], v14 offset:4096
    v_mfma_f32_32x32x16_bf16 v[48:63], a[32:35], a[100:103], v[48:63]
    buffer_load_dwordx4 v2, s[8:11], s35 offen offset:0 lds
    ds_read_b64_tr_b16 a[0:1], v10 offset:0
    ds_read_b64_tr_b16 a[2:3], v10 offset:1024
    v_mfma_f32_32x32x16_bf16 v[64:79], a[36:39], a[96:99], v[64:79]
    buffer_load_dwordx4 v3, s[8:11], s35 offen offset:1024 lds
    ds_read_b64_tr_b16 a[4:5], v11 offset:0
    ds_read_b64_tr_b16 a[6:7], v11 offset:1024
    v_mfma_f32_32x32x16_bf16 v[80:95], a[36:39], a[100:103], v[80:95]
    buffer_load_dwordx4 v4, s[8:11], s35 offen offset:2048 lds
    ds_read_b128 a[72:75], v14 offset:1024
    v_mfma_f32_32x32x16_bf16 v[32:47], a[40:43], a[104:107], v[32:47]
    buffer_load_dwordx4 v5, s[8:11], s35 offen offset:3072 lds
    ds_read_b128 a[76:79], v14 offset:5120
    ds_read_b64_tr_b16 a[8:9], v10 offset:4096
    v_mfma_f32_32x32x16_bf16 v[48:63], a[40:43], a[108:111], v[48:63]
    s_add_u32 s35, s35, 65536
    ds_read_b64_tr_b16 a[10:11], v10 offset:5120
    ds_read_b64_tr_b16 a[12:13], v11 offset:4096
    v_mfma_f32_32x32x16_bf16 v[64:79], a[44:47], a[104:107], v[64:79]
    s_add_u32 m0, s37, 114688
    ds_read_b64_tr_b16 a[14:15], v11 offset:5120
    v_mfma_f32_32x32x16_bf16 v[80:95], a[44:47], a[108:111], v[80:95]
    ds_read_b128 a[80:83], v14 offset:2048
    buffer_load_dwordx4 v6, s[12:15], s36 offen offset:0 sc1 lds
    ds_read_b128 a[84:87], v14 offset:6144
    v_mfma_f32_32x32x16_bf16 v[32:47], a[48:51], a[112:115], v[32:47]
    buffer_load_dwordx4 v6, s[12:15], s36 offen offset:1024 sc1 lds
    ds_read_b64_tr_b16 a[16:17], v10 offset:8192
    ds_read_b64_tr_b16 a[18:19], v10 offset:9216
    v_mfma_f32_32x32x16_bf16 v[48:63], a[48:51], a[116:119], v[48:63]
    buffer_load_dwordx4 v6, s[12:15], s36 offen offset:2048 sc1 lds
    ds_read_b64_tr_b16 a[20:21], v11 offset:8192
    ds_read_b64_tr_b16 a[22:23], v11 offset:9216
    v_mfma_f32_32x32x16_bf16 v[64:79], a[52:55], a[112:115], v[64:79]
    buffer_load_dwordx4 v6, s[12:15], s36 offen offset:3072 sc1 lds
    ds_read_b128 a[88:91], v14 offset:3072
    v_mfma_f32_32x32x16_bf16 v[80:95], a[52:55], a[116:119], v[80:95]
    s_add_u32 s36, s36, 4096
    ds_read_b128 a[92:95], v14 offset:7168
    ds_read_b64_tr_b16 a[24:25], v10 offset:12288
    v_mfma_f32_32x32x16_bf16 v[32:47], a[56:59], a[120:123], v[32:47]
    buffer_load_dword v223, v27, s[12:15], s63 offen sc1
    ds_read_b64_tr_b16 a[26:27], v10 offset:13312
    ds_read_b64_tr_b16 a[28:29], v11 offset:12288
    v_mfma_f32_32x32x16_bf16 v[48:63], a[56:59], a[124:127], v[48:63]
    s_add_u32 s63, s63, 4096
    ds_read_b64_tr_b16 a[30:31], v11 offset:13312
    v_mfma_f32_32x32x16_bf16 v[64:79], a[60:63], a[120:123], v[64:79]
    v_mfma_f32_32x32x16_bf16 v[80:95], a[60:63], a[124:127], v[80:95]
    s_waitcnt lgkmcnt(0)
    s_waitcnt vmcnt(19)
    s_barrier
    v_mfma_f32_32x32x16_bf16 v[32:47], a[0:3], a[64:67], v[32:47]
    ds_read_b128 a[96:99], v14 offset:32768
    s_add_u32 m0, s37, 0
    ds_read_b128 a[100:103], v14 offset:36864
    v_mfma_f32_32x32x16_bf16 v[48:63], a[0:3], a[68:71], v[48:63]
    buffer_load_dwordx4 v2, s[8:11], s35 offen offset:0 lds
    ds_read_b64_tr_b16 a[32:33], v10 offset:32768
    ds_read_b64_tr_b16 a[34:35], v10 offset:33792
    v_mfma_f32_32x32x16_bf16 v[64:79], a[4:7], a[64:67], v[64:79]
    buffer_load_dwordx4 v3, s[8:11], s35 offen offset:1024 lds
    ds_read_b64_tr_b16 a[36:37], v11 offset:32768
    ds_read_b64_tr_b16 a[38:39], v11 offset:33792
    v_mfma_f32_32x32x16_bf16 v[80:95], a[4:7], a[68:71], v[80:95]
    buffer_load_dwordx4 v4, s[8:11], s35 offen offset:2048 lds
    ds_read_b128 a[104:107], v14 offset:33792
    v_mfma_f32_32x32x16_bf16 v[32:47], a[8:11], a[72:75], v[32:47]
    buffer_load_dwordx4 v5, s[8:11], s35 offen offset:3072 lds
    ds_read_b128 a[108:111], v14 offset:37888
    ds_read_b64_tr_b16 a[40:41], v10 offset:36864
    v_mfma_f32_32x32x16_bf16 v[48:63], a[8:11], a[76:79], v[48:63]
    s_add_u32 s35, s35, 65536
    ds_read_b64_tr_b16 a[42:43], v10 offset:37888
    ds_read_b64_tr_b16 a[44:45], v11 offset:36864
    v_mfma_f32_32x32x16_bf16 v[64:79], a[12:15], a[72:75], v[64:79]
    s_add_u32 m0, s37, 16384
    ds_read_b64_tr_b16 a[46:47], v11 offset:37888
    v_mfma_f32_32x32x16_bf16 v[80:95], a[12:15], a[76:79], v[80:95]
    ds_read_b128 a[112:115], v14 offset:34816
    buffer_load_dwordx4 v6, s[12:15], s36 offen offset:0 sc1 lds
    ds_read_b128 a[116:119], v14 offset:38912
    v_mfma_f32_32x32x16_bf16 v[32:47], a[16:19], a[80:83], v[32:47]
    buffer_load_dwordx4 v6, s[12:15], s36 offen offset:1024 sc1 lds
    ds_read_b64_tr_b16 a[48:49], v10 offset:40960
    ds_read_b64_tr_b16 a[50:51], v10 offset:41984
    v_mfma_f32_32x32x16_bf16 v[48:63], a[16:19], a[84:87], v[48:63]
    buffer_load_dwordx4 v6, s[12:15], s36 offen offset:2048 sc1 lds
    ds_read_b64_tr_b16 a[52:53], v11 offset:40960
    ds_read_b64_tr_b16 a[54:55], v11 offset:41984
    v_mfma_f32_32x32x16_bf16 v[64:79], a[20:23], a[80:83], v[64:79]
    buffer_load_dwordx4 v6, s[12:15], s36 offen offset:3072 sc1 lds
    ds_read_b128 a[120:123], v14 offset:35840
    v_mfma_f32_32x32x16_bf16 v[80:95], a[20:23], a[84:87], v[80:95]
    s_add_u32 s36, s36, 4096
    ds_read_b128 a[124:127], v14 offset:39936
    ds_read_b64_tr_b16 a[56:57], v10 offset:45056
    v_mfma_f32_32x32x16_bf16 v[32:47], a[24:27], a[88:91], v[32:47]
    buffer_load_dword v223, v27, s[12:15], s63 offen sc1
    ds_read_b64_tr_b16 a[58:59], v10 offset:46080
    ds_read_b64_tr_b16 a[60:61], v11 offset:45056
    v_mfma_f32_32x32x16_bf16 v[48:63], a[24:27], a[92:95], v[48:63]
    s_add_u32 s63, s63, 4096
    ds_read_b64_tr_b16 a[62:63], v11 offset:46080
    v_mfma_f32_32x32x16_bf16 v[64:79], a[28:31], a[88:91], v[64:79]
    v_mfma_f32_32x32x16_bf16 v[80:95], a[28:31], a[92:95], v[80:95]
    s_waitcnt lgkmcnt(0)
    s_waitcnt vmcnt(19)
    s_barrier
    v_mfma_f32_32x32x16_bf16 v[32:47], a[32:35], a[96:99], v[32:47]
    ds_read_b128 a[64:67], v15 offset:0
    s_add_u32 m0, s37, 32768
    ds_read_b128 a[68:71], v15 offset:4096
    v_mfma_f32_32x32x16_bf16 v[48:63], a[32:35], a[100:103], v[48:63]
    buffer_load_dwordx4 v2, s[8:11], s35 offen offset:0 lds
    ds_read_b64_tr_b16 a[0:1], v12 offset:0
    ds_read_b64_tr_b16 a[2:3], v12 offset:1024
    v_mfma_f32_32x32x16_bf16 v[64:79], a[36:39], a[96:99], v[64:79]
    buffer_load_dwordx4 v3, s[8:11], s35 offen offset:1024 lds
    ds_read_b64_tr_b16 a[4:5], v13 offset:0
    ds_read_b64_tr_b16 a[6:7], v13 offset:1024
    v_mfma_f32_32x32x16_bf16 v[80:95], a[36:39], a[100:103], v[80:95]
    buffer_load_dwordx4 v4, s[8:11], s35 offen offset:2048 lds
    ds_read_b128 a[72:75], v15 offset:1024
    v_mfma_f32_32x32x16_bf16 v[32:47], a[40:43], a[104:107], v[32:47]
    buffer_load_dwordx4 v5, s[8:11], s35 offen offset:3072 lds
    ds_read_b128 a[76:79], v15 offset:5120
    ds_read_b64_tr_b16 a[8:9], v12 offset:4096
    v_mfma_f32_32x32x16_bf16 v[48:63], a[40:43], a[108:111], v[48:63]
    s_add_u32 s35, s35, 65536
    ds_read_b64_tr_b16 a[10:11], v12 offset:5120
    ds_read_b64_tr_b16 a[12:13], v13 offset:4096
    v_mfma_f32_32x32x16_bf16 v[64:79], a[44:47], a[104:107], v[64:79]
    s_add_u32 m0, s37, 49152
    ds_read_b64_tr_b16 a[14:15], v13 offset:5120
    v_mfma_f32_32x32x16_bf16 v[80:95], a[44:47], a[108:111], v[80:95]
    ds_read_b128 a[80:83], v15 offset:2048
    buffer_load_dwordx4 v6, s[12:15], s36 offen offset:0 sc1 lds
    ds_read_b128 a[84:87], v15 offset:6144
    v_mfma_f32_32x32x16_bf16 v[32:47], a[48:51], a[112:115], v[32:47]
    buffer_load_dwordx4 v6, s[12:15], s36 offen offset:1024 sc1 lds
    ds_read_b64_tr_b16 a[16:17], v12 offset:8192
    ds_read_b64_tr_b16 a[18:19], v12 offset:9216
    v_mfma_f32_32x32x16_bf16 v[48:63], a[48:51], a[116:119], v[48:63]
    buffer_load_dwordx4 v6, s[12:15], s36 offen offset:2048 sc1 lds
    ds_read_b64_tr_b16 a[20:21], v13 offset:8192
    ds_read_b64_tr_b16 a[22:23], v13 offset:9216
    v_mfma_f32_32x32x16_bf16 v[64:79], a[52:55], a[112:115], v[64:79]
    buffer_load_dwordx4 v6, s[12:15], s36 offen offset:3072 sc1 lds
    ds_read_b128 a[88:91], v15 offset:3072
    v_mfma_f32_32x32x16_bf16 v[80:95], a[52:55], a[116:119], v[80:95]
    s_add_u32 s36, s36, 4096
    ds_read_b128 a[92:95], v15 offset:7168
    ds_read_b64_tr_b16 a[24:25], v12 offset:12288
    v_mfma_f32_32x32x16_bf16 v[32:47], a[56:59], a[120:123], v[32:47]
    buffer_load_dword v223, v27, s[12:15], s63 offen sc1
    ds_read_b64_tr_b16 a[26:27], v12 offset:13312
    ds_read_b64_tr_b16 a[28:29], v13 offset:12288
    v_mfma_f32_32x32x16_bf16 v[48:63], a[56:59], a[124:127], v[48:63]
    s_add_u32 s63, s63, 4096
    ds_read_b64_tr_b16 a[30:31], v13 offset:13312
    v_mfma_f32_32x32x16_bf16 v[64:79], a[60:63], a[120:123], v[64:79]
    v_mfma_f32_32x32x16_bf16 v[80:95], a[60:63], a[124:127], v[80:95]
    s_waitcnt lgkmcnt(0)
    s_waitcnt vmcnt(19)
    s_barrier
    v_mfma_f32_32x32x16_bf16 v[32:47], a[0:3], a[64:67], v[32:47]
    ds_read_b128 a[96:99], v15 offset:32768
    s_add_u32 m0, s37, 65536
    ds_read_b128 a[100:103], v15 offset:36864
    v_mfma_f32_32x32x16_bf16 v[48:63], a[0:3], a[68:71], v[48:63]
    ds_read_b64_tr_b16 a[32:33], v12 offset:32768
    buffer_load_dwordx4 v2, s[8:11], s35 offen offset:0 lds
    ds_read_b64_tr_b16 a[34:35], v12 offset:33792
    v_mfma_f32_32x32x16_bf16 v[64:79], a[4:7], a[64:67], v[64:79]
    ds_read_b64_tr_b16 a[36:37], v13 offset:32768
    buffer_load_dwordx4 v3, s[8:11], s35 offen offset:1024 lds
    v_mfma_f32_32x32x16_bf16 v[80:95], a[4:7], a[68:71], v[80:95]
    ds_read_b64_tr_b16 a[38:39], v13 offset:33792
    ds_read_b128 a[104:107], v15 offset:33792
    buffer_load_dwordx4 v4, s[8:11], s35 offen offset:2048 lds
    v_mfma_f32_32x32x16_bf16 v[32:47], a[8:11], a[72:75], v[32:47]
    ds_read_b128 a[108:111], v15 offset:37888
    ds_read_b64_tr_b16 a[40:41], v12 offset:36864
    v_mfma_f32_32x32x16_bf16 v[48:63], a[8:11], a[76:79], v[48:63]
    buffer_load_dwordx4 v5, s[8:11], s35 offen offset:3072 lds
    ds_read_b64_tr_b16 a[42:43], v12 offset:37888
    ds_read_b64_tr_b16 a[44:45], v13 offset:36864
    v_mfma_f32_32x32x16_bf16 v[64:79], a[12:15], a[72:75], v[64:79]
    s_add_u32 s35, s35, 65536
    ds_read_b64_tr_b16 a[46:47], v13 offset:37888
    v_mfma_f32_32x32x16_bf16 v[80:95], a[12:15], a[76:79], v[80:95]
    ds_read_b128 a[112:115], v15 offset:34816
    s_add_u32 m0, s37, 81920
    ds_read_b128 a[116:119], v15 offset:38912
    v_mfma_f32_32x32x16_bf16 v[32:47], a[16:19], a[80:83], v[32:47]
    ds_read_b64_tr_b16 a[48:49], v12 offset:40960
    buffer_load_dwordx4 v6, s[12:15], s36 offen offset:0 sc1 lds
    ds_read_b64_tr_b16 a[50:51], v12 offset:41984
    v_mfma_f32_32x32x16_bf16 v[48:63], a[16:19], a[84:87], v[48:63]
    ds_read_b64_tr_b16 a[52:53], v13 offset:40960
    buffer_load_dwordx4 v6, s[12:15], s36 offen offset:1024 sc1 lds
    v_mfma_f32_32x32x16_bf16 v[64:79], a[20:23], a[80:83], v[64:79]
    ds_read_b64_tr_b16 a[54:55], v13 offset:41984
    ds_read_b128 a[120:123], v15 offset:35840
    buffer_load_dwordx4 v6, s[12:15], s36 offen offset:2048 sc1 lds
    v_mfma_f32_32x32x16_bf16 v[80:95], a[20:23], a[84:87], v[80:95]
    ds_read_b128 a[124:127], v15 offset:39936
    ds_read_b64_tr_b16 a[56:57], v12 offset:45056
    v_mfma_f32_32x32x16_bf16 v[32:47], a[24:27], a[88:91], v[32:47]
    buffer_load_dwordx4 v6, s[12:15], s36 offen offset:3072 sc1 lds
    ds_read_b64_tr_b16 a[58:59], v12 offset:46080
    ds_read_b64_tr_b16 a[60:61], v13 offset:45056
    v_mfma_f32_32x32x16_bf16 v[48:63], a[24:27], a[92:95], v[48:63]
    s_add_u32 s36, s36, 4096
    ds_read_b64_tr_b16 a[62:63], v13 offset:46080
    v_mfma_f32_32x32x16_bf16 v[64:79], a[28:31], a[88:91], v[64:79]
    v_mfma_f32_32x32x16_bf16 v[80:95], a[28:31], a[92:95], v[80:95]
    s_waitcnt lgkmcnt(0)
    s_waitcnt vmcnt(18)
    s_barrier
    v_mfma_f32_32x32x16_bf16 v[32:47], a[32:35], a[96:99], v[32:47]
    ds_read_b128 a[64:67], v14 offset:0
    s_add_u32 m0, s37, 98304
    ds_read_b128 a[68:71], v14 offset:4096
    v_mfma_f32_32x32x16_bf16 v[48:63], a[32:35], a[100:103], v[48:63]
    ds_read_b64_tr_b16 a[0:1], v10 offset:0
    buffer_load_dwordx4 v2, s[8:11], s35 offen offset:0 lds
    ds_read_b64_tr_b16 a[2:3], v10 offset:1024
    v_mfma_f32_32x32x16_bf16 v[64:79], a[36:39], a[96:99], v[64:79]
    ds_read_b64_tr_b16 a[4:5], v11 offset:0
    buffer_load_dwordx4 v3, s[8:11], s35 offen offset:1024 lds
    v_mfma_f32_32x32x16_bf16 v[80:95], a[36:39], a[100:103], v[80:95]
    ds_read_b64_tr_b16 a[6:7], v11 offset:1024
    ds_read_b128 a[72:75], v14 offset:1024
    buffer_load_dwordx4 v4, s[8:11], s35 offen offset:2048 lds
    v_mfma_f32_32x32x16_bf16 v[32:47], a[40:43], a[104:107], v[32:47]
    ds_read_b128 a[76:79], v14 offset:5120
    ds_read_b64_tr_b16 a[8:9], v10 offset:4096
    v_mfma_f32_32x32x16_bf16 v[48:63], a[40:43], a[108:111], v[48:63]
    buffer_load_dwordx4 v5, s[8:11], s35 offen offset:3072 lds
    ds_read_b64_tr_b16 a[10:11], v10 offset:5120
    ds_read_b64_tr_b16 a[12:13], v11 offset:4096
    v_mfma_f32_32x32x16_bf16 v[64:79], a[44:47], a[104:107], v[64:79]
    s_add_u32 s35, s35, 65536
    ds_read_b64_tr_b16 a[14:15], v11 offset:5120
    v_mfma_f32_32x32x16_bf16 v[80:95], a[44:47], a[108:111], v[80:95]
    ds_read_b128 a[80:83], v14 offset:2048
    s_add_u32 m0, s37, 114688
    ds_read_b128 a[84:87], v14 offset:6144
    v_mfma_f32_32x32x16_bf16 v[32:47], a[48:51], a[112:115], v[32:47]
    ds_read_b64_tr_b16 a[16:17], v10 offset:8192
    buffer_load_dwordx4 v6, s[12:15], s36 offen offset:0 sc1 lds
    ds_read_b64_tr_b16 a[18:19], v10 offset:9216
    v_mfma_f32_32x32x16_bf16 v[48:63], a[48:51], a[116:119], v[48:63]
    ds_read_b64_tr_b16 a[20:21], v11 offset:8192
    buffer_load_dwordx4 v6, s[12:15], s36 offen offset:1024 sc1 lds
    v_mfma_f32_32x32x16_bf16 v[64:79], a[52:55], a[112:115], v[64:79]
    ds_read_b64_tr_b16 a[22:23], v11 offset:9216
    ds_read_b128 a[88:91], v14 offset:3072
    buffer_load_dwordx4 v6, s[12:15], s36 offen offset:2048 sc1 lds
    v_mfma_f32_32x32x16_bf16 v[80:95], a[52:55], a[116:119], v[80:95]
    ds_read_b128 a[92:95], v14 offset:7168
    ds_read_b64_tr_b16 a[24:25], v10 offset:12288
    v_mfma_f32_32x32x16_bf16 v[32:47], a[56:59], a[120:123], v[32:47]
    buffer_load_dwordx4 v6, s[12:15], s36 offen offset:3072 sc1 lds
    ds_read_b64_tr_b16 a[26:27], v10 offset:13312
    ds_read_b64_tr_b16 a[28:29], v11 offset:12288
    v_mfma_f32_32x32x16_bf16 v[48:63], a[56:59], a[124:127], v[48:63]
    s_add_u32 s36, s36, 4096
    ds_read_b64_tr_b16 a[30:31], v11 offset:13312
    v_mfma_f32_32x32x16_bf16 v[64:79], a[60:63], a[120:123], v[64:79]
    v_mfma_f32_32x32x16_bf16 v[80:95], a[60:63], a[124:127], v[80:95]
    s_waitcnt lgkmcnt(0)
    s_waitcnt vmcnt(17)
    s_barrier
    v_mfma_f32_32x32x16_bf16 v[32:47], a[0:3], a[64:67], v[32:47]
    ds_read_b128 a[96:99], v14 offset:32768
    ds_read_b128 a[100:103], v14 offset:36864
    v_mfma_f32_32x32x16_bf16 v[48:63], a[0:3], a[68:71], v[48:63]
    ds_read_b64_tr_b16 a[32:33], v10 offset:32768
    ds_read_b64_tr_b16 a[34:35], v10 offset:33792
    v_mfma_f32_32x32x16_bf16 v[64:79], a[4:7], a[64:67], v[64:79]
    ds_read_b64_tr_b16 a[36:37], v11 offset:32768
    ds_read_b64_tr_b16 a[38:39], v11 offset:33792
    v_mfma_f32_32x32x16_bf16 v[80:95], a[4:7], a[68:71], v[80:95]
    ds_read_b128 a[104:107], v14 offset:33792
    v_mfma_f32_32x32x16_bf16 v[32:47], a[8:11], a[72:75], v[32:47]
    ds_read_b128 a[108:111], v14 offset:37888
    ds_read_b64_tr_b16 a[40:41], v10 offset:36864
    v_mfma_f32_32x32x16_bf16 v[48:63], a[8:11], a[76:79], v[48:63]
    ds_read_b64_tr_b16 a[42:43], v10 offset:37888
    ds_read_b64_tr_b16 a[44:45], v11 offset:36864
    v_mfma_f32_32x32x16_bf16 v[64:79], a[12:15], a[72:75], v[64:79]
    ds_read_b64_tr_b16 a[46:47], v11 offset:37888
    v_mfma_f32_32x32x16_bf16 v[80:95], a[12:15], a[76:79], v[80:95]
    ds_read_b128 a[112:115], v14 offset:34816
    ds_read_b128 a[116:119], v14 offset:38912
    v_mfma_f32_32x32x16_bf16 v[32:47], a[16:19], a[80:83], v[32:47]
    ds_read_b64_tr_b16 a[48:49], v10 offset:40960
    ds_read_b64_tr_b16 a[50:51], v10 offset:41984
    v_mfma_f32_32x32x16_bf16 v[48:63], a[16:19], a[84:87], v[48:63]
    ds_read_b64_tr_b16 a[52:53], v11 offset:40960
    ds_read_b64_tr_b16 a[54:55], v11 offset:41984
    v_mfma_f32_32x32x16_bf16 v[64:79], a[20:23], a[80:83], v[64:79]
    ds_read_b128 a[120:123], v14 offset:35840
    v_mfma_f32_32x32x16_bf16 v[80:95], a[20:23], a[84:87], v[80:95]
    ds_read_b128 a[124:127], v14 offset:39936
    ds_read_b64_tr_b16 a[56:57], v10 offset:45056
    v_mfma_f32_32x32x16_bf16 v[32:47], a[24:27], a[88:91], v[32:47]
    ds_read_b64_tr_b16 a[58:59], v10 offset:46080
    ds_read_b64_tr_b16 a[60:61], v11 offset:45056
    v_mfma_f32_32x32x16_bf16 v[48:63], a[24:27], a[92:95], v[48:63]
    ds_read_b64_tr_b16 a[62:63], v11 offset:46080
    v_mfma_f32_32x32x16_bf16 v[64:79], a[28:31], a[88:91], v[64:79]
    v_mfma_f32_32x32x16_bf16 v[80:95], a[28:31], a[92:95], v[80:95]
    s_waitcnt lgkmcnt(0)
    s_waitcnt vmcnt(8)
    s_barrier
    v_mfma_f32_32x32x16_bf16 v[32:47], a[32:35], a[96:99], v[32:47]
    ds_read_b128 a[64:67], v15 offset:0
    ds_read_b128 a[68:71], v15 offset:4096
    v_mfma_f32_32x32x16_bf16 v[48:63], a[32:35], a[100:103], v[48:63]
    ds_read_b64_tr_b16 a[0:1], v12 offset:0
    ds_read_b64_tr_b16 a[2:3], v12 offset:1024
    v_mfma_f32_32x32x16_bf16 v[64:79], a[36:39], a[96:99], v[64:79]
    ds_read_b64_tr_b16 a[4:5], v13 offset:0
    ds_read_b64_tr_b16 a[6:7], v13 offset:1024
    v_mfma_f32_32x32x16_bf16 v[80:95], a[36:39], a[100:103], v[80:95]
    ds_read_b128 a[72:75], v15 offset:1024
    v_mfma_f32_32x32x16_bf16 v[32:47], a[40:43], a[104:107], v[32:47]
    ds_read_b128 a[76:79], v15 offset:5120
    ds_read_b64_tr_b16 a[8:9], v12 offset:4096
    v_mfma_f32_32x32x16_bf16 v[48:63], a[40:43], a[108:111], v[48:63]
    ds_read_b64_tr_b16 a[10:11], v12 offset:5120
    ds_read_b64_tr_b16 a[12:13], v13 offset:4096
    v_mfma_f32_32x32x16_bf16 v[64:79], a[44:47], a[104:107], v[64:79]
    ds_read_b64_tr_b16 a[14:15], v13 offset:5120
    v_mfma_f32_32x32x16_bf16 v[80:95], a[44:47], a[108:111], v[80:95]
    ds_read_b128 a[80:83], v15 offset:2048
    ds_read_b128 a[84:87], v15 offset:6144
    v_mfma_f32_32x32x16_bf16 v[32:47], a[48:51], a[112:115], v[32:47]
    ds_read_b64_tr_b16 a[16:17], v12 offset:8192
    ds_read_b64_tr_b16 a[18:19], v12 offset:9216
    v_mfma_f32_32x32x16_bf16 v[48:63], a[48:51], a[116:119], v[48:63]
    ds_read_b64_tr_b16 a[20:21], v13 offset:8192
    ds_read_b64_tr_b16 a[22:23], v13 offset:9216
    v_mfma_f32_32x32x16_bf16 v[64:79], a[52:55], a[112:115], v[64:79]
    ds_read_b128 a[88:91], v15 offset:3072
    v_mfma_f32_32x32x16_bf16 v[80:95], a[52:55], a[116:119], v[80:95]
    ds_read_b128 a[92:95], v15 offset:7168
    ds_read_b64_tr_b16 a[24:25], v12 offset:12288
    v_mfma_f32_32x32x16_bf16 v[32:47], a[56:59], a[120:123], v[32:47]
    ds_read_b64_tr_b16 a[26:27], v12 offset:13312
    ds_read_b64_tr_b16 a[28:29], v13 offset:12288
    v_mfma_f32_32x32x16_bf16 v[48:63], a[56:59], a[124:127], v[48:63]
    ds_read_b64_tr_b16 a[30:31], v13 offset:13312
    v_mfma_f32_32x32x16_bf16 v[64:79], a[60:63], a[120:123], v[64:79]
    v_mfma_f32_32x32x16_bf16 v[80:95], a[60:63], a[124:127], v[80:95]
    s_waitcnt lgkmcnt(0)
    s_waitcnt vmcnt(0)
    s_barrier
    v_mfma_f32_32x32x16_bf16 v[32:47], a[0:3], a[64:67], v[32:47]
    ds_read_b128 a[96:99], v15 offset:32768
    ds_read_b128 a[100:103], v15 offset:36864
    v_mfma_f32_32x32x16_bf16 v[48:63], a[0:3], a[68:71], v[48:63]
    ds_read_b64_tr_b16 a[32:33], v12 offset:32768
    ds_read_b64_tr_b16 a[34:35], v12 offset:33792
    v_mfma_f32_32x32x16_bf16 v[64:79], a[4:7], a[64:67], v[64:79]
    ds_read_b64_tr_b16 a[36:37], v13 offset:32768
    ds_read_b64_tr_b16 a[38:39], v13 offset:33792
    v_mfma_f32_32x32x16_bf16 v[80:95], a[4:7], a[68:71], v[80:95]
    ds_read_b128 a[104:107], v15 offset:33792
    v_mfma_f32_32x32x16_bf16 v[32:47], a[8:11], a[72:75], v[32:47]
    ds_read_b128 a[108:111], v15 offset:37888
    ds_read_b64_tr_b16 a[40:41], v12 offset:36864
    v_mfma_f32_32x32x16_bf16 v[48:63], a[8:11], a[76:79], v[48:63]
    ds_read_b64_tr_b16 a[42:43], v12 offset:37888
    ds_read_b64_tr_b16 a[44:45], v13 offset:36864
    v_mfma_f32_32x32x16_bf16 v[64:79], a[12:15], a[72:75], v[64:79]
    ds_read_b64_tr_b16 a[46:47], v13 offset:37888
    v_mfma_f32_32x32x16_bf16 v[80:95], a[12:15], a[76:79], v[80:95]
    ds_read_b128 a[112:115], v15 offset:34816
    ds_read_b128 a[116:119], v15 offset:38912
    v_mfma_f32_32x32x16_bf16 v[32:47], a[16:19], a[80:83], v[32:47]
    ds_read_b64_tr_b16 a[48:49], v12 offset:40960
    ds_read_b64_tr_b16 a[50:51], v12 offset:41984
    v_mfma_f32_32x32x16_bf16 v[48:63], a[16:19], a[84:87], v[48:63]
    ds_read_b64_tr_b16 a[52:53], v13 offset:40960
    ds_read_b64_tr_b16 a[54:55], v13 offset:41984
    v_mfma_f32_32x32x16_bf16 v[64:79], a[20:23], a[80:83], v[64:79]
    ds_read_b128 a[120:123], v15 offset:35840
    v_mfma_f32_32x32x16_bf16 v[80:95], a[20:23], a[84:87], v[80:95]
    ds_read_b128 a[124:127], v15 offset:39936
    ds_read_b64_tr_b16 a[56:57], v12 offset:45056
    v_mfma_f32_32x32x16_bf16 v[32:47], a[24:27], a[88:91], v[32:47]
    ds_read_b64_tr_b16 a[58:59], v12 offset:46080
    ds_read_b64_tr_b16 a[60:61], v13 offset:45056
    v_mfma_f32_32x32x16_bf16 v[48:63], a[24:27], a[92:95], v[48:63]
    ds_read_b64_tr_b16 a[62:63], v13 offset:46080
    v_mfma_f32_32x32x16_bf16 v[64:79], a[28:31], a[88:91], v[64:79]
    v_mfma_f32_32x32x16_bf16 v[80:95], a[28:31], a[92:95], v[80:95]
    s_waitcnt lgkmcnt(0)
    v_mfma_f32_32x32x16_bf16 v[32:47], a[32:35], a[96:99], v[32:47]
    v_mfma_f32_32x32x16_bf16 v[48:63], a[32:35], a[100:103], v[48:63]
    v_mfma_f32_32x32x16_bf16 v[64:79], a[36:39], a[96:99], v[64:79]
    v_mfma_f32_32x32x16_bf16 v[80:95], a[36:39], a[100:103], v[80:95]
    v_mfma_f32_32x32x16_bf16 v[32:47], a[40:43], a[104:107], v[32:47]
    v_mfma_f32_32x32x16_bf16 v[48:63], a[40:43], a[108:111], v[48:63]
    v_mfma_f32_32x32x16_bf16 v[64:79], a[44:47], a[104:107], v[64:79]
    v_mfma_f32_32x32x16_bf16 v[80:95], a[44:47], a[108:111], v[80:95]
    v_mfma_f32_32x32x16_bf16 v[32:47], a[48:51], a[112:115], v[32:47]
    v_mfma_f32_32x32x16_bf16 v[48:63], a[48:51], a[116:119], v[48:63]
    v_mfma_f32_32x32x16_bf16 v[64:79], a[52:55], a[112:115], v[64:79]
    v_mfma_f32_32x32x16_bf16 v[80:95], a[52:55], a[116:119], v[80:95]
    v_mfma_f32_32x32x16_bf16 v[32:47], a[56:59], a[120:123], v[32:47]
    v_mfma_f32_32x32x16_bf16 v[48:63], a[56:59], a[124:127], v[48:63]
    v_mfma_f32_32x32x16_bf16 v[64:79], a[60:63], a[120:123], v[64:79]
    v_mfma_f32_32x32x16_bf16 v[80:95], a[60:63], a[124:127], v[80:95]
    s_barrier
    s_load_dwordx2 s[44:45], s[0:1], 0
    s_load_dwordx2 s[52:53], s[0:1], 48
    s_nop 9
    v_cvt_pk_bf16_f32 v96, v32, v33
    v_cvt_pk_bf16_f32 v97, v34, v35
    v_cvt_pk_bf16_f32 v98, v36, v37
    v_cvt_pk_bf16_f32 v99, v38, v39
    s_mov_b32 s48, 0
    buffer_store_dwordx4 v[96:99], v16, s[16:19], s48 offen offset:0 sc1
    v_cvt_pk_bf16_f32 v100, v40, v41
    v_cvt_pk_bf16_f32 v101, v42, v43
    v_cvt_pk_bf16_f32 v102, v44, v45
    v_cvt_pk_bf16_f32 v103, v46, v47
    s_mov_b32 s48, 0
    buffer_store_dwordx4 v[100:103], v16, s[16:19], s48 offen offset:1024 sc1
    v_cvt_pk_bf16_f32 v104, v64, v65
    v_cvt_pk_bf16_f32 v105, v66, v67
    v_cvt_pk_bf16_f32 v106, v68, v69
    v_cvt_pk_bf16_f32 v107, v70, v71
    s_mov_b32 s48, 0
    buffer_store_dwordx4 v[104:107], v16, s[16:19], s48 offen offset:2048 sc1
    v_cvt_pk_bf16_f32 v108, v72, v73
    v_cvt_pk_bf16_f32 v109, v74, v75
    v_cvt_pk_bf16_f32 v110, v76, v77
    v_cvt_pk_bf16_f32 v111, v78, v79
    s_mov_b32 s48, 0
    buffer_store_dwordx4 v[108:111], v16, s[16:19], s48 offen offset:3072 sc1
    v_cvt_pk_bf16_f32 v112, v48, v49
    v_cvt_pk_bf16_f32 v113, v50, v51
    v_cvt_pk_bf16_f32 v114, v52, v53
    v_cvt_pk_bf16_f32 v115, v54, v55
    s_mov_b32 s48, 32768
    buffer_store_dwordx4 v[112:115], v16, s[16:19], s48 offen offset:0 sc1
    v_cvt_pk_bf16_f32 v116, v56, v57
    v_cvt_pk_bf16_f32 v117, v58, v59
    v_cvt_pk_bf16_f32 v118, v60, v61
    v_cvt_pk_bf16_f32 v119, v62, v63
    s_mov_b32 s48, 32768
    buffer_store_dwordx4 v[116:119], v16, s[16:19], s48 offen offset:1024 sc1
    v_cvt_pk_bf16_f32 v120, v80, v81
    v_cvt_pk_bf16_f32 v121, v82, v83
    v_cvt_pk_bf16_f32 v122, v84, v85
    v_cvt_pk_bf16_f32 v123, v86, v87
    s_mov_b32 s48, 32768
    buffer_store_dwordx4 v[120:123], v16, s[16:19], s48 offen offset:2048 sc1
    v_cvt_pk_bf16_f32 v124, v88, v89
    v_cvt_pk_bf16_f32 v125, v90, v91
    v_cvt_pk_bf16_f32 v126, v92, v93
    v_cvt_pk_bf16_f32 v127, v94, v95
    s_mov_b32 s48, 32768
    buffer_store_dwordx4 v[124:127], v16, s[16:19], s48 offen offset:3072 sc1
    v_and_b32 v200, 7, v0
    v_lshrrev_b32 v201, 3, v0
    s_waitcnt lgkmcnt(0)
    s_add_u32 s72, s44, 0
    s_addc_u32 s73, s45, 0
    s_mov_b32 s74, 2097152
    s_mov_b32 s75, 0x00020000
    s_add_u32 s76, s46, 20971520
    s_addc_u32 s77, s47, 0
    s_mov_b32 s78, 8388608
    s_mov_b32 s79, 0x00020000
    s_add_u32 s80, s46, 0
    s_addc_u32 s81, s47, 0
    s_mov_b32 s82, 16384
    s_mov_b32 s83, 0x00020000
    s_add_u32 s84, s46, 37748736
    s_addc_u32 s85, s47, 0
    s_mov_b32 s86, 2097152
    s_mov_b32 s87, 0x00020000
    s_add_u32 s88, s46, 39845888
    s_addc_u32 s89, s47, 0
    s_mov_b32 s90, 2097152
    s_mov_b32 s91, 0x00020000
    s_add_u32 s92, s46, 41943040
    s_addc_u32 s93, s47, 0
    s_mov_b32 s94, 2097152
    s_mov_b32 s95, 0x00020000
    s_lshr_b32 s48, s2, 2
    s_lshl_b32 s48, s48, 15
    s_and_b32 s49, s2, 3
    s_lshl_b32 s49, s49, 7
    s_add_u32 s48, s48, s49
    v_lshlrev_b32 v202, 9, v201
    v_lshl_add_u32 v202, v200, 4, v202
    v_add_u32 v202, s48, v202
    v_add_u32 v203, 16384, v202
    s_lshl_b32 s48, s2, 13
    v_lshlrev_b32 v204, 10, v200
    v_lshl_add_u32 v204, v201, 4, v204
    v_add_u32 v204, s48, v204
    v_lshlrev_b32 v205, 5, v201
    s_and_b32 s48, s2, 7
    s_lshr_b32 s49, s2, 3
    s_lshl_b32 s48, s48, 2
    s_lshr_b32 s50, s49, 3
    s_add_u32 s48, s48, s50
    s_lshl_b32 s38, s48, 6
    s_and_b32 s49, s49, 7
    s_lshl_b32 s39, s49, 6
    s_add_u32 s8, s52, 0
    s_addc_u32 s9, s53, 0
    s_mov_b32 s10, 524288
    s_mov_b32 s11, 0x00020000
    s_add_u32 s12, s46, 41943040
    s_addc_u32 s13, s47, 0
    s_mov_b32 s14, 2097152
    s_mov_b32 s15, 0x00020000
    s_add_u32 s16, s46, 44040192
    s_addc_u32 s17, s47, 0
    s_mov_b32 s18, 2097152
    s_mov_b32 s19, 0x00020000
    s_lshl_b32 s37, s32, 12
    v_lshrrev_b32 v16, 3, v1
    v_and_b32 v17, 7, v1
    v_lshrrev_b32 v18, 1, v16
    v_and_b32 v18, 1, v18
    v_lshlrev_b32 v18, 2, v18
    v_xor_b32 v18, v18, v17
    v_lshlrev_b32 v18, 4, v18
    s_mov_b32 s41, 1024
    v_mul_lo_u32 v19, v16, s41
    v_add_u32 v18, v18, v19
    s_mul_i32 s41, s32, 32768
    v_add_u32 v18, s41, v18
    v_add_u32 v2, 0, v18
    v_add_u32 v3, 7168, v18
    v_add_u32 v4, 14336, v18
    v_add_u32 v5, 21504, v18
    s_lshr_b32 s41, s32, 1
    s_mul_i32 s41, s41, 32768
    s_and_b32 s42, s32, 1
    s_lshl_b32 s42, s42, 12
    s_add_u32 s41, s41, s42
    v_lshlrev_b32 v16, 4, v1
    v_add_u32 v6, s41, v16
    v_and_b32 v16, 15, v1
    v_lshrrev_b32 v16, 2, v16
    v_and_b32 v17, 3, v1
    v_lshrrev_b32 v18, 4, v1
    v_and_b32 v18, 1, v18
    v_lshrrev_b32 v19, 5, v1
    v_and_b32 v20, 1, v17
    v_lshl_add_u32 v20, v18, 1, v20
    v_lshlrev_b32 v20, 4, v20
    v_lshrrev_b32 v17, 1, v17
    v_lshl_add_u32 v20, v17, 3, v20
    v_lshl_add_u32 v20, v16, 7, v20
    v_lshl_add_u32 v20, v19, 10, v20
    v_lshrrev_b32 v16, 1, v16
    s_mul_i32 s41, s34, 1
    s_add_u32 s41, s41, 0
    v_xor_b32 v21, s41, v16
    v_lshl_add_u32 v10, v21, 6, v20
    v_add_u32 v12, 65536, v10
    s_mul_i32 s41, s33, 8192
    s_add_u32 s41, s41, 16384
    v_lshlrev_b32 v16, 4, v1
    v_add_u32 v14, s41, v16
    v_add_u32 v15, 65536, v14
    s_lshl_b32 s35, s39, 1
    s_lshl_b32 s36, s38, 10
    s_lshr_b32 s48, s38, 5
    s_mul_i32 s49, s33, 1
    s_add_u32 s48, s48, s49
    s_mul_i32 s48, s48, 32
    s_lshr_b32 s49, s39, 4
    s_add_u32 s48, s48, s49
    s_mul_i32 s49, s34, 2
    s_add_u32 s48, s48, s49
    s_lshl_b32 s48, s48, 10
    v_lshlrev_b32 v16, 4, v1
    v_add_u32 v16, s48, v16
    v_mov_b32 v31, 0xc0135761
    s_waitcnt vmcnt(0)
    s_barrier
    s_cmp_lg_u32 s32, 0
    s_cbranch_scc1 L_sig5
    v_mov_b32 v216, 0
    v_mov_b32 v217, s100
    s_mov_b64 exec, 1
    buffer_store_dword v217, v216, s[68:71], s64 offen sc1
    s_mov_b64 exec, -1
L_sig5:
    s_and_b32 s65, s2, 0xf0
    s_add_u32 s65, s65, 576
    s_lshl_b32 s65, s65, 7
    s_cmp_eq_u32 s32, 1
    s_cbranch_scc1 L_wp6
    buffer_load_dwordx4 v[128:131], v204, s[72:75], 0 offen offset:0
    buffer_load_dwordx4 v[132:135], v204, s[72:75], 0 offen offset:512
    s_mov_b32 s48, 0
    buffer_load_dwordx4 v[136:139], v205, s[80:83], s48 offen offset:0 sc1
    s_mov_b32 s48, 0
    buffer_load_dwordx4 v[140:143], v205, s[80:83], s48 offen offset:16 sc1
    s_mov_b32 s48, 4096
    buffer_load_dwordx4 v[144:147], v205, s[80:83], s48 offen offset:0 sc1
    s_mov_b32 s48, 4096
    buffer_load_dwordx4 v[148:151], v205, s[80:83], s48 offen offset:16 sc1
    s_mov_b32 s48, 2048
    buffer_load_dwordx4 v[152:155], v205, s[80:83], s48 offen offset:0 sc1
    s_mov_b32 s48, 2048
    buffer_load_dwordx4 v[156:159], v205, s[80:83], s48 offen offset:16 sc1
    s_mov_b32 s48, 1024
    buffer_load_dwordx4 v[160:163], v205, s[80:83], s48 offen offset:0 sc1
    s_mov_b32 s48, 1024
    buffer_load_dwordx4 v[164:167], v205, s[80:83], s48 offen offset:16 sc1
    s_mov_b32 s48, 5120
    buffer_load_dwordx4 v[168:171], v205, s[80:83], s48 offen offset:0 sc1
    s_mov_b32 s48, 5120
    buffer_load_dwordx4 v[172:175], v205, s[80:83], s48 offen offset:16 sc1
    s_mov_b32 s48, 3072
    buffer_load_dwordx4 v[176:179], v205, s[80:83], s48 offen offset:0 sc1
    s_mov_b32 s48, 3072
    buffer_load_dwordx4 v[180:183], v205, s[80:83], s48 offen offset:16 sc1
    s_add_u32 m0, s37, 0
    s_nop 0
    buffer_load_dwordx4 v2, s[8:11], s35 offen offset:0 lds
    buffer_load_dwordx4 v3, s[8:11], s35 offen offset:1024 lds
    buffer_load_dwordx4 v4, s[8:11], s35 offen offset:2048 lds
    buffer_load_dwordx4 v5, s[8:11], s35 offen offset:3072 lds
    s_add_u32 s35, s35, 131072
    s_add_u32 m0, s37, 32768
    s_nop 0
    buffer_load_dwordx4 v2, s[8:11], s35 offen offset:0 lds
    buffer_load_dwordx4 v3, s[8:11], s35 offen offset:1024 lds
    buffer_load_dwordx4 v4, s[8:11], s35 offen offset:2048 lds
    buffer_load_dwordx4 v5, s[8:11], s35 offen offset:3072 lds
    s_add_u32 s35, s35, 131072
    s_add_u32 m0, s37, 65536
    s_nop 0
    buffer_load_dwordx4 v2, s[8:11], s35 offen offset:0 lds
    buffer_load_dwordx4 v3, s[8:11], s35 offen offset:1024 lds
    buffer_load_dwordx4 v4, s[8:11], s35 offen offset:2048 lds
    buffer_load_dwordx4 v5, s[8:11], s35 offen offset:3072 lds
    s_add_u32 s35, s35, 131072
    s_add_u32 m0, s37, 98304
    s_nop 0
    buffer_load_dwordx4 v2, s[8:11], s35 offen offset:0 lds
    buffer_load_dwordx4 v3, s[8:11], s35 offen offset:1024 lds
    buffer_load_dwordx4 v4, s[8:11], s35 offen offset:2048 lds
    buffer_load_dwordx4 v5, s[8:11], s35 offen offset:3072 lds
    s_add_u32 s35, s35, 131072
    s_branch L_wdone6
L_wp6:
    s_mov_b32 s62, 524288
    v_min_u32 v216, 15, v1
    v_lshlrev_b32 v216, 7, v216
L_fp8:
    buffer_load_dword v217, v216, s[68:71], s65 offen sc1
    s_waitcnt vmcnt(0)
    v_cmp_ne_u32 vcc, s100, v217
    s_cbranch_vccz L_wgo6
    s_sleep 1
    s_sub_u32 s62, s62, 1
    s_cmp_lg_u32 s62, 0
    s_cbranch_scc1 L_fp8
L_wgo6:
    buffer_load_dwordx4 v[128:131], v204, s[72:75], 0 offen offset:0
    buffer_load_dwordx4 v[132:135], v204, s[72:75], 0 offen offset:512
    s_mov_b32 s48, 0
    buffer_load_dwordx4 v[136:139], v205, s[80:83], s48 offen offset:0 sc1
    s_mov_b32 s48, 0
    buffer_load_dwordx4 v[140:143], v205, s[80:83], s48 offen offset:16 sc1
    s_mov_b32 s48, 4096
    buffer_load_dwordx4 v[144:147], v205, s[80:83], s48 offen offset:0 sc1
    s_mov_b32 s48, 4096
    buffer_load_dwordx4 v[148:151], v205, s[80:83], s48 offen offset:16 sc1
    s_mov_b32 s48, 2048
    buffer_load_dwordx4 v[152:155], v205, s[80:83], s48 offen offset:0 sc1
    s_mov_b32 s48, 2048
    buffer_load_dwordx4 v[156:159], v205, s[80:83], s48 offen offset:16 sc1
    s_mov_b32 s48, 1024
    buffer_load_dwordx4 v[160:163], v205, s[80:83], s48 offen offset:0 sc1
    s_mov_b32 s48, 1024
    buffer_load_dwordx4 v[164:167], v205, s[80:83], s48 offen offset:16 sc1
    s_mov_b32 s48, 5120
    buffer_load_dwordx4 v[168:171], v205, s[80:83], s48 offen offset:0 sc1
    s_mov_b32 s48, 5120
    buffer_load_dwordx4 v[172:175], v205, s[80:83], s48 offen offset:16 sc1
    s_mov_b32 s48, 3072
    buffer_load_dwordx4 v[176:179], v205, s[80:83], s48 offen offset:0 sc1
    s_mov_b32 s48, 3072
    buffer_load_dwordx4 v[180:183], v205, s[80:83], s48 offen offset:16 sc1
    s_add_u32 m0, s37, 0
    s_nop 0
    buffer_load_dwordx4 v2, s[8:11], s35 offen offset:0 lds
    buffer_load_dwordx4 v3, s[8:11], s35 offen offset:1024 lds
    buffer_load_dwordx4 v4, s[8:11], s35 offen offset:2048 lds
    buffer_load_dwordx4 v5, s[8:11], s35 offen offset:3072 lds
    s_add_u32 s35, s35, 131072
    s_add_u32 m0, s37, 32768
    s_nop 0
    buffer_load_dwordx4 v2, s[8:11], s35 offen offset:0 lds
    buffer_load_dwordx4 v3, s[8:11], s35 offen offset:1024 lds
    buffer_load_dwordx4 v4, s[8:11], s35 offen offset:2048 lds
    buffer_load_dwordx4 v5, s[8:11], s35 offen offset:3072 lds
    s_add_u32 s35, s35, 131072
    s_add_u32 m0, s37, 65536
    s_nop 0
    buffer_load_dwordx4 v2, s[8:11], s35 offen offset:0 lds
    buffer_load_dwordx4 v3, s[8:11], s35 offen offset:1024 lds
    buffer_load_dwordx4 v4, s[8:11], s35 offen offset:2048 lds
    buffer_load_dwordx4 v5, s[8:11], s35 offen offset:3072 lds
    s_add_u32 s35, s35, 131072
    s_add_u32 m0, s37, 98304
    s_nop 0
    buffer_load_dwordx4 v2, s[8:11], s35 offen offset:0 lds
    buffer_load_dwordx4 v3, s[8:11], s35 offen offset:1024 lds
    buffer_load_dwordx4 v4, s[8:11], s35 offen offset:2048 lds
    buffer_load_dwordx4 v5, s[8:11], s35 offen offset:3072 lds
    s_add_u32 s35, s35, 131072
L_wdone6:
    s_barrier
    s_mov_b32 s48, 0
    buffer_load_dwordx4 v[96:99], v202, s[76:79], s48 offen sc1
    s_mov_b32 s48, 2097152
    buffer_load_dwordx4 v[100:103], v202, s[76:79], s48 offen sc1
    s_mov_b32 s48, 4194304
    buffer_load_dwordx4 v[104:107], v202, s[76:79], s48 offen sc1
    s_mov_b32 s48, 6291456
    buffer_load_dwordx4 v[108:111], v202, s[76:79], s48 offen sc1
    s_mov_b32 s48, 0
    buffer_load_dwordx4 v[112:115], v203, s[76:79], s48 offen sc1
    s_mov_b32 s48, 2097152
    buffer_load_dwordx4 v[116:119], v203, s[76:79], s48 offen sc1
    s_mov_b32 s48, 4194304
    buffer_load_dwordx4 v[120:123], v203, s[76:79], s48 offen sc1
    s_mov_b32 s48, 6291456
    buffer_load_dwordx4 v[124:127], v203, s[76:79], s48 offen sc1
    s_waitcnt vmcnt(4)
    v_lshlrev_b32 v184, 16, v96
    v_and_b32 v185, 0xffff0000, v96
    v_lshlrev_b32 v186, 16, v97
    v_and_b32 v187, 0xffff0000, v97
    v_lshlrev_b32 v188, 16, v98
    v_and_b32 v189, 0xffff0000, v98
    v_lshlrev_b32 v190, 16, v99
    v_and_b32 v191, 0xffff0000, v99
    v_lshlrev_b32 v206, 16, v100
    v_and_b32 v207, 0xffff0000, v100
    v_lshlrev_b32 v208, 16, v101
    v_and_b32 v209, 0xffff0000, v101
    v_lshlrev_b32 v210, 16, v102
    v_and_b32 v211, 0xffff0000, v102
    v_lshlrev_b32 v212, 16, v103
    v_and_b32 v213, 0xffff0000, v103
    v_pk_add_f32 v[184:185], v[184:185], v[206:207]
    v_pk_add_f32 v[186:187], v[186:187], v[208:209]
    v_pk_add_f32 v[188:189], v[188:189], v[210:211]
    v_pk_add_f32 v[190:191], v[190:191], v[212:213]
    v_lshlrev_b32 v206, 16, v104
    v_and_b32 v207, 0xffff0000, v104
    v_lshlrev_b32 v208, 16, v105
    v_and_b32 v209, 0xffff0000, v105
    v_lshlrev_b32 v210, 16, v106
    v_and_b32 v211, 0xffff0000, v106
    v_lshlrev_b32 v212, 16, v107
    v_and_b32 v213, 0xffff0000, v107
    v_pk_add_f32 v[184:185], v[184:185], v[206:207]
    v_pk_add_f32 v[186:187], v[186:187], v[208:209]
    v_pk_add_f32 v[188:189], v[188:189], v[210:211]
    v_pk_add_f32 v[190:191], v[190:191], v[212:213]
    v_lshlrev_b32 v206, 16, v108
    v_and_b32 v207, 0xffff0000, v108
    v_lshlrev_b32 v208, 16, v109
    v_and_b32 v209, 0xffff0000, v109
    v_lshlrev_b32 v210, 16, v110
    v_and_b32 v211, 0xffff0000, v110
    v_lshlrev_b32 v212, 16, v111
    v_and_b32 v213, 0xffff0000, v111
    v_pk_add_f32 v[184:185], v[184:185], v[206:207]
    v_pk_add_f32 v[186:187], v[186:187], v[208:209]
    v_pk_add_f32 v[188:189], v[188:189], v[210:211]
    v_pk_add_f32 v[190:191], v[190:191], v[212:213]
    s_waitcnt vmcnt(0)
    v_lshlrev_b32 v192, 16, v112
    v_and_b32 v193, 0xffff0000, v112
    v_lshlrev_b32 v194, 16, v113
    v_and_b32 v195, 0xffff0000, v113
    v_lshlrev_b32 v196, 16, v114
    v_and_b32 v197, 0xffff0000, v114
    v_lshlrev_b32 v198, 16, v115
    v_and_b32 v199, 0xffff0000, v115
    v_lshlrev_b32 v206, 16, v116
    v_and_b32 v207, 0xffff0000, v116
    v_lshlrev_b32 v208, 16, v117
    v_and_b32 v209, 0xffff0000, v117
    v_lshlrev_b32 v210, 16, v118
    v_and_b32 v211, 0xffff0000, v118
    v_lshlrev_b32 v212, 16, v119
    v_and_b32 v213, 0xffff0000, v119
    v_pk_add_f32 v[192:193], v[192:193], v[206:207]
    v_pk_add_f32 v[194:195], v[194:195], v[208:209]
    v_pk_add_f32 v[196:197], v[196:197], v[210:211]
    v_pk_add_f32 v[198:199], v[198:199], v[212:213]
    v_lshlrev_b32 v206, 16, v120
    v_and_b32 v207, 0xffff0000, v120
    v_lshlrev_b32 v208, 16, v121
    v_and_b32 v209, 0xffff0000, v121
    v_lshlrev_b32 v210, 16, v122
    v_and_b32 v211, 0xffff0000, v122
    v_lshlrev_b32 v212, 16, v123
    v_and_b32 v213, 0xffff0000, v123
    v_pk_add_f32 v[192:193], v[192:193], v[206:207]
    v_pk_add_f32 v[194:195], v[194:195], v[208:209]
    v_pk_add_f32 v[196:197], v[196:197], v[210:211]
    v_pk_add_f32 v[198:199], v[198:199], v[212:213]
    v_lshlrev_b32 v206, 16, v124
    v_and_b32 v207, 0xffff0000, v124
    v_lshlrev_b32 v208, 16, v125
    v_and_b32 v209, 0xffff0000, v125
    v_lshlrev_b32 v210, 16, v126
    v_and_b32 v211, 0xffff0000, v126
    v_lshlrev_b32 v212, 16, v127
    v_and_b32 v213, 0xffff0000, v127
    v_pk_add_f32 v[192:193], v[192:193], v[206:207]
    v_pk_add_f32 v[194:195], v[194:195], v[208:209]
    v_pk_add_f32 v[196:197], v[196:197], v[210:211]
    v_pk_add_f32 v[198:199], v[198:199], v[212:213]
    v_lshlrev_b32 v206, 16, v128
    v_and_b32 v207, 0xffff0000, v128
    v_lshlrev_b32 v208, 16, v129
    v_and_b32 v209, 0xffff0000, v129
    v_lshlrev_b32 v210, 16, v130
    v_and_b32 v211, 0xffff0000, v130
    v_lshlrev_b32 v212, 16, v131
    v_and_b32 v213, 0xffff0000, v131
    v_pk_fma_f32 v[184:185], v[184:185], v[136:137], v[206:207]
    v_pk_fma_f32 v[186:187], v[186:187], v[138:139], v[208:209]
    v_pk_fma_f32 v[188:189], v[188:189], v[140:141], v[210:211]
    v_pk_fma_f32 v[190:191], v[190:191], v[142:143], v[212:213]
    v_cvt_pk_bf16_f32 v96, v184, v185
    v_cvt_pk_bf16_f32 v97, v186, v187
    v_cvt_pk_bf16_f32 v98, v188, v189
    v_cvt_pk_bf16_f32 v99, v190, v191
    v_lshlrev_b32 v184, 16, v96
    v_and_b32 v185, 0xffff0000, v96
    v_lshlrev_b32 v186, 16, v97
    v_and_b32 v187, 0xffff0000, v97
    v_lshlrev_b32 v188, 16, v98
    v_and_b32 v189, 0xffff0000, v98
    v_lshlrev_b32 v190, 16, v99
    v_and_b32 v191, 0xffff0000, v99
    buffer_store_dwordx4 v[96:99], v202, s[84:87], 0 offen sc1
    v_lshlrev_b32 v206, 16, v132
    v_and_b32 v207, 0xffff0000, v132
    v_lshlrev_b32 v208, 16, v133
    v_and_b32 v209, 0xffff0000, v133
    v_lshlrev_b32 v210, 16, v134
    v_and_b32 v211, 0xffff0000, v134
    v_lshlrev_b32 v212, 16, v135
    v_and_b32 v213, 0xffff0000, v135
    v_pk_fma_f32 v[192:193], v[192:193], v[160:161], v[206:207]
    v_pk_fma_f32 v[194:195], v[194:195], v[162:163], v[208:209]
    v_pk_fma_f32 v[196:197], v[196:197], v[164:165], v[210:211]
    v_pk_fma_f32 v[198:199], v[198:199], v[166:167], v[212:213]
    v_cvt_pk_bf16_f32 v100, v192, v193
    v_cvt_pk_bf16_f32 v101, v194, v195
    v_cvt_pk_bf16_f32 v102, v196, v197
    v_cvt_pk_bf16_f32 v103, v198, v199
    v_lshlrev_b32 v192, 16, v100
    v_and_b32 v193, 0xffff0000, v100
    v_lshlrev_b32 v194, 16, v101
    v_and_b32 v195, 0xffff0000, v101
    v_lshlrev_b32 v196, 16, v102
    v_and_b32 v197, 0xffff0000, v102
    v_lshlrev_b32 v198, 16, v103
    v_and_b32 v199, 0xffff0000, v103
    buffer_store_dwordx4 v[100:103], v203, s[84:87], 0 offen sc1
    v_mov_b32 v214, 0
    v_mov_b32 v215, 0
    v_add_f32 v214, v214, v184
    v_fmac_f32 v215, v184, v184
    v_add_f32 v214, v214, v185
    v_fmac_f32 v215, v185, v185
    v_add_f32 v214, v214, v186
    v_fmac_f32 v215, v186, v186
    v_add_f32 v214, v214, v187
    v_fmac_f32 v215, v187, v187
    v_add_f32 v214, v214, v188
    v_fmac_f32 v215, v188, v188
    v_add_f32 v214, v214, v189
    v_fmac_f32 v215, v189, v189
    v_add_f32 v214, v214, v190
    v_fmac_f32 v215, v190, v190
    v_add_f32 v214, v214, v191
    v_fmac_f32 v215, v191, v191
    v_add_f32 v214, v214, v192
    v_fmac_f32 v215, v192, v192
    v_add_f32 v214, v214, v193
    v_fmac_f32 v215, v193, v193
    v_add_f32 v214, v214, v194
    v_fmac_f32 v215, v194, v194
    v_add_f32 v214, v214, v195
    v_fmac_f32 v215, v195, v195
    v_add_f32 v214, v214, v196
    v_fmac_f32 v215, v196, v196
    v_add_f32 v214, v214, v197
    v_fmac_f32 v215, v197, v197
    v_add_f32 v214, v214, v198
    v_fmac_f32 v215, v198, v198
    v_add_f32 v214, v214, v199
    v_fmac_f32 v215, v199, v199
    s_nop 1
    v_add_f32_dpp v214, v214, v214 row_ror:8 row_mask:0xf bank_mask:0xf
    v_add_f32_dpp v215, v215, v215 row_ror:8 row_mask:0xf bank_mask:0xf
    v_mov_b32 v206, v214
    v_mov_b32 v207, v215
    s_nop 1
    v_permlane16_swap_b32 v214, v206
    v_permlane16_swap_b32 v215, v207
    s_nop 1
    v_add_f32 v214, v214, v206
    v_add_f32 v215, v215, v207
    v_mov_b32 v206, v214
    v_mov_b32 v207, v215
    s_nop 1
    v_permlane32_swap_b32 v214, v206
    v_permlane32_swap_b32 v215, v207
    s_nop 1
    v_add_f32 v214, v214, v206
    v_add_f32 v215, v215, v207
    v_lshrrev_b32 v206, 6, v0
    v_lshlrev_b32 v206, 3, v206
    v_lshl_add_u32 v206, v200, 5, v206
    v_add_u32 v206, 131072, v206
    ds_write_b64 v206, v[214:215] offset:0
    s_waitcnt lgkmcnt(0)
    s_barrier
    v_lshlrev_b32 v206, 5, v200
    v_add_u32 v206, 131072, v206
    ds_read_b128 v[210:213], v206 offset:16
    ds_read_b128 v[206:209], v206 offset:0
    s_waitcnt lgkmcnt(0)
    v_add_f32 v206, v206, v208
    v_add_f32 v207, v207, v209
    v_add_f32 v210, v210, v212
    v_add_f32 v211, v211, v213
    v_add_f32 v214, v206, v210
    v_add_f32 v215, v207, v211
    v_mul_f32 v214, 0.001953125, v214
    v_mul_f32 v215, 0.001953125, v215
    v_fma_f32 v215, -v214, v214, v215
    v_max_f32 v215, 0, v215
    v_add_f32 v215, 0x3727c5ac, v215
    v_rsq_f32 v215, v215
    s_nop 0
    v_mul_f32 v214, v214, v215
    v_mov_b32 v206, v215
    v_mov_b32 v208, v214
    v_pk_fma_f32 v[184:185], v[184:185], v[206:207], v[208:209] op_sel_hi:[1,0,0] neg_lo:[0,0,1] neg_hi:[0,0,1]
    v_pk_fma_f32 v[186:187], v[186:187], v[206:207], v[208:209] op_sel_hi:[1,0,0] neg_lo:[0,0,1] neg_hi:[0,0,1]
    v_pk_fma_f32 v[188:189], v[188:189], v[206:207], v[208:209] op_sel_hi:[1,0,0] neg_lo:[0,0,1] neg_hi:[0,0,1]
    v_pk_fma_f32 v[190:191], v[190:191], v[206:207], v[208:209] op_sel_hi:[1,0,0] neg_lo:[0,0,1] neg_hi:[0,0,1]
    v_pk_fma_f32 v[184:185], v[184:185], v[144:145], v[152:153]
    v_pk_fma_f32 v[186:187], v[186:187], v[146:147], v[154:155]
    v_pk_fma_f32 v[188:189], v[188:189], v[148:149], v[156:157]
    v_pk_fma_f32 v[190:191], v[190:191], v[150:151], v[158:159]
    v_cvt_pk_bf16_f32 v104, v184, v185
    v_cvt_pk_bf16_f32 v105, v186, v187
    v_cvt_pk_bf16_f32 v106, v188, v189
    v_cvt_pk_bf16_f32 v107, v190, v191
    v_lshlrev_b32 v184, 16, v104
    v_and_b32 v185, 0xffff0000, v104
    v_lshlrev_b32 v186, 16, v105
    v_and_b32 v187, 0xffff0000, v105
    v_lshlrev_b32 v188, 16, v106
    v_and_b32 v189, 0xffff0000, v106
    v_lshlrev_b32 v190, 16, v107
    v_and_b32 v191, 0xffff0000, v107
    buffer_store_dwordx4 v[104:107], v202, s[88:91], 0 offen sc1
    v_pk_fma_f32 v[192:193], v[192:193], v[206:207], v[208:209] op_sel_hi:[1,0,0] neg_lo:[0,0,1] neg_hi:[0,0,1]
    v_pk_fma_f32 v[194:195], v[194:195], v[206:207], v[208:209] op_sel_hi:[1,0,0] neg_lo:[0,0,1] neg_hi:[0,0,1]
    v_pk_fma_f32 v[196:197], v[196:197], v[206:207], v[208:209] op_sel_hi:[1,0,0] neg_lo:[0,0,1] neg_hi:[0,0,1]
    v_pk_fma_f32 v[198:199], v[198:199], v[206:207], v[208:209] op_sel_hi:[1,0,0] neg_lo:[0,0,1] neg_hi:[0,0,1]
    v_pk_fma_f32 v[192:193], v[192:193], v[168:169], v[176:177]
    v_pk_fma_f32 v[194:195], v[194:195], v[170:171], v[178:179]
    v_pk_fma_f32 v[196:197], v[196:197], v[172:173], v[180:181]
    v_pk_fma_f32 v[198:199], v[198:199], v[174:175], v[182:183]
    v_cvt_pk_bf16_f32 v108, v192, v193
    v_cvt_pk_bf16_f32 v109, v194, v195
    v_cvt_pk_bf16_f32 v110, v196, v197
    v_cvt_pk_bf16_f32 v111, v198, v199
    v_lshlrev_b32 v192, 16, v108
    v_and_b32 v193, 0xffff0000, v108
    v_lshlrev_b32 v194, 16, v109
    v_and_b32 v195, 0xffff0000, v109
    v_lshlrev_b32 v196, 16, v110
    v_and_b32 v197, 0xffff0000, v110
    v_lshlrev_b32 v198, 16, v111
    v_and_b32 v199, 0xffff0000, v111
    buffer_store_dwordx4 v[108:111], v203, s[88:91], 0 offen sc1
    v_mov_b32 v214, 0
    v_mov_b32 v215, 0
    v_add_f32 v214, v214, v184
    v_fmac_f32 v215, v184, v184
    v_add_f32 v214, v214, v185
    v_fmac_f32 v215, v185, v185
    v_add_f32 v214, v214, v186
    v_fmac_f32 v215, v186, v186
    v_add_f32 v214, v214, v187
    v_fmac_f32 v215, v187, v187
    v_add_f32 v214, v214, v188
    v_fmac_f32 v215, v188, v188
    v_add_f32 v214, v214, v189
    v_fmac_f32 v215, v189, v189
    v_add_f32 v214, v214, v190
    v_fmac_f32 v215, v190, v190
    v_add_f32 v214, v214, v191
    v_fmac_f32 v215, v191, v191
    v_add_f32 v214, v214, v192
    v_fmac_f32 v215, v192, v192
    v_add_f32 v214, v214, v193
    v_fmac_f32 v215, v193, v193
    v_add_f32 v214, v214, v194
    v_fmac_f32 v215, v194, v194
    v_add_f32 v214, v214, v195
    v_fmac_f32 v215, v195, v195
    v_add_f32 v214, v214, v196
    v_fmac_f32 v215, v196, v196
    v_add_f32 v214, v214, v197
    v_fmac_f32 v215, v197, v197
    v_add_f32 v214, v214, v198
    v_fmac_f32 v215, v198, v198
    v_add_f32 v214, v214, v199
    v_fmac_f32 v215, v199, v199
    s_nop 1
    v_add_f32_dpp v214, v214, v214 row_ror:8 row_mask:0xf bank_mask:0xf
    v_add_f32_dpp v215, v215, v215 row_ror:8 row_mask:0xf bank_mask:0xf
    v_mov_b32 v206, v214
    v_mov_b32 v207, v215
    s_nop 1
    v_permlane16_swap_b32 v214, v206
    v_permlane16_swap_b32 v215, v207
    s_nop 1
    v_add_f32 v214, v214, v206
    v_add_f32 v215, v215, v207
    v_mov_b32 v206, v214
    v_mov_b32 v207, v215
    s_nop 1
    v_permlane32_swap_b32 v214, v206
    v_permlane32_swap_b32 v215, v207
    s_nop 1
    v_add_f32 v214, v214, v206
    v_add_f32 v215, v215, v207
    v_lshrrev_b32 v206, 6, v0
    v_lshlrev_b32 v206, 3, v206
    v_lshl_add_u32 v206, v200, 5, v206
    v_add_u32 v206, 131072, v206
    ds_write_b64 v206, v[214:215] offset:1024
    s_waitcnt lgkmcnt(0)
    s_barrier
    v_lshlrev_b32 v206, 5, v200
    v_add_u32 v206, 131072, v206
    ds_read_b128 v[210:213], v206 offset:1040
    ds_read_b128 v[206:209], v206 offset:1024
    s_waitcnt lgkmcnt(0)
    v_add_f32 v206, v206, v208
    v_add_f32 v207, v207, v209
    v_add_f32 v210, v210, v212
    v_add_f32 v211, v211, v213
    v_add_f32 v214, v206, v210
    v_add_f32 v215, v207, v211
    v_mul_f32 v214, 0.001953125, v214
    v_mul_f32 v215, 0.001953125, v215
    v_fma_f32 v215, -v214, v214, v215
    v_max_f32 v215, 0, v215
    v_add_f32 v215, 0x3727c5ac, v215
    v_rsq_f32 v215, v215
    s_nop 0
    v_mul_f32 v214, v214, v215
    v_mov_b32 v206, v215
    v_mov_b32 v208, v214
    v_pk_fma_f32 v[184:185], v[184:185], v[206:207], v[208:209] op_sel_hi:[1,0,0] neg_lo:[0,0,1] neg_hi:[0,0,1]
    v_pk_fma_f32 v[186:187], v[186:187], v[206:207], v[208:209] op_sel_hi:[1,0,0] neg_lo:[0,0,1] neg_hi:[0,0,1]
    v_pk_fma_f32 v[188:189], v[188:189], v[206:207], v[208:209] op_sel_hi:[1,0,0] neg_lo:[0,0,1] neg_hi:[0,0,1]
    v_pk_fma_f32 v[190:191], v[190:191], v[206:207], v[208:209] op_sel_hi:[1,0,0] neg_lo:[0,0,1] neg_hi:[0,0,1]
    v_cvt_pk_bf16_f32 v112, v184, v185
    v_cvt_pk_bf16_f32 v113, v186, v187
    v_cvt_pk_bf16_f32 v114, v188, v189
    v_cvt_pk_bf16_f32 v115, v190, v191
    buffer_store_dwordx4 v[112:115], v202, s[92:95], 0 offen sc1
    v_pk_fma_f32 v[192:193], v[192:193], v[206:207], v[208:209] op_sel_hi:[1,0,0] neg_lo:[0,0,1] neg_hi:[0,0,1]
    v_pk_fma_f32 v[194:195], v[194:195], v[206:207], v[208:209] op_sel_hi:[1,0,0] neg_lo:[0,0,1] neg_hi:[0,0,1]
    v_pk_fma_f32 v[196:197], v[196:197], v[206:207], v[208:209] op_sel_hi:[1,0,0] neg_lo:[0,0,1] neg_hi:[0,0,1]
    v_pk_fma_f32 v[198:199], v[198:199], v[206:207], v[208:209] op_sel_hi:[1,0,0] neg_lo:[0,0,1] neg_hi:[0,0,1]
    v_cvt_pk_bf16_f32 v116, v192, v193
    v_cvt_pk_bf16_f32 v117, v194, v195
    v_cvt_pk_bf16_f32 v118, v196, v197
    v_cvt_pk_bf16_f32 v119, v198, v199
    buffer_store_dwordx4 v[116:119], v203, s[92:95], 0 offen sc1
    s_lshr_b32 s64, s2, 0
    s_add_u32 s64, s64, 832
    s_lshl_b32 s64, s64, 7
    s_waitcnt vmcnt(0)
    s_barrier
    s_cmp_lg_u32 s32, 0
    s_cbranch_scc1 L_sig7
    v_mov_b32 v216, 0
    v_mov_b32 v217, s100
    s_mov_b64 exec, 1
    buffer_store_dword v217, v216, s[68:71], s64 offen sc1
    s_mov_b64 exec, -1
L_sig7:
    s_lshr_b32 s65, s38, 3
    s_add_u32 s65, s65, 832
    s_lshl_b32 s65, s65, 7
    s_cmp_eq_u32 s32, 1
    s_cbranch_scc1 L_wp8
    s_branch L_wdone8
L_wp8:
    s_mov_b32 s62, 524288
    v_min_u32 v216, 7, v1
    v_lshlrev_b32 v216, 7, v216
L_fp9:
    buffer_load_dword v217, v216, s[68:71], s65 offen sc1
    s_waitcnt vmcnt(0)
    v_cmp_ne_u32 vcc, s100, v217
    s_cbranch_vccz L_wgo8
    s_sleep 1
    s_sub_u32 s62, s62, 1
    s_cmp_lg_u32 s62, 0
    s_cbranch_scc1 L_fp9
L_wgo8:
L_wdone8:
    s_barrier
    s_add_u32 m0, s37, 16384
    s_nop 0
    buffer_load_dwordx4 v6, s[12:15], s36 offen offset:0 sc1 lds
    buffer_load_dwordx4 v6, s[12:15], s36 offen offset:1024 sc1 lds
    buffer_load_dwordx4 v6, s[12:15], s36 offen offset:2048 sc1 lds
    buffer_load_dwordx4 v6, s[12:15], s36 offen offset:3072 sc1 lds
    s_add_u32 s36, s36, 8192
    s_add_u32 m0, s37, 49152
    s_nop 0
    buffer_load_dwordx4 v6, s[12:15], s36 offen offset:0 sc1 lds
    buffer_load_dwordx4 v6, s[12:15], s36 offen offset:1024 sc1 lds
    buffer_load_dwordx4 v6, s[12:15], s36 offen offset:2048 sc1 lds
    buffer_load_dwordx4 v6, s[12:15], s36 offen offset:3072 sc1 lds
    s_add_u32 s36, s36, 8192
    s_add_u32 m0, s37, 81920
    s_nop 0
    buffer_load_dwordx4 v6, s[12:15], s36 offen offset:0 sc1 lds
    buffer_load_dwordx4 v6, s[12:15], s36 offen offset:1024 sc1 lds
    buffer_load_dwordx4 v6, s[12:15], s36 offen offset:2048 sc1 lds
    buffer_load_dwordx4 v6, s[12:15], s36 offen offset:3072 sc1 lds
    s_add_u32 s36, s36, 8192
    s_add_u32 m0, s37, 114688
    s_nop 0
    buffer_load_dwordx4 v6, s[12:15], s36 offen offset:0 sc1 lds
    buffer_load_dwordx4 v6, s[12:15], s36 offen offset:1024 sc1 lds
    buffer_load_dwordx4 v6, s[12:15], s36 offen offset:2048 sc1 lds
    buffer_load_dwordx4 v6, s[12:15], s36 offen offset:3072 sc1 lds
    s_add_u32 s36, s36, 8192
    s_load_dwordx2 s[44:45], s[0:1], 56
    s_waitcnt vmcnt(12)
    s_barrier
    ds_read_b128 a[64:67], v14 offset:0
    ds_read_b64_tr_b16 a[0:1], v10 offset:0
    ds_read_b64_tr_b16 a[2:3], v10 offset:512
    ds_read_b128 a[68:71], v14 offset:1024
    ds_read_b64_tr_b16 a[4:5], v10 offset:2048
    ds_read_b64_tr_b16 a[6:7], v10 offset:2560
    ds_read_b128 a[72:75], v14 offset:2048
    ds_read_b64_tr_b16 a[8:9], v10 offset:4096
    ds_read_b64_tr_b16 a[10:11], v10 offset:4608
    ds_read_b128 a[76:79], v14 offset:3072
    ds_read_b64_tr_b16 a[12:13], v10 offset:6144
    ds_read_b64_tr_b16 a[14:15], v10 offset:6656
    ds_read_b128 a[80:83], v14 offset:4096
    ds_read_b64_tr_b16 a[16:17], v10 offset:8192
    ds_read_b64_tr_b16 a[18:19], v10 offset:8704
    ds_read_b128 a[84:87], v14 offset:5120
    ds_read_b64_tr_b16 a[20:21], v10 offset:10240
    ds_read_b64_tr_b16 a[22:23], v10 offset:10752
    ds_read_b128 a[88:91], v14 offset:6144
    ds_read_b64_tr_b16 a[24:25], v10 offset:12288
    ds_read_b64_tr_b16 a[26:27], v10 offset:12800
    ds_read_b128 a[92:95], v14 offset:7168
    ds_read_b64_tr_b16 a[28:29], v10 offset:14336
    ds_read_b64_tr_b16 a[30:31], v10 offset:14848
    s_waitcnt lgkmcnt(0)
    s_waitcnt vmcnt(8)
    s_barrier
    v_mfma_f32_32x32x16_bf16 v[32:47], a[0:3], a[64:67], 0
    ds_read_b128 a[96:99], v14 offset:32768
    ds_read_b64_tr_b16 a[32:33], v10 offset:32768
    ds_read_b64_tr_b16 a[34:35], v10 offset:33280
    ds_read_b128 a[100:103], v14 offset:33792
    v_mfma_f32_32x32x16_bf16 v[32:47], a[4:7], a[68:71], v[32:47]
    ds_read_b64_tr_b16 a[36:37], v10 offset:34816
    ds_read_b64_tr_b16 a[38:39], v10 offset:35328
    ds_read_b128 a[104:107], v14 offset:34816
    ds_read_b64_tr_b16 a[40:41], v10 offset:36864
    v_mfma_f32_32x32x16_bf16 v[32:47], a[8:11], a[72:75], v[32:47]
    ds_read_b64_tr_b16 a[42:43], v10 offset:37376
    ds_read_b128 a[108:111], v14 offset:35840
    ds_read_b64_tr_b16 a[44:45], v10 offset:38912
    ds_read_b64_tr_b16 a[46:47], v10 offset:39424
    v_mfma_f32_32x32x16_bf16 v[32:47], a[12:15], a[76:79], v[32:47]
    ds_read_b128 a[112:115], v14 offset:36864
    ds_read_b64_tr_b16 a[48:49], v10 offset:40960
    ds_read_b64_tr_b16 a[50:51], v10 offset:41472
    ds_read_b128 a[116:119], v14 offset:37888
    v_mfma_f32_32x32x16_bf16 v[32:47], a[16:19], a[80:83], v[32:47]
    ds_read_b64_tr_b16 a[52:53], v10 offset:43008
    ds_read_b64_tr_b16 a[54:55], v10 offset:43520
    ds_read_b128 a[120:123], v14 offset:38912
    ds_read_b64_tr_b16 a[56:57], v10 offset:45056
    v_mfma_f32_32x32x16_bf16 v[32:47], a[20:23], a[84:87], v[32:47]
    ds_read_b64_tr_b16 a[58:59], v10 offset:45568
    ds_read_b128 a[124:127], v14 offset:39936
    ds_read_b64_tr_b16 a[60:61], v10 offset:47104
    ds_read_b64_tr_b16 a[62:63], v10 offset:47616
    v_mfma_f32_32x32x16_bf16 v[32:47], a[24:27], a[88:91], v[32:47]
    v_mfma_f32_32x32x16_bf16 v[32:47], a[28:31], a[92:95], v[32:47]
    s_waitcnt lgkmcnt(0)
    s_waitcnt vmcnt(4)
    s_barrier
    v_mfma_f32_32x32x16_bf16 v[32:47], a[32:35], a[96:99], v[32:47]
    ds_read_b128 a[64:67], v15 offset:0
    ds_read_b64_tr_b16 a[0:1], v12 offset:0
    ds_read_b64_tr_b16 a[2:3], v12 offset:512
    ds_read_b128 a[68:71], v15 offset:1024
    v_mfma_f32_32x32x16_bf16 v[32:47], a[36:39], a[100:103], v[32:47]
    ds_read_b64_tr_b16 a[4:5], v12 offset:2048
    ds_read_b64_tr_b16 a[6:7], v12 offset:2560
    ds_read_b128 a[72:75], v15 offset:2048
    ds_read_b64_tr_b16 a[8:9], v12 offset:4096
    v_mfma_f32_32x32x16_bf16 v[32:47], a[40:43], a[104:107], v[32:47]
    ds_read_b64_tr_b16 a[10:11], v12 offset:4608
    ds_read_b128 a[76:79], v15 offset:3072
    ds_read_b64_tr_b16 a[12:13], v12 offset:6144
    ds_read_b64_tr_b16 a[14:15], v12 offset:6656
    v_mfma_f32_32x32x16_bf16 v[32:47], a[44:47], a[108:111], v[32:47]
    ds_read_b128 a[80:83], v15 offset:4096
    ds_read_b64_tr_b16 a[16:17], v12 offset:8192
    ds_read_b64_tr_b16 a[18:19], v12 offset:8704
    ds_read_b128 a[84:87], v15 offset:5120
    v_mfma_f32_32x32x16_bf16 v[32:47], a[48:51], a[112:115], v[32:47]
    ds_read_b64_tr_b16 a[20:21], v12 offset:10240
    ds_read_b64_tr_b16 a[22:23], v12 offset:10752
    ds_read_b128 a[88:91], v15 offset:6144
    ds_read_b64_tr_b16 a[24:25], v12 offset:12288
    v_mfma_f32_32x32x16_bf16 v[32:47], a[52:55], a[116:119], v[32:47]
    ds_read_b64_tr_b16 a[26:27], v12 offset:12800
    ds_read_b128 a[92:95], v15 offset:7168
    ds_read_b64_tr_b16 a[28:29], v12 offset:14336
    ds_read_b64_tr_b16 a[30:31], v12 offset:14848
    v_mfma_f32_32x32x16_bf16 v[32:47], a[56:59], a[120:123], v[32:47]
    v_mfma_f32_32x32x16_bf16 v[32:47], a[60:63], a[124:127], v[32:47]
    s_waitcnt lgkmcnt(0)
    s_waitcnt vmcnt(0)
    s_barrier
    v_mfma_f32_32x32x16_bf16 v[32:47], a[0:3], a[64:67], v[32:47]
    ds_read_b128 a[96:99], v15 offset:32768
    ds_read_b64_tr_b16 a[32:33], v12 offset:32768
    ds_read_b64_tr_b16 a[34:35], v12 offset:33280
    ds_read_b128 a[100:103], v15 offset:33792
    v_mfma_f32_32x32x16_bf16 v[32:47], a[4:7], a[68:71], v[32:47]
    ds_read_b64_tr_b16 a[36:37], v12 offset:34816
    ds_read_b64_tr_b16 a[38:39], v12 offset:35328
    ds_read_b128 a[104:107], v15 offset:34816
    ds_read_b64_tr_b16 a[40:41], v12 offset:36864
    v_mfma_f32_32x32x16_bf16 v[32:47], a[8:11], a[72:75], v[32:47]
    ds_read_b64_tr_b16 a[42:43], v12 offset:37376
    ds_read_b128 a[108:111], v15 offset:35840
    ds_read_b64_tr_b16 a[44:45], v12 offset:38912
    ds_read_b64_tr_b16 a[46:47], v12 offset:39424
    v_mfma_f32_32x32x16_bf16 v[32:47], a[12:15], a[76:79], v[32:47]
    ds_read_b128 a[112:115], v15 offset:36864
    ds_read_b64_tr_b16 a[48:49], v12 offset:40960
    ds_read_b64_tr_b16 a[50:51], v12 offset:41472
    ds_read_b128 a[116:119], v15 offset:37888
    v_mfma_f32_32x32x16_bf16 v[32:47], a[16:19], a[80:83], v[32:47]
    ds_read_b64_tr_b16 a[52:53], v12 offset:43008
    ds_read_b64_tr_b16 a[54:55], v12 offset:43520
    ds_read_b128 a[120:123], v15 offset:38912
    ds_read_b64_tr_b16 a[56:57], v12 offset:45056
    v_mfma_f32_32x32x16_bf16 v[32:47], a[20:23], a[84:87], v[32:47]
    ds_read_b64_tr_b16 a[58:59], v12 offset:45568
    ds_read_b128 a[124:127], v15 offset:39936
    ds_read_b64_tr_b16 a[60:61], v12 offset:47104
    ds_read_b64_tr_b16 a[62:63], v12 offset:47616
    v_mfma_f32_32x32x16_bf16 v[32:47], a[24:27], a[88:91], v[32:47]
    v_mfma_f32_32x32x16_bf16 v[32:47], a[28:31], a[92:95], v[32:47]
    s_waitcnt lgkmcnt(0)
    v_mfma_f32_32x32x16_bf16 v[32:47], a[32:35], a[96:99], v[32:47]
    v_mfma_f32_32x32x16_bf16 v[32:47], a[36:39], a[100:103], v[32:47]
    v_mfma_f32_32x32x16_bf16 v[32:47], a[40:43], a[104:107], v[32:47]
    v_mfma_f32_32x32x16_bf16 v[32:47], a[44:47], a[108:111], v[32:47]
    v_mfma_f32_32x32x16_bf16 v[32:47], a[48:51], a[112:115], v[32:47]
    v_mfma_f32_32x32x16_bf16 v[32:47], a[52:55], a[116:119], v[32:47]
    v_mfma_f32_32x32x16_bf16 v[32:47], a[56:59], a[120:123], v[32:47]
    v_mfma_f32_32x32x16_bf16 v[32:47], a[60:63], a[124:127], v[32:47]
    s_barrier
    s_mov_b32 s50, 0xbdd2d3e8
    s_nop 9
    v_mov_b32 v176, 0xc0135761
    v_mov_b32 v178, 0xbdd2d3e8
    v_mov_b32 v180, 1.0
    v_pk_mul_f32 v[160:161], v[32:33], v[32:33]
    v_pk_mul_f32 v[162:163], v[34:35], v[34:35]
    v_pk_mul_f32 v[164:165], v[36:37], v[36:37]
    v_pk_mul_f32 v[166:167], v[38:39], v[38:39]
    v_pk_mul_f32 v[168:169], v[40:41], v[40:41]
    v_pk_mul_f32 v[170:171], v[42:43], v[42:43]
    v_pk_mul_f32 v[172:173], v[44:45], v[44:45]
    v_pk_mul_f32 v[174:175], v[46:47], v[46:47]
    v_pk_fma_f32 v[160:161], v[160:161], v[178:179], v[176:177] op_sel_hi:[1,0,0]
    v_pk_fma_f32 v[162:163], v[162:163], v[178:179], v[176:177] op_sel_hi:[1,0,0]
    v_pk_fma_f32 v[164:165], v[164:165], v[178:179], v[176:177] op_sel_hi:[1,0,0]
    v_pk_fma_f32 v[166:167], v[166:167], v[178:179], v[176:177] op_sel_hi:[1,0,0]
    v_pk_fma_f32 v[168:169], v[168:169], v[178:179], v[176:177] op_sel_hi:[1,0,0]
    v_pk_fma_f32 v[170:171], v[170:171], v[178:179], v[176:177] op_sel_hi:[1,0,0]
    v_pk_fma_f32 v[172:173], v[172:173], v[178:179], v[176:177] op_sel_hi:[1,0,0]
    v_pk_fma_f32 v[174:175], v[174:175], v[178:179], v[176:177] op_sel_hi:[1,0,0]
    v_pk_mul_f32 v[160:161], v[160:161], v[32:33]
    v_pk_mul_f32 v[162:163], v[162:163], v[34:35]
    v_pk_mul_f32 v[164:165], v[164:165], v[36:37]
    v_pk_mul_f32 v[166:167], v[166:167], v[38:39]
    v_pk_mul_f32 v[168:169], v[168:169], v[40:41]
    v_pk_mul_f32 v[170:171], v[170:171], v[42:43]
    v_pk_mul_f32 v[172:173], v[172:173], v[44:45]
    v_pk_mul_f32 v[174:175], v[174:175], v[46:47]
    v_exp_f32 v160, v160
    v_exp_f32 v161, v161
    v_exp_f32 v162, v162
    v_exp_f32 v163, v163
    v_exp_f32 v164, v164
    v_exp_f32 v165, v165
    v_exp_f32 v166, v166
    v_exp_f32 v167, v167
    v_exp_f32 v168, v168
    v_exp_f32 v169, v169
    v_exp_f32 v170, v170
    v_exp_f32 v171, v171
    v_exp_f32 v172, v172
    v_exp_f32 v173, v173
    v_exp_f32 v174, v174
    v_exp_f32 v175, v175
    v_pk_add_f32 v[160:161], v[160:161], v[180:181] op_sel_hi:[1,0]
    v_pk_add_f32 v[162:163], v[162:163], v[180:181] op_sel_hi:[1,0]
    v_pk_add_f32 v[164:165], v[164:165], v[180:181] op_sel_hi:[1,0]
    v_pk_add_f32 v[166:167], v[166:167], v[180:181] op_sel_hi:[1,0]
    v_pk_add_f32 v[168:169], v[168:169], v[180:181] op_sel_hi:[1,0]
    v_pk_add_f32 v[170:171], v[170:171], v[180:181] op_sel_hi:[1,0]
    v_pk_add_f32 v[172:173], v[172:173], v[180:181] op_sel_hi:[1,0]
    v_pk_add_f32 v[174:175], v[174:175], v[180:181] op_sel_hi:[1,0]
    v_rcp_f32 v160, v160
    v_rcp_f32 v161, v161
    v_rcp_f32 v162, v162
    v_rcp_f32 v163, v163
    v_rcp_f32 v164, v164
    v_rcp_f32 v165, v165
    v_rcp_f32 v166, v166
    v_rcp_f32 v167, v167
    v_rcp_f32 v168, v168
    v_rcp_f32 v169, v169
    v_rcp_f32 v170, v170
    v_rcp_f32 v171, v171
    v_rcp_f32 v172, v172
    v_rcp_f32 v173, v173
    v_rcp_f32 v174, v174
    v_rcp_f32 v175, v175
    v_pk_mul_f32 v[32:33], v[32:33], v[160:161]
    v_pk_mul_f32 v[34:35], v[34:35], v[162:163]
    v_pk_mul_f32 v[36:37], v[36:37], v[164:165]
    v_pk_mul_f32 v[38:39], v[38:39], v[166:167]
    v_pk_mul_f32 v[40:41], v[40:41], v[168:169]
    v_pk_mul_f32 v[42:43], v[42:43], v[170:171]
    v_pk_mul_f32 v[44:45], v[44:45], v[172:173]
    v_pk_mul_f32 v[46:47], v[46:47], v[174:175]
    v_cvt_pk_bf16_f32 v96, v32, v33
    v_cvt_pk_bf16_f32 v97, v34, v35
    v_cvt_pk_bf16_f32 v98, v36, v37
    v_cvt_pk_bf16_f32 v99, v38, v39
    buffer_store_dwordx4 v[96:99], v16, s[16:19], 0 offen offset:0 sc1
    v_cvt_pk_bf16_f32 v100, v40, v41
    v_cvt_pk_bf16_f32 v101, v42, v43
    v_cvt_pk_bf16_f32 v102, v44, v45
    v_cvt_pk_bf16_f32 v103, v46, v47
    buffer_store_dwordx4 v[100:103], v16, s[16:19], 0 offen offset:1024 sc1
    s_lshr_b32 s64, s38, 3
    s_lshr_b32 s48, s39, 6
    s_add_u32 s64, s64, s48
    s_add_u32 s64, s64, 1088
    s_lshl_b32 s64, s64, 7
    s_waitcnt lgkmcnt(0)
    s_add_u32 s8, s44, 0
    s_addc_u32 s9, s45, 0
    s_mov_b32 s10, 524288
    s_mov_b32 s11, 0x00020000
    s_add_u32 s12, s46, 44040192
    s_addc_u32 s13, s47, 0
    s_mov_b32 s14, 2097152
    s_mov_b32 s15, 0x00020000
    s_add_u32 s16, s46, 46137344
    s_addc_u32 s17, s47, 0
    s_mov_b32 s18, 2097152
    s_mov_b32 s19, 0x00020000
    s_add_u32 s20, s46, 39845888
    s_addc_u32 s21, s47, 0
    s_mov_b32 s22, 2097152
    s_mov_b32 s23, 0x00020000
    s_add_u32 s24, s46, 48234496
    s_addc_u32 s25, s47, 0
    s_mov_b32 s26, 262144
    s_mov_b32 s27, 0x00020000
    s_lshl_b32 s37, s32, 12
    v_lshrrev_b32 v16, 3, v1
    v_and_b32 v17, 7, v1
    v_lshrrev_b32 v18, 1, v16
    v_and_b32 v18, 1, v18
    v_lshlrev_b32 v18, 2, v18
    v_xor_b32 v18, v18, v17
    v_lshlrev_b32 v18, 4, v18
    s_mov_b32 s41, 1024
    v_mul_lo_u32 v19, v16, s41
    v_add_u32 v18, v18, v19
    s_mul_i32 s41, s32, 32768
    v_add_u32 v18, s41, v18
    v_add_u32 v2, 0, v18
    v_add_u32 v3, 7168, v18
    v_add_u32 v4, 14336, v18
    v_add_u32 v5, 21504, v18
    s_lshr_b32 s41, s32, 1
    s_mul_i32 s41, s41, 32768
    s_and_b32 s42, s32, 1
    s_lshl_b32 s42, s42, 12
    s_add_u32 s41, s41, s42
    s_lshr_b32 s42, s38, 5
    s_mul_i32 s42, s42, 32768
    s_add_u32 s41, s41, s42
    v_and_b32 v16, 31, v1
    v_and_b32 v17, 32, v1
    v_add_u32 v18, -1, v16
    v_ashrrev_i32 v19, 5, v18
    v_and_b32 v18, 31, v18
    v_add_u32 v18, v18, v17
    v_lshlrev_b32 v18, 4, v18
    s_mov_b32 s42, 32768
    v_mul_lo_u32 v19, v19, s42
    v_add_u32 v18, v18, v19
    v_add_u32 v6, s41, v18
    v_add_u32 v18, 1, v16
    v_ashrrev_i32 v19, 5, v18
    v_and_b32 v18, 31, v18
    v_add_u32 v18, v18, v17
    v_lshlrev_b32 v18, 4, v18
    s_mov_b32 s42, 32768
    v_mul_lo_u32 v19, v19, s42
    v_add_u32 v18, v18, v19
    v_add_u32 v7, s41, v18
    v_add_u32 v18, -2, v16
    v_ashrrev_i32 v19, 5, v18
    v_and_b32 v18, 31, v18
    v_add_u32 v18, v18, v17
    v_lshlrev_b32 v18, 4, v18
    s_mov_b32 s42, 32768
    v_mul_lo_u32 v19, v19, s42
    v_add_u32 v18, v18, v19
    v_add_u32 v8, s41, v18
    v_add_u32 v18, 2, v16
    v_ashrrev_i32 v19, 5, v18
    v_and_b32 v18, 31, v18
    v_add_u32 v18, v18, v17
    v_lshlrev_b32 v18, 4, v18
    s_mov_b32 s42, 32768
    v_mul_lo_u32 v19, v19, s42
    v_add_u32 v18, v18, v19
    v_add_u32 v9, s41, v18
    v_and_b32 v16, 15, v1
    v_lshrrev_b32 v16, 2, v16
    v_and_b32 v17, 3, v1
    v_lshrrev_b32 v18, 4, v1
    v_and_b32 v18, 1, v18
    v_lshrrev_b32 v19, 5, v1
    v_and_b32 v20, 1, v17
    v_lshl_add_u32 v20, v18, 1, v20
    v_lshlrev_b32 v20, 4, v20
    v_lshrrev_b32 v17, 1, v17
    v_lshl_add_u32 v20, v17, 3, v20
    v_lshl_add_u32 v20, v16, 7, v20
    v_lshl_add_u32 v20, v19, 10, v20
    v_lshrrev_b32 v16, 1, v16
    s_mul_i32 s41, s34, 1
    s_add_u32 s41, s41, 0
    v_xor_b32 v21, s41, v16
    v_lshl_add_u32 v10, v21, 6, v20
    v_add_u32 v12, 65536, v10
    s_mul_i32 s41, s33, 8192
    s_add_u32 s41, s41, 16384
    v_lshlrev_b32 v16, 4, v1
    v_add_u32 v14, s41, v16
    v_add_u32 v15, 65536, v14
    s_lshl_b32 s35, s39, 1
    s_mov_b32 s36, 0
    s_lshr_b32 s48, s38, 5
    s_mul_i32 s49, s33, 1
    s_add_u32 s48, s48, s49
    s_mul_i32 s48, s48, 32
    s_lshr_b32 s49, s39, 4
    s_add_u32 s48, s48, s49
    s_mul_i32 s49, s34, 2
    s_add_u32 s48, s48, s49
    s_lshl_b32 s48, s48, 10
    v_lshlrev_b32 v16, 4, v1
    v_add_u32 v16, s48, v16
    v_and_b32 v17, 31, v1
    s_lshl_b32 s48, s33, 5
    s_add_u32 s48, s48, s38
    v_add_u32 v17, s48, v17
    v_lshlrev_b32 v17, 3, v17
    s_lshr_b32 s48, s39, 5
    s_add_u32 s48, s48, s34
    s_lshl_b32 s48, s48, 14
    v_add_u32 v17, s48, v17
    s_waitcnt vmcnt(0)
    s_barrier
    s_cmp_lg_u32 s32, 0
    s_cbranch_scc1 L_sig9
    v_mov_b32 v216, 0
    v_mov_b32 v217, s100
    s_mov_b64 exec, 1
    buffer_store_dword v217, v216, s[68:71], s64 offen sc1
    s_mov_b64 exec, -1
L_sig9:
    s_lshr_b32 s48, s38, 6
    s_max_u32 s49, s48, 1
    s_sub_u32 s49, s49, 1
    s_add_u32 s48, s48, 1
    s_min_u32 s48, s48, 31
    s_sub_u32 s48, s48, s49
    s_lshl_b32 s48, s48, 3
    s_add_u32 s66, s48, 7
    s_lshl_b32 s49, s49, 3
    s_add_u32 s49, s49, 1088
    s_lshl_b32 s65, s49, 7
    s_cmp_eq_u32 s32, 1
    s_cbranch_scc1 L_wp10
    s_add_u32 m0, s37, 0
    s_nop 0
    buffer_load_dwordx4 v2, s[8:11], s35 offen offset:0 lds
    buffer_load_dwordx4 v3, s[8:11], s35 offen offset:1024 lds
    buffer_load_dwordx4 v4, s[8:11], s35 offen offset:2048 lds
    buffer_load_dwordx4 v5, s[8:11], s35 offen offset:3072 lds
    s_add_u32 s35, s35, 131072
    s_add_u32 m0, s37, 32768
    s_nop 0
    buffer_load_dwordx4 v2, s[8:11], s35 offen offset:0 lds
    buffer_load_dwordx4 v3, s[8:11], s35 offen offset:1024 lds
    buffer_load_dwordx4 v4, s[8:11], s35 offen offset:2048 lds
    buffer_load_dwordx4 v5, s[8:11], s35 offen offset:3072 lds
    s_add_u32 s35, s35, 131072
    s_add_u32 m0, s37, 65536
    s_nop 0
    buffer_load_dwordx4 v2, s[8:11], s35 offen offset:0 lds
    buffer_load_dwordx4 v3, s[8:11], s35 offen offset:1024 lds
    buffer_load_dwordx4 v4, s[8:11], s35 offen offset:2048 lds
    buffer_load_dwordx4 v5, s[8:11], s35 offen offset:3072 lds
    s_add_u32 s35, s35, 131072
    s_add_u32 m0, s37, 98304
    s_nop 0
    buffer_load_dwordx4 v2, s[8:11], s35 offen offset:0 lds
    buffer_load_dwordx4 v3, s[8:11], s35 offen offset:1024 lds
    buffer_load_dwordx4 v4, s[8:11], s35 offen offset:2048 lds
    buffer_load_dwordx4 v5, s[8:11], s35 offen offset:3072 lds
    s_add_u32 s35, s35, 131072
    buffer_load_dwordx4 v[20:23], v16, s[20:23], 0 offen offset:0 sc1
    buffer_load_dwordx4 v[24:27], v16, s[20:23], 0 offen offset:1024 sc1
    s_branch L_wdone10
L_wp10:
    s_mov_b32 s62, 524288
    v_min_u32 v216, s66, v1
    v_lshlrev_b32 v216, 7, v216
L_fp10:
    buffer_load_dword v217, v216, s[68:71], s65 offen sc1
    s_waitcnt vmcnt(0)
    v_cmp_ne_u32 vcc, s100, v217
    s_cbranch_vccz L_wgo10
    s_sleep 1
    s_sub_u32 s62, s62, 1
    s_cmp_lg_u32 s62, 0
    s_cbranch_scc1 L_fp10
L_wgo10:
    s_add_u32 m0, s37, 0
    s_nop 0
    buffer_load_dwordx4 v2, s[8:11], s35 offen offset:0 lds
    buffer_load_dwordx4 v3, s[8:11], s35 offen offset:1024 lds
    buffer_load_dwordx4 v4, s[8:11], s35 offen offset:2048 lds
    buffer_load_dwordx4 v5, s[8:11], s35 offen offset:3072 lds
    s_add_u32 s35, s35, 131072
    s_add_u32 m0, s37, 32768
    s_nop 0
    buffer_load_dwordx4 v2, s[8:11], s35 offen offset:0 lds
    buffer_load_dwordx4 v3, s[8:11], s35 offen offset:1024 lds
    buffer_load_dwordx4 v4, s[8:11], s35 offen offset:2048 lds
    buffer_load_dwordx4 v5, s[8:11], s35 offen offset:3072 lds
    s_add_u32 s35, s35, 131072
    s_add_u32 m0, s37, 65536
    s_nop 0
    buffer_load_dwordx4 v2, s[8:11], s35 offen offset:0 lds
    buffer_load_dwordx4 v3, s[8:11], s35 offen offset:1024 lds
    buffer_load_dwordx4 v4, s[8:11], s35 offen offset:2048 lds
    buffer_load_dwordx4 v5, s[8:11], s35 offen offset:3072 lds
    s_add_u32 s35, s35, 131072
    s_add_u32 m0, s37, 98304
    s_nop 0
    buffer_load_dwordx4 v2, s[8:11], s35 offen offset:0 lds
    buffer_load_dwordx4 v3, s[8:11], s35 offen offset:1024 lds
    buffer_load_dwordx4 v4, s[8:11], s35 offen offset:2048 lds
    buffer_load_dwordx4 v5, s[8:11], s35 offen offset:3072 lds
    s_add_u32 s35, s35, 131072
    buffer_load_dwordx4 v[20:23], v16, s[20:23], 0 offen offset:0 sc1
    buffer_load_dwordx4 v[24:27], v16, s[20:23], 0 offen offset:1024 sc1
L_wdone10:
    s_barrier
    s_add_u32 m0, s37, 16384
    s_nop 0
    buffer_load_dwordx4 v6, s[12:15], s36 offen offset:0 sc1 lds
    buffer_load_dwordx4 v6, s[12:15], s36 offen offset:1024 sc1 lds
    buffer_load_dwordx4 v6, s[12:15], s36 offen offset:2048 sc1 lds
    buffer_load_dwordx4 v6, s[12:15], s36 offen offset:3072 sc1 lds
    s_add_u32 s36, s36, 8192
    s_add_u32 m0, s37, 49152
    s_nop 0
    buffer_load_dwordx4 v7, s[12:15], s36 offen offset:0 sc1 lds
    buffer_load_dwordx4 v7, s[12:15], s36 offen offset:1024 sc1 lds
    buffer_load_dwordx4 v7, s[12:15], s36 offen offset:2048 sc1 lds
    buffer_load_dwordx4 v7, s[12:15], s36 offen offset:3072 sc1 lds
    s_add_u32 s36, s36, 8192
    s_add_u32 m0, s37, 81920
    s_nop 0
    buffer_load_dwordx4 v8, s[12:15], s36 offen offset:0 sc1 lds
    buffer_load_dwordx4 v8, s[12:15], s36 offen offset:1024 sc1 lds
    buffer_load_dwordx4 v8, s[12:15], s36 offen offset:2048 sc1 lds
    buffer_load_dwordx4 v8, s[12:15], s36 offen offset:3072 sc1 lds
    s_add_u32 s36, s36, 8192
    s_add_u32 m0, s37, 114688
    s_nop 0
    buffer_load_dwordx4 v9, s[12:15], s36 offen offset:0 sc1 lds
    buffer_load_dwordx4 v9, s[12:15], s36 offen offset:1024 sc1 lds
    buffer_load_dwordx4 v9, s[12:15], s36 offen offset:2048 sc1 lds
    buffer_load_dwordx4 v9, s[12:15], s36 offen offset:3072 sc1 lds
    s_add_u32 s36, s36, 8192
    s_load_dwordx2 s[44:45], s[0:1], 64
    s_waitcnt vmcnt(12)
    s_barrier
    ds_read_b128 a[64:67], v14 offset:0
    ds_read_b64_tr_b16 a[0:1], v10 offset:0
    ds_read_b64_tr_b16 a[2:3], v10 offset:512
    ds_read_b128 a[68:71], v14 offset:1024
    ds_read_b64_tr_b16 a[4:5], v10 offset:2048
    ds_read_b64_tr_b16 a[6:7], v10 offset:2560
    ds_read_b128 a[72:75], v14 offset:2048
    ds_read_b64_tr_b16 a[8:9], v10 offset:4096
    ds_read_b64_tr_b16 a[10:11], v10 offset:4608
    ds_read_b128 a[76:79], v14 offset:3072
    ds_read_b64_tr_b16 a[12:13], v10 offset:6144
    ds_read_b64_tr_b16 a[14:15], v10 offset:6656
    ds_read_b128 a[80:83], v14 offset:4096
    ds_read_b64_tr_b16 a[16:17], v10 offset:8192
    ds_read_b64_tr_b16 a[18:19], v10 offset:8704
    ds_read_b128 a[84:87], v14 offset:5120
    ds_read_b64_tr_b16 a[20:21], v10 offset:10240
    ds_read_b64_tr_b16 a[22:23], v10 offset:10752
    ds_read_b128 a[88:91], v14 offset:6144
    ds_read_b64_tr_b16 a[24:25], v10 offset:12288
    ds_read_b64_tr_b16 a[26:27], v10 offset:12800
    ds_read_b128 a[92:95], v14 offset:7168
    ds_read_b64_tr_b16 a[28:29], v10 offset:14336
    ds_read_b64_tr_b16 a[30:31], v10 offset:14848
    s_waitcnt lgkmcnt(0)
    s_waitcnt vmcnt(8)
    s_barrier
    v_mfma_f32_32x32x16_bf16 v[32:47], a[0:3], a[64:67], 0
    ds_read_b128 a[96:99], v14 offset:32768
    ds_read_b64_tr_b16 a[32:33], v10 offset:32768
    ds_read_b64_tr_b16 a[34:35], v10 offset:33280
    ds_read_b128 a[100:103], v14 offset:33792
    v_mfma_f32_32x32x16_bf16 v[32:47], a[4:7], a[68:71], v[32:47]
    ds_read_b64_tr_b16 a[36:37], v10 offset:34816
    ds_read_b64_tr_b16 a[38:39], v10 offset:35328
    ds_read_b128 a[104:107], v14 offset:34816
    ds_read_b64_tr_b16 a[40:41], v10 offset:36864
    v_mfma_f32_32x32x16_bf16 v[32:47], a[8:11], a[72:75], v[32:47]
    ds_read_b64_tr_b16 a[42:43], v10 offset:37376
    ds_read_b128 a[108:111], v14 offset:35840
    ds_read_b64_tr_b16 a[44:45], v10 offset:38912
    ds_read_b64_tr_b16 a[46:47], v10 offset:39424
    v_mfma_f32_32x32x16_bf16 v[32:47], a[12:15], a[76:79], v[32:47]
    ds_read_b128 a[112:115], v14 offset:36864
    ds_read_b64_tr_b16 a[48:49], v10 offset:40960
    ds_read_b64_tr_b16 a[50:51], v10 offset:41472
    ds_read_b128 a[116:119], v14 offset:37888
    v_mfma_f32_32x32x16_bf16 v[32:47], a[16:19], a[80:83], v[32:47]
    ds_read_b64_tr_b16 a[52:53], v10 offset:43008
    ds_read_b64_tr_b16 a[54:55], v10 offset:43520
    ds_read_b128 a[120:123], v14 offset:38912
    ds_read_b64_tr_b16 a[56:57], v10 offset:45056
    v_mfma_f32_32x32x16_bf16 v[32:47], a[20:23], a[84:87], v[32:47]
    ds_read_b64_tr_b16 a[58:59], v10 offset:45568
    ds_read_b128 a[124:127], v14 offset:39936
    ds_read_b64_tr_b16 a[60:61], v10 offset:47104
    ds_read_b64_tr_b16 a[62:63], v10 offset:47616
    v_mfma_f32_32x32x16_bf16 v[32:47], a[24:27], a[88:91], v[32:47]
    v_mfma_f32_32x32x16_bf16 v[32:47], a[28:31], a[92:95], v[32:47]
    s_waitcnt lgkmcnt(0)
    s_waitcnt vmcnt(4)
    s_barrier
    v_mfma_f32_32x32x16_bf16 v[32:47], a[32:35], a[96:99], v[32:47]
    ds_read_b128 a[64:67], v15 offset:0
    ds_read_b64_tr_b16 a[0:1], v12 offset:0
    ds_read_b64_tr_b16 a[2:3], v12 offset:512
    ds_read_b128 a[68:71], v15 offset:1024
    v_mfma_f32_32x32x16_bf16 v[32:47], a[36:39], a[100:103], v[32:47]
    ds_read_b64_tr_b16 a[4:5], v12 offset:2048
    ds_read_b64_tr_b16 a[6:7], v12 offset:2560
    ds_read_b128 a[72:75], v15 offset:2048
    ds_read_b64_tr_b16 a[8:9], v12 offset:4096
    v_mfma_f32_32x32x16_bf16 v[32:47], a[40:43], a[104:107], v[32:47]
    ds_read_b64_tr_b16 a[10:11], v12 offset:4608
    ds_read_b128 a[76:79], v15 offset:3072
    ds_read_b64_tr_b16 a[12:13], v12 offset:6144
    ds_read_b64_tr_b16 a[14:15], v12 offset:6656
    v_mfma_f32_32x32x16_bf16 v[32:47], a[44:47], a[108:111], v[32:47]
    ds_read_b128 a[80:83], v15 offset:4096
    ds_read_b64_tr_b16 a[16:17], v12 offset:8192
    ds_read_b64_tr_b16 a[18:19], v12 offset:8704
    ds_read_b128 a[84:87], v15 offset:5120
    v_mfma_f32_32x32x16_bf16 v[32:47], a[48:51], a[112:115], v[32:47]
    ds_read_b64_tr_b16 a[20:21], v12 offset:10240
    ds_read_b64_tr_b16 a[22:23], v12 offset:10752
    ds_read_b128 a[88:91], v15 offset:6144
    ds_read_b64_tr_b16 a[24:25], v12 offset:12288
    v_mfma_f32_32x32x16_bf16 v[32:47], a[52:55], a[116:119], v[32:47]
    ds_read_b64_tr_b16 a[26:27], v12 offset:12800
    ds_read_b128 a[92:95], v15 offset:7168
    ds_read_b64_tr_b16 a[28:29], v12 offset:14336
    ds_read_b64_tr_b16 a[30:31], v12 offset:14848
    v_mfma_f32_32x32x16_bf16 v[32:47], a[56:59], a[120:123], v[32:47]
    v_mfma_f32_32x32x16_bf16 v[32:47], a[60:63], a[124:127], v[32:47]
    s_waitcnt lgkmcnt(0)
    s_waitcnt vmcnt(0)
    s_barrier
    v_mfma_f32_32x32x16_bf16 v[32:47], a[0:3], a[64:67], v[32:47]
    ds_read_b128 a[96:99], v15 offset:32768
    ds_read_b64_tr_b16 a[32:33], v12 offset:32768
    ds_read_b64_tr_b16 a[34:35], v12 offset:33280
    ds_read_b128 a[100:103], v15 offset:33792
    v_mfma_f32_32x32x16_bf16 v[32:47], a[4:7], a[68:71], v[32:47]
    ds_read_b64_tr_b16 a[36:37], v12 offset:34816
    ds_read_b64_tr_b16 a[38:39], v12 offset:35328
    ds_read_b128 a[104:107], v15 offset:34816
    ds_read_b64_tr_b16 a[40:41], v12 offset:36864
    v_mfma_f32_32x32x16_bf16 v[32:47], a[8:11], a[72:75], v[32:47]
    ds_read_b64_tr_b16 a[42:43], v12 offset:37376
    ds_read_b128 a[108:111], v15 offset:35840
    ds_read_b64_tr_b16 a[44:45], v12 offset:38912
    ds_read_b64_tr_b16 a[46:47], v12 offset:39424
    v_mfma_f32_32x32x16_bf16 v[32:47], a[12:15], a[76:79], v[32:47]
    ds_read_b128 a[112:115], v15 offset:36864
    ds_read_b64_tr_b16 a[48:49], v12 offset:40960
    ds_read_b64_tr_b16 a[50:51], v12 offset:41472
    ds_read_b128 a[116:119], v15 offset:37888
    v_mfma_f32_32x32x16_bf16 v[32:47], a[16:19], a[80:83], v[32:47]
    ds_read_b64_tr_b16 a[52:53], v12 offset:43008
    ds_read_b64_tr_b16 a[54:55], v12 offset:43520
    ds_read_b128 a[120:123], v15 offset:38912
    ds_read_b64_tr_b16 a[56:57], v12 offset:45056
    v_mfma_f32_32x32x16_bf16 v[32:47], a[20:23], a[84:87], v[32:47]
    ds_read_b64_tr_b16 a[58:59], v12 offset:45568
    ds_read_b128 a[124:127], v15 offset:39936
    ds_read_b64_tr_b16 a[60:61], v12 offset:47104
    ds_read_b64_tr_b16 a[62:63], v12 offset:47616
    v_mfma_f32_32x32x16_bf16 v[32:47], a[24:27], a[88:91], v[32:47]
    v_mfma_f32_32x32x16_bf16 v[32:47], a[28:31], a[92:95], v[32:47]
    s_waitcnt lgkmcnt(0)
    v_mfma_f32_32x32x16_bf16 v[32:47], a[32:35], a[96:99], v[32:47]
    v_mfma_f32_32x32x16_bf16 v[32:47], a[36:39], a[100:103], v[32:47]
    v_mfma_f32_32x32x16_bf16 v[32:47], a[40:43], a[104:107], v[32:47]
    v_mfma_f32_32x32x16_bf16 v[32:47], a[44:47], a[108:111], v[32:47]
    v_mfma_f32_32x32x16_bf16 v[32:47], a[48:51], a[112:115], v[32:47]
    v_mfma_f32_32x32x16_bf16 v[32:47], a[52:55], a[116:119], v[32:47]
    v_mfma_f32_32x32x16_bf16 v[32:47], a[56:59], a[120:123], v[32:47]
    v_mfma_f32_32x32x16_bf16 v[32:47], a[60:63], a[124:127], v[32:47]
    s_barrier
    s_nop 10
    v_lshlrev_b32 v160, 16, v20
    v_and_b32 v161, 0xffff0000, v20
    v_lshlrev_b32 v162, 16, v21
    v_and_b32 v163, 0xffff0000, v21
    v_lshlrev_b32 v164, 16, v22
    v_and_b32 v165, 0xffff0000, v22
    v_lshlrev_b32 v166, 16, v23
    v_and_b32 v167, 0xffff0000, v23
    v_pk_add_f32 v[32:33], v[32:33], v[160:161]
    v_pk_add_f32 v[34:35], v[34:35], v[162:163]
    v_pk_add_f32 v[36:37], v[36:37], v[164:165]
    v_pk_add_f32 v[38:39], v[38:39], v[166:167]
    v_cvt_pk_bf16_f32 v104, v32, v33
    v_cvt_pk_bf16_f32 v105, v34, v35
    v_cvt_pk_bf16_f32 v106, v36, v37
    v_cvt_pk_bf16_f32 v107, v38, v39
    v_lshlrev_b32 v32, 16, v104
    v_and_b32 v33, 0xffff0000, v104
    v_lshlrev_b32 v34, 16, v105
    v_and_b32 v35, 0xffff0000, v105
    v_lshlrev_b32 v36, 16, v106
    v_and_b32 v37, 0xffff0000, v106
    v_lshlrev_b32 v38, 16, v107
    v_and_b32 v39, 0xffff0000, v107
    buffer_store_dwordx4 v[104:107], v16, s[16:19], 0 offen offset:0 sc1
    v_lshlrev_b32 v160, 16, v24
    v_and_b32 v161, 0xffff0000, v24
    v_lshlrev_b32 v162, 16, v25
    v_and_b32 v163, 0xffff0000, v25
    v_lshlrev_b32 v164, 16, v26
    v_and_b32 v165, 0xffff0000, v26
    v_lshlrev_b32 v166, 16, v27
    v_and_b32 v167, 0xffff0000, v27
    v_pk_add_f32 v[40:41], v[40:41], v[160:161]
    v_pk_add_f32 v[42:43], v[42:43], v[162:163]
    v_pk_add_f32 v[44:45], v[44:45], v[164:165]
    v_pk_add_f32 v[46:47], v[46:47], v[166:167]
    v_cvt_pk_bf16_f32 v108, v40, v41
    v_cvt_pk_bf16_f32 v109, v42, v43
    v_cvt_pk_bf16_f32 v110, v44, v45
    v_cvt_pk_bf16_f32 v111, v46, v47
    v_lshlrev_b32 v40, 16, v108
    v_and_b32 v41, 0xffff0000, v108
    v_lshlrev_b32 v42, 16, v109
    v_and_b32 v43, 0xffff0000, v109
    v_lshlrev_b32 v44, 16, v110
    v_and_b32 v45, 0xffff0000, v110
    v_lshlrev_b32 v46, 16, v111
    v_and_b32 v47, 0xffff0000, v111
    buffer_store_dwordx4 v[108:111], v16, s[16:19], 0 offen offset:1024 sc1
    v_mov_b32 v160, 0
    v_mov_b32 v161, 0
    v_add_f32 v160, v160, v32
    v_fmac_f32 v161, v32, v32
    v_add_f32 v160, v160, v33
    v_fmac_f32 v161, v33, v33
    v_add_f32 v160, v160, v34
    v_fmac_f32 v161, v34, v34
    v_add_f32 v160, v160, v35
    v_fmac_f32 v161, v35, v35
    v_add_f32 v160, v160, v36
    v_fmac_f32 v161, v36, v36
    v_add_f32 v160, v160, v37
    v_fmac_f32 v161, v37, v37
    v_add_f32 v160, v160, v38
    v_fmac_f32 v161, v38, v38
    v_add_f32 v160, v160, v39
    v_fmac_f32 v161, v39, v39
    v_add_f32 v160, v160, v40
    v_fmac_f32 v161, v40, v40
    v_add_f32 v160, v160, v41
    v_fmac_f32 v161, v41, v41
    v_add_f32 v160, v160, v42
    v_fmac_f32 v161, v42, v42
    v_add_f32 v160, v160, v43
    v_fmac_f32 v161, v43, v43
    v_add_f32 v160, v160, v44
    v_fmac_f32 v161, v44, v44
    v_add_f32 v160, v160, v45
    v_fmac_f32 v161, v45, v45
    v_add_f32 v160, v160, v46
    v_fmac_f32 v161, v46, v46
    v_add_f32 v160, v160, v47
    v_fmac_f32 v161, v47, v47
    v_mov_b32 v162, v160
    v_mov_b32 v163, v161
    s_nop 1
    v_permlane32_swap_b32 v160, v162
    v_permlane32_swap_b32 v161, v163
    s_nop 1
    v_add_f32 v160, v160, v162
    v_add_f32 v161, v161, v163
    v_cmp_gt_u32 vcc, 32, v1
    s_and_saveexec_b64 s[50:51], vcc
    buffer_store_dwordx2 v[160:161], v17, s[24:27], 0 offen sc1
    s_mov_b64 exec, s[50:51]
    s_lshr_b32 s64, s38, 3
    s_lshr_b32 s48, s39, 6
    s_add_u32 s64, s64, s48
    s_add_u32 s64, s64, 1344
    s_lshl_b32 s64, s64, 7
    s_waitcnt lgkmcnt(0)
    s_lshr_b32 s49, s2, 3
    s_cmp_ge_u32 s49, 28
    s_cbranch_scc1 L_tail_skip
    s_load_dwordx2 s[54:55], s[0:1], 72
    s_and_b32 s48, s2, 7
    s_lshr_b32 s49, s2, 3
    s_cmp_ge_u32 s49, 14
    s_cselect_b32 s50, 1, 0
    s_cselect_b32 s51, 14, 0
    s_sub_u32 s49, s49, s51
    s_lshl_b32 s48, s48, 1
    s_add_u32 s48, s48, s50
    s_lshl_b32 s38, s48, 7
    s_lshl_b32 s39, s49, 7
    s_add_u32 s8, s44, 0
    s_addc_u32 s9, s45, 0
    s_mov_b32 s10, 1835008
    s_mov_b32 s11, 0x00020000
    s_add_u32 s12, s46, 46137344
    s_addc_u32 s13, s47, 0
    s_mov_b32 s14, 2097152
    s_mov_b32 s15, 0x00020000
    s_add_u32 s16, s46, 50331648
    s_addc_u32 s17, s47, 0
    s_mov_b32 s18, 7340032
    s_mov_b32 s19, 0x00020000
    s_add_u32 s20, s46, 48234496
    s_addc_u32 s21, s47, 0
    s_mov_b32 s22, 262144
    s_mov_b32 s23, 0x00020000
    s_add_u32 s24, s46, 8192
    s_addc_u32 s25, s47, 0
    s_mov_b32 s26, 7168
    s_mov_b32 s27, 0x00020000
    s_lshl_b32 s37, s32, 12
    v_lshrrev_b32 v16, 4, v1
    v_and_b32 v17, 15, v1
    v_lshlrev_b32 v18, 2, v16
    v_xor_b32 v18, v18, v17
    v_lshlrev_b32 v18, 4, v18
    s_mov_b32 s41, 3584
    v_mul_lo_u32 v19, v16, s41
    v_add_u32 v18, v18, v19
    s_mul_i32 s41, s32, 57344
    v_add_u32 v18, s41, v18
    v_add_u32 v2, 0, v18
    v_add_u32 v3, 13312, v18
    v_add_u32 v4, 26624, v18
    v_add_u32 v5, 39936, v18
    s_mul_i32 s41, s32, 32768
    v_lshlrev_b32 v16, 4, v1
    v_add_u32 v6, s41, v16
    v_and_b32 v16, 15, v1
    v_lshrrev_b32 v16, 2, v16
    v_and_b32 v17, 3, v1
    v_lshrrev_b32 v18, 4, v1
    v_and_b32 v18, 1, v18
    v_lshrrev_b32 v19, 5, v1
    v_and_b32 v20, 1, v17
    v_lshl_add_u32 v20, v18, 1, v20
    v_lshlrev_b32 v20, 4, v20
    v_lshrrev_b32 v17, 1, v17
    v_lshl_add_u32 v20, v17, 3, v20
    v_lshl_add_u32 v20, v16, 8, v20
    v_lshl_add_u32 v20, v19, 11, v20
    s_mul_i32 s41, s34, 2
    s_add_u32 s41, s41, 0
    v_xor_b32 v21, s41, v16
    v_lshl_add_u32 v10, v21, 6, v20
    v_add_u32 v12, 65536, v10
    s_mul_i32 s41, s34, 2
    s_add_u32 s41, s41, 1
    v_xor_b32 v21, s41, v16
    v_lshl_add_u32 v11, v21, 6, v20
    v_add_u32 v13, 65536, v11
    s_mul_i32 s41, s33, 8192
    s_add_u32 s41, s41, 16384
    v_lshlrev_b32 v16, 4, v1
    v_add_u32 v14, s41, v16
    v_add_u32 v15, 65536, v14
    s_lshl_b32 s35, s39, 1
    s_lshl_b32 s36, s38, 10
    s_lshr_b32 s48, s39, 7
    s_and_b32 s48, s48, 3
    s_lshl_b32 s48, s48, 2
    s_add_u32 s48, s48, s32
    s_lshr_b32 s50, s48, 2
    s_and_b32 s48, s48, 3
    s_mul_i32 s50, s50, 32768
    s_lshl_b32 s48, s48, 10
    s_add_u32 s48, s48, s50
    v_and_b32 v27, 7, v1
    v_lshlrev_b32 v27, 7, v27
    v_add_u32 v27, s48, v27
    s_lshr_b32 s48, s38, 5
    s_mul_i32 s49, s33, 2
    s_add_u32 s48, s48, s49
    s_mul_i32 s48, s48, 112
    s_lshr_b32 s49, s39, 4
    s_add_u32 s48, s48, s49
    s_mul_i32 s49, s34, 4
    s_add_u32 s48, s48, s49
    s_lshl_b32 s48, s48, 10
    v_lshlrev_b32 v16, 4, v1
    v_add_u32 v16, s48, v16
    v_and_b32 v17, 31, v1
    s_lshl_b32 s48, s33, 6
    s_add_u32 s48, s48, s38
    v_add_u32 v17, s48, v17
    v_lshlrev_b32 v17, 3, v17
    v_lshrrev_b32 v18, 5, v1
    v_lshl_add_u32 v17, v18, 17, v17
    v_lshlrev_b32 v18, 5, v18
    s_lshl_b32 s48, s34, 6
    s_add_u32 s48, s48, s39
    s_lshl_b32 s48, s48, 2
    v_add_u32 v18, s48, v18
    s_waitcnt vmcnt(0)
    s_barrier
    s_cmp_lg_u32 s32, 0
    s_cbranch_scc1 L_sig11
    v_mov_b32 v216, 0
    v_mov_b32 v217, s100
    s_mov_b64 exec, 1
    buffer_store_dword v217, v216, s[68:71], s64 offen sc1
    s_mov_b64 exec, -1
L_sig11:
    s_lshr_b32 s65, s38, 3
    s_add_u32 s65, s65, 1344
    s_lshl_b32 s65, s65, 7
    s_cmp_eq_u32 s32, 1
    s_cbranch_scc1 L_wp12
    s_add_u32 m0, s37, 0
    s_nop 0
    buffer_load_dwordx4 v2, s[8:11], s35 offen offset:0 lds
    buffer_load_dwordx4 v3, s[8:11], s35 offen offset:1024 lds
    buffer_load_dwordx4 v4, s[8:11], s35 offen offset:2048 lds
    buffer_load_dwordx4 v5, s[8:11], s35 offen offset:3072 lds
    s_add_u32 s35, s35, 229376
    s_add_u32 m0, s37, 32768
    s_nop 0
    buffer_load_dwordx4 v2, s[8:11], s35 offen offset:0 lds
    buffer_load_dwordx4 v3, s[8:11], s35 offen offset:1024 lds
    buffer_load_dwordx4 v4, s[8:11], s35 offen offset:2048 lds
    buffer_load_dwordx4 v5, s[8:11], s35 offen offset:3072 lds
    s_add_u32 s35, s35, 229376
    s_add_u32 m0, s37, 65536
    s_nop 0
    buffer_load_dwordx4 v2, s[8:11], s35 offen offset:0 lds
    buffer_load_dwordx4 v3, s[8:11], s35 offen offset:1024 lds
    buffer_load_dwordx4 v4, s[8:11], s35 offen offset:2048 lds
    buffer_load_dwordx4 v5, s[8:11], s35 offen offset:3072 lds
    s_add_u32 s35, s35, 229376
    s_add_u32 m0, s37, 98304
    s_nop 0
    buffer_load_dwordx4 v2, s[8:11], s35 offen offset:0 lds
    buffer_load_dwordx4 v3, s[8:11], s35 offen offset:1024 lds
    buffer_load_dwordx4 v4, s[8:11], s35 offen offset:2048 lds
    buffer_load_dwordx4 v5, s[8:11], s35 offen offset:3072 lds
    s_add_u32 s35, s35, 229376
    buffer_load_dwordx4 v[160:163], v18, s[24:27], 0 offen offset:0 sc1
    buffer_load_dwordx4 v[164:167], v18, s[24:27], 0 offen offset:16 sc1
    buffer_load_dwordx4 v[168:171], v18, s[24:27], 0 offen offset:64 sc1
    buffer_load_dwordx4 v[172:175], v18, s[24:27], 0 offen offset:80 sc1
    buffer_load_dwordx4 v[176:179], v18, s[24:27], 0 offen offset:128 sc1
    buffer_load_dwordx4 v[180:183], v18, s[24:27], 0 offen offset:144 sc1
    buffer_load_dwordx4 v[184:187], v18, s[24:27], 0 offen offset:192 sc1
    buffer_load_dwordx4 v[188:191], v18, s[24:27], 0 offen offset:208 sc1
    s_branch L_wdone12
L_wp12:
    s_mov_b32 s62, 524288
    v_min_u32 v216, 15, v1
    v_lshlrev_b32 v216, 7, v216
L_fp11:
    buffer_load_dword v217, v216, s[68:71], s65 offen sc1
    s_waitcnt vmcnt(0)
    v_cmp_ne_u32 vcc, s100, v217
    s_cbranch_vccz L_wgo12
    s_sleep 1
    s_sub_u32 s62, s62, 1
    s_cmp_lg_u32 s62, 0
    s_cbranch_scc1 L_fp11
L_wgo12:
    s_add_u32 m0, s37, 0
    s_nop 0
    buffer_load_dwordx4 v2, s[8:11], s35 offen offset:0 lds
    buffer_load_dwordx4 v3, s[8:11], s35 offen offset:1024 lds
    buffer_load_dwordx4 v4, s[8:11], s35 offen offset:2048 lds
    buffer_load_dwordx4 v5, s[8:11], s35 offen offset:3072 lds
    s_add_u32 s35, s35, 229376
    s_add_u32 m0, s37, 32768
    s_nop 0
    buffer_load_dwordx4 v2, s[8:11], s35 offen offset:0 lds
    buffer_load_dwordx4 v3, s[8:11], s35 offen offset:1024 lds
    buffer_load_dwordx4 v4, s[8:11], s35 offen offset:2048 lds
    buffer_load_dwordx4 v5, s[8:11], s35 offen offset:3072 lds
    s_add_u32 s35, s35, 229376
    s_add_u32 m0, s37, 65536
    s_nop 0
    buffer_load_dwordx4 v2, s[8:11], s35 offen offset:0 lds
    buffer_load_dwordx4 v3, s[8:11], s35 offen offset:1024 lds
    buffer_load_dwordx4 v4, s[8:11], s35 offen offset:2048 lds
    buffer_load_dwordx4 v5, s[8:11], s35 offen offset:3072 lds
    s_add_u32 s35, s35, 229376
    s_add_u32 m0, s37, 98304
    s_nop 0
    buffer_load_dwordx4 v2, s[8:11], s35 offen offset:0 lds
    buffer_load_dwordx4 v3, s[8:11], s35 offen offset:1024 lds
    buffer_load_dwordx4 v4, s[8:11], s35 offen offset:2048 lds
    buffer_load_dwordx4 v5, s[8:11], s35 offen offset:3072 lds
    s_add_u32 s35, s35, 229376
    buffer_load_dwordx4 v[160:163], v18, s[24:27], 0 offen offset:0 sc1
    buffer_load_dwordx4 v[164:167], v18, s[24:27], 0 offen offset:16 sc1
    buffer_load_dwordx4 v[168:171], v18, s[24:27], 0 offen offset:64 sc1
    buffer_load_dwordx4 v[172:175], v18, s[24:27], 0 offen offset:80 sc1
    buffer_load_dwordx4 v[176:179], v18, s[24:27], 0 offen offset:128 sc1
    buffer_load_dwordx4 v[180:183], v18, s[24:27], 0 offen offset:144 sc1
    buffer_load_dwordx4 v[184:187], v18, s[24:27], 0 offen offset:192 sc1
    buffer_load_dwordx4 v[188:191], v18, s[24:27], 0 offen offset:208 sc1
L_wdone12:
    s_barrier
    s_add_u32 m0, s37, 16384
    s_nop 0
    buffer_load_dwordx4 v6, s[12:15], s36 offen offset:0 sc1 lds
    buffer_load_dwordx4 v6, s[12:15], s36 offen offset:1024 sc1 lds
    buffer_load_dwordx4 v6, s[12:15], s36 offen offset:2048 sc1 lds
    buffer_load_dwordx4 v6, s[12:15], s36 offen offset:3072 sc1 lds
    s_add_u32 s36, s36, 4096
    s_add_u32 m0, s37, 49152
    s_nop 0
    buffer_load_dwordx4 v6, s[12:15], s36 offen offset:0 sc1 lds
    buffer_load_dwordx4 v6, s[12:15], s36 offen offset:1024 sc1 lds
    buffer_load_dwordx4 v6, s[12:15], s36 offen offset:2048 sc1 lds
    buffer_load_dwordx4 v6, s[12:15], s36 offen offset:3072 sc1 lds
    s_add_u32 s36, s36, 4096
    s_add_u32 m0, s37, 81920
    s_nop 0
    buffer_load_dwordx4 v6, s[12:15], s36 offen offset:0 sc1 lds
    buffer_load_dwordx4 v6, s[12:15], s36 offen offset:1024 sc1 lds
    buffer_load_dwordx4 v6, s[12:15], s36 offen offset:2048 sc1 lds
    buffer_load_dwordx4 v6, s[12:15], s36 offen offset:3072 sc1 lds
    s_add_u32 s36, s36, 4096
    s_add_u32 m0, s37, 114688
    s_nop 0
    buffer_load_dwordx4 v6, s[12:15], s36 offen offset:0 sc1 lds
    buffer_load_dwordx4 v6, s[12:15], s36 offen offset:1024 sc1 lds
    buffer_load_dwordx4 v6, s[12:15], s36 offen offset:2048 sc1 lds
    buffer_load_dwordx4 v6, s[12:15], s36 offen offset:3072 sc1 lds
    s_add_u32 s36, s36, 4096
    s_mov_b32 s63, s36
    buffer_load_dword v223, v27, s[12:15], s63 offen sc1
    s_add_u32 s63, s63, 4096
    buffer_load_dword v223, v27, s[12:15], s63 offen sc1
    s_add_u32 s63, s63, 4096
    s_waitcnt lgkmcnt(0)
    s_waitcnt vmcnt(14)
    s_barrier
    ds_read_b128 a[64:67], v14 offset:0
    ds_read_b128 a[68:71], v14 offset:4096
    ds_read_b64_tr_b16 a[0:1], v10 offset:0
    ds_read_b64_tr_b16 a[2:3], v10 offset:1024
    ds_read_b64_tr_b16 a[4:5], v11 offset:0
    ds_read_b64_tr_b16 a[6:7], v11 offset:1024
    ds_read_b128 a[72:75], v14 offset:1024
    ds_read_b128 a[76:79], v14 offset:5120
    ds_read_b64_tr_b16 a[8:9], v10 offset:4096
    ds_read_b64_tr_b16 a[10:11], v10 offset:5120
    ds_read_b64_tr_b16 a[12:13], v11 offset:4096
    ds_read_b64_tr_b16 a[14:15], v11 offset:5120
    ds_read_b128 a[80:83], v14 offset:2048
    ds_read_b128 a[84:87], v14 offset:6144
    ds_read_b64_tr_b16 a[16:17], v10 offset:8192
    ds_read_b64_tr_b16 a[18:19], v10 offset:9216
    ds_read_b64_tr_b16 a[20:21], v11 offset:8192
    ds_read_b64_tr_b16 a[22:23], v11 offset:9216
    ds_read_b128 a[88:91], v14 offset:3072
    ds_read_b128 a[92:95], v14 offset:7168
    ds_read_b64_tr_b16 a[24:25], v10 offset:12288
    ds_read_b64_tr_b16 a[26:27], v10 offset:13312
    ds_read_b64_tr_b16 a[28:29], v11 offset:12288
    ds_read_b64_tr_b16 a[30:31], v11 offset:13312
    s_waitcnt lgkmcnt(0)
    s_waitcnt vmcnt(10)
    s_barrier
    v_mfma_f32_32x32x16_bf16 v[32:47], a[0:3], a[64:67], 0
    ds_read_b128 a[96:99], v14 offset:32768
    s_add_u32 m0, s37, 0
    ds_read_b128 a[100:103], v14 offset:36864
    v_mfma_f32_32x32x16_bf16 v[48:63], a[0:3], a[68:71], 0
    buffer_load_dwordx4 v2, s[8:11], s35 offen offset:0 lds
    ds_read_b64_tr_b16 a[32:33], v10 offset:32768
    ds_read_b64_tr_b16 a[34:35], v10 offset:33792
    v_mfma_f32_32x32x16_bf16 v[64:79], a[4:7], a[64:67], 0
    buffer_load_dwordx4 v3, s[8:11], s35 offen offset:1024 lds
    ds_read_b64_tr_b16 a[36:37], v11 offset:32768
    ds_read_b64_tr_b16 a[38:39], v11 offset:33792
    v_mfma_f32_32x32x16_bf16 v[80:95], a[4:7], a[68:71], 0
    buffer_load_dwordx4 v4, s[8:11], s35 offen offset:2048 lds
    ds_read_b128 a[104:107], v14 offset:33792
    v_mfma_f32_32x32x16_bf16 v[32:47], a[8:11], a[72:75], v[32:47]
    buffer_load_dwordx4 v5, s[8:11], s35 offen offset:3072 lds
    ds_read_b128 a[108:111], v14 offset:37888
    ds_read_b64_tr_b16 a[40:41], v10 offset:36864
    v_mfma_f32_32x32x16_bf16 v[48:63], a[8:11], a[76:79], v[48:63]
    s_add_u32 s35, s35, 229376
    ds_read_b64_tr_b16 a[42:43], v10 offset:37888
    ds_read_b64_tr_b16 a[44:45], v11 offset:36864
    v_mfma_f32_32x32x16_bf16 v[64:79], a[12:15], a[72:75], v[64:79]
    s_add_u32 m0, s37, 16384
    ds_read_b64_tr_b16 a[46:47], v11 offset:37888
    v_mfma_f32_32x32x16_bf16 v[80:95], a[12:15], a[76:79], v[80:95]
    ds_read_b128 a[112:115], v14 offset:34816
    buffer_load_dwordx4 v6, s[12:15], s36 offen offset:0 sc1 lds
    ds_read_b128 a[116:119], v14 offset:38912
    v_mfma_f32_32x32x16_bf16 v[32:47], a[16:19], a[80:83], v[32:47]
    buffer_load_dwordx4 v6, s[12:15], s36 offen offset:1024 sc1 lds
    ds_read_b64_tr_b16 a[48:49], v10 offset:40960
    ds_read_b64_tr_b16 a[50:51], v10 offset:41984
    v_mfma_f32_32x32x16_bf16 v[48:63], a[16:19], a[84:87], v[48:63]
    buffer_load_dwordx4 v6, s[12:15], s36 offen offset:2048 sc1 lds
    ds_read_b64_tr_b16 a[52:53], v11 offset:40960
    ds_read_b64_tr_b16 a[54:55], v11 offset:41984
    v_mfma_f32_32x32x16_bf16 v[64:79], a[20:23], a[80:83], v[64:79]
    buffer_load_dwordx4 v6, s[12:15], s36 offen offset:3072 sc1 lds
    ds_read_b128 a[120:123], v14 offset:35840
    v_mfma_f32_32x32x16_bf16 v[80:95], a[20:23], a[84:87], v[80:95]
    s_add_u32 s36, s36, 4096
    ds_read_b128 a[124:127], v14 offset:39936
    ds_read_b64_tr_b16 a[56:57], v10 offset:45056
    v_mfma_f32_32x32x16_bf16 v[32:47], a[24:27], a[88:91], v[32:47]
    buffer_load_dword v223, v27, s[12:15], s63 offen sc1
    ds_read_b64_tr_b16 a[58:59], v10 offset:46080
    ds_read_b64_tr_b16 a[60:61], v11 offset:45056
    v_mfma_f32_32x32x16_bf16 v[48:63], a[24:27], a[92:95], v[48:63]
    s_add_u32 s63, s63, 4096
    ds_read_b64_tr_b16 a[62:63], v11 offset:46080
    v_mfma_f32_32x32x16_bf16 v[64:79], a[28:31], a[88:91], v[64:79]
    v_mfma_f32_32x32x16_bf16 v[80:95], a[28:31], a[92:95], v[80:95]
    s_waitcnt lgkmcnt(0)
    s_waitcnt vmcnt(15)
    s_barrier
    v_mfma_f32_32x32x16_bf16 v[32:47], a[32:35], a[96:99], v[32:47]
    ds_read_b128 a[64:67], v15 offset:0
    s_add_u32 m0, s37, 32768
    ds_read_b128 a[68:71], v15 offset:4096
    v_mfma_f32_32x32x16_bf16 v[48:63], a[32:35], a[100:103], v[48:63]
    buffer_load_dwordx4 v2, s[8:11], s35 offen offset:0 lds
    ds_read_b64_tr_b16 a[0:1], v12 offset:0
    ds_read_b64_tr_b16 a[2:3], v12 offset:1024
    v_mfma_f32_32x32x16_bf16 v[64:79], a[36:39], a[96:99], v[64:79]
    buffer_load_dwordx4 v3, s[8:11], s35 offen offset:1024 lds
    ds_read_b64_tr_b16 a[4:5], v13 offset:0
    ds_read_b64_tr_b16 a[6:7], v13 offset:1024
    v_mfma_f32_32x32x16_bf16 v[80:95], a[36:39], a[100:103], v[80:95]
    buffer_load_dwordx4 v4, s[8:11], s35 offen offset:2048 lds
    ds_read_b128 a[72:75], v15 offset:1024
    v_mfma_f32_32x32x16_bf16 v[32:47], a[40:43], a[104:107], v[32:47]
    buffer_load_dwordx4 v5, s[8:11], s35 offen offset:3072 lds
    ds_read_b128 a[76:79], v15 offset:5120
    ds_read_b64_tr_b16 a[8:9], v12 offset:4096
    v_mfma_f32_32x32x16_bf16 v[48:63], a[40:43], a[108:111], v[48:63]
    s_add_u32 s35, s35, 229376
    ds_read_b64_tr_b16 a[10:11], v12 offset:5120
    ds_read_b64_tr_b16 a[12:13], v13 offset:4096
    v_mfma_f32_32x32x16_bf16 v[64:79], a[44:47], a[104:107], v[64:79]
    s_add_u32 m0, s37, 49152
    ds_read_b64_tr_b16 a[14:15], v13 offset:5120
    v_mfma_f32_32x32x16_bf16 v[80:95], a[44:47], a[108:111], v[80:95]
    ds_read_b128 a[80:83], v15 offset:2048
    buffer_load_dwordx4 v6, s[12:15], s36 offen offset:0 sc1 lds
    ds_read_b128 a[84:87], v15 offset:6144
    v_mfma_f32_32x32x16_bf16 v[32:47], a[48:51], a[112:115], v[32:47]
    buffer_load_dwordx4 v6, s[12:15], s36 offen offset:1024 sc1 lds
    ds_read_b64_tr_b16 a[16:17], v12 offset:8192
    ds_read_b64_tr_b16 a[18:19], v12 offset:9216
    v_mfma_f32_32x32x16_bf16 v[48:63], a[48:51], a[116:119], v[48:63]
    buffer_load_dwordx4 v6, s[12:15], s36 offen offset:2048 sc1 lds
    ds_read_b64_tr_b16 a[20:21], v13 offset:8192
    ds_read_b64_tr_b16 a[22:23], v13 offset:9216
    v_mfma_f32_32x32x16_bf16 v[64:79], a[52:55], a[112:115], v[64:79]
    buffer_load_dwordx4 v6, s[12:15], s36 offen offset:3072 sc1 lds
    ds_read_b128 a[88:91], v15 offset:3072
    v_mfma_f32_32x32x16_bf16 v[80:95], a[52:55], a[116:119], v[80:95]
    s_add_u32 s36, s36, 4096
    ds_read_b128 a[92:95], v15 offset:7168
    ds_read_b64_tr_b16 a[24:25], v12 offset:12288
    v_mfma_f32_32x32x16_bf16 v[32:47], a[56:59], a[120:123], v[32:47]
    buffer_load_dword v223, v27, s[12:15], s63 offen sc1
    ds_read_b64_tr_b16 a[26:27], v12 offset:13312
    ds_read_b64_tr_b16 a[28:29], v13 offset:12288
    v_mfma_f32_32x32x16_bf16 v[48:63], a[56:59], a[124:127], v[48:63]
    s_add_u32 s63, s63, 4096
    ds_read_b64_tr_b16 a[30:31], v13 offset:13312
    v_mfma_f32_32x32x16_bf16 v[64:79], a[60:63], a[120:123], v[64:79]
    v_mfma_f32_32x32x16_bf16 v[80:95], a[60:63], a[124:127], v[80:95]
    s_waitcnt lgkmcnt(0)
    s_waitcnt vmcnt(20)
    s_barrier
    v_mfma_f32_32x32x16_bf16 v[32:47], a[0:3], a[64:67], v[32:47]
    ds_read_b128 a[96:99], v15 offset:32768
    s_add_u32 m0, s37, 65536
    ds_read_b128 a[100:103], v15 offset:36864
    v_mfma_f32_32x32x16_bf16 v[48:63], a[0:3], a[68:71], v[48:63]
    ds_read_b64_tr_b16 a[32:33], v12 offset:32768
    buffer_load_dwordx4 v2, s[8:11], s35 offen offset:0 lds
    ds_read_b64_tr_b16 a[34:35], v12 offset:33792
    v_mfma_f32_32x32x16_bf16 v[64:79], a[4:7], a[64:67], v[64:79]
    ds_read_b64_tr_b16 a[36:37], v13 offset:32768
    buffer_load_dwordx4 v3, s[8:11], s35 offen offset:1024 lds
    v_mfma_f32_32x32x16_bf16 v[80:95], a[4:7], a[68:71], v[80:95]
    ds_read_b64_tr_b16 a[38:39], v13 offset:33792
    ds_read_b128 a[104:107], v15 offset:33792
    buffer_load_dwordx4 v4, s[8:11], s35 offen offset:2048 lds
    v_mfma_f32_32x32x16_bf16 v[32:47], a[8:11], a[72:75], v[32:47]
    ds_read_b128 a[108:111], v15 offset:37888
    ds_read_b64_tr_b16 a[40:41], v12 offset:36864
    v_mfma_f32_32x32x16_bf16 v[48:63], a[8:11], a[76:79], v[48:63]
    buffer_load_dwordx4 v5, s[8:11], s35 offen offset:3072 lds
    ds_read_b64_tr_b16 a[42:43], v12 offset:37888
    ds_read_b64_tr_b16 a[44:45], v13 offset:36864
    v_mfma_f32_32x32x16_bf16 v[64:79], a[12:15], a[72:75], v[64:79]
    s_add_u32 s35, s35, 229376
    ds_read_b64_tr_b16 a[46:47], v13 offset:37888
    v_mfma_f32_32x32x16_bf16 v[80:95], a[12:15], a[76:79], v[80:95]
    ds_read_b128 a[112:115], v15 offset:34816
    s_add_u32 m0, s37, 81920
    ds_read_b128 a[116:119], v15 offset:38912
    v_mfma_f32_32x32x16_bf16 v[32:47], a[16:19], a[80:83], v[32:47]
    ds_read_b64_tr_b16 a[48:49], v12 offset:40960
    buffer_load_dwordx4 v6, s[12:15], s36 offen offset:0 sc1 lds
    ds_read_b64_tr_b16 a[50:51], v12 offset:41984
    v_mfma_f32_32x32x16_bf16 v[48:63], a[16:19], a[84:87], v[48:63]
    ds_read_b64_tr_b16 a[52:53], v13 offset:40960
    buffer_load_dwordx4 v6, s[12:15], s36 offen offset:1024 sc1 lds
    v_mfma_f32_32x32x16_bf16 v[64:79], a[20:23], a[80:83], v[64:79]
    ds_read_b64_tr_b16 a[54:55], v13 offset:41984
    ds_read_b128 a[120:123], v15 offset:35840
    buffer_load_dwordx4 v6, s[12:15], s36 offen offset:2048 sc1 lds
    v_mfma_f32_32x32x16_bf16 v[80:95], a[20:23], a[84:87], v[80:95]
    ds_read_b128 a[124:127], v15 offset:39936
    ds_read_b64_tr_b16 a[56:57], v12 offset:45056
    v_mfma_f32_32x32x16_bf16 v[32:47], a[24:27], a[88:91], v[32:47]
    buffer_load_dwordx4 v6, s[12:15], s36 offen offset:3072 sc1 lds
    ds_read_b64_tr_b16 a[58:59], v12 offset:46080
    ds_read_b64_tr_b16 a[60:61], v13 offset:45056
    v_mfma_f32_32x32x16_bf16 v[48:63], a[24:27], a[92:95], v[48:63]
    s_add_u32 s36, s36, 4096
    ds_read_b64_tr_b16 a[62:63], v13 offset:46080
    v_mfma_f32_32x32x16_bf16 v[64:79], a[28:31], a[88:91], v[64:79]
    v_mfma_f32_32x32x16_bf16 v[80:95], a[28:31], a[92:95], v[80:95]
    s_waitcnt lgkmcnt(0)
    s_waitcnt vmcnt(18)
    s_barrier
    v_mfma_f32_32x32x16_bf16 v[32:47], a[32:35], a[96:99], v[32:47]
    ds_read_b128 a[64:67], v14 offset:0
    s_add_u32 m0, s37, 98304
    ds_read_b128 a[68:71], v14 offset:4096
    v_mfma_f32_32x32x16_bf16 v[48:63], a[32:35], a[100:103], v[48:63]
    ds_read_b64_tr_b16 a[0:1], v10 offset:0
    buffer_load_dwordx4 v2, s[8:11], s35 offen offset:0 lds
    ds_read_b64_tr_b16 a[2:3], v10 offset:1024
    v_mfma_f32_32x32x16_bf16 v[64:79], a[36:39], a[96:99], v[64:79]
    ds_read_b64_tr_b16 a[4:5], v11 offset:0
    buffer_load_dwordx4 v3, s[8:11], s35 offen offset:1024 lds
    v_mfma_f32_32x32x16_bf16 v[80:95], a[36:39], a[100:103], v[80:95]
    ds_read_b64_tr_b16 a[6:7], v11 offset:1024
    ds_read_b128 a[72:75], v14 offset:1024
    buffer_load_dwordx4 v4, s[8:11], s35 offen offset:2048 lds
    v_mfma_f32_32x32x16_bf16 v[32:47], a[40:43], a[104:107], v[32:47]
    ds_read_b128 a[76:79], v14 offset:5120
    ds_read_b64_tr_b16 a[8:9], v10 offset:4096
    v_mfma_f32_32x32x16_bf16 v[48:63], a[40:43], a[108:111], v[48:63]
    buffer_load_dwordx4 v5, s[8:11], s35 offen offset:3072 lds
    ds_read_b64_tr_b16 a[10:11], v10 offset:5120
    ds_read_b64_tr_b16 a[12:13], v11 offset:4096
    v_mfma_f32_32x32x16_bf16 v[64:79], a[44:47], a[104:107], v[64:79]
    s_add_u32 s35, s35, 229376
    ds_read_b64_tr_b16 a[14:15], v11 offset:5120
    v_mfma_f32_32x32x16_bf16 v[80:95], a[44:47], a[108:111], v[80:95]
    ds_read_b128 a[80:83], v14 offset:2048
    s_add_u32 m0, s37, 114688
    ds_read_b128 a[84:87], v14 offset:6144
    v_mfma_f32_32x32x16_bf16 v[32:47], a[48:51], a[112:115], v[32:47]
    ds_read_b64_tr_b16 a[16:17], v10 offset:8192
    buffer_load_dwordx4 v6, s[12:15], s36 offen offset:0 sc1 lds
    ds_read_b64_tr_b16 a[18:19], v10 offset:9216
    v_mfma_f32_32x32x16_bf16 v[48:63], a[48:51], a[116:119], v[48:63]
    ds_read_b64_tr_b16 a[20:21], v11 offset:8192
    buffer_load_dwordx4 v6, s[12:15], s36 offen offset:1024 sc1 lds
    v_mfma_f32_32x32x16_bf16 v[64:79], a[52:55], a[112:115], v[64:79]
    ds_read_b64_tr_b16 a[22:23], v11 offset:9216
    ds_read_b128 a[88:91], v14 offset:3072
    buffer_load_dwordx4 v6, s[12:15], s36 offen offset:2048 sc1 lds
    v_mfma_f32_32x32x16_bf16 v[80:95], a[52:55], a[116:119], v[80:95]
    ds_read_b128 a[92:95], v14 offset:7168
    ds_read_b64_tr_b16 a[24:25], v10 offset:12288
    v_mfma_f32_32x32x16_bf16 v[32:47], a[56:59], a[120:123], v[32:47]
    buffer_load_dwordx4 v6, s[12:15], s36 offen offset:3072 sc1 lds
    ds_read_b64_tr_b16 a[26:27], v10 offset:13312
    ds_read_b64_tr_b16 a[28:29], v11 offset:12288
    v_mfma_f32_32x32x16_bf16 v[48:63], a[56:59], a[124:127], v[48:63]
    s_add_u32 s36, s36, 4096
    ds_read_b64_tr_b16 a[30:31], v11 offset:13312
    v_mfma_f32_32x32x16_bf16 v[64:79], a[60:63], a[120:123], v[64:79]
    v_mfma_f32_32x32x16_bf16 v[80:95], a[60:63], a[124:127], v[80:95]
    s_waitcnt lgkmcnt(0)
    s_waitcnt vmcnt(17)
    s_barrier
    v_mfma_f32_32x32x16_bf16 v[32:47], a[0:3], a[64:67], v[32:47]
    ds_read_b128 a[96:99], v14 offset:32768
    s_mov_b32 s55, 0
    ds_read_b128 a[100:103], v14 offset:36864
    buffer_load_dwordx2 v[96:97], v17, s[20:23], s55 offen offset:0 sc1
    v_mfma_f32_32x32x16_bf16 v[48:63], a[0:3], a[68:71], v[48:63]
    ds_read_b64_tr_b16 a[32:33], v10 offset:32768
    buffer_load_dwordx2 v[112:113], v17, s[20:23], s55 offen offset:256 sc1
    ds_read_b64_tr_b16 a[34:35], v10 offset:33792
    v_mfma_f32_32x32x16_bf16 v[64:79], a[4:7], a[64:67], v[64:79]
    s_mov_b32 s55, 16384
    ds_read_b64_tr_b16 a[36:37], v11 offset:32768
    buffer_load_dwordx2 v[98:99], v17, s[20:23], s55 offen offset:0 sc1
    ds_read_b64_tr_b16 a[38:39], v11 offset:33792
    v_mfma_f32_32x32x16_bf16 v[80:95], a[4:7], a[68:71], v[80:95]
    buffer_load_dwordx2 v[114:115], v17, s[20:23], s55 offen offset:256 sc1
    ds_read_b128 a[104:107], v14 offset:33792
    s_mov_b32 s55, 32768
    v_mfma_f32_32x32x16_bf16 v[32:47], a[8:11], a[72:75], v[32:47]
    ds_read_b128 a[108:111], v14 offset:37888
    buffer_load_dwordx2 v[100:101], v17, s[20:23], s55 offen offset:0 sc1
    ds_read_b64_tr_b16 a[40:41], v10 offset:36864
    buffer_load_dwordx2 v[116:117], v17, s[20:23], s55 offen offset:256 sc1
    v_mfma_f32_32x32x16_bf16 v[48:63], a[8:11], a[76:79], v[48:63]
    ds_read_b64_tr_b16 a[42:43], v10 offset:37888
    s_mov_b32 s55, 49152
    ds_read_b64_tr_b16 a[44:45], v11 offset:36864
    v_mfma_f32_32x32x16_bf16 v[64:79], a[12:15], a[72:75], v[64:79]
    buffer_load_dwordx2 v[102:103], v17, s[20:23], s55 offen offset:0 sc1
    ds_read_b64_tr_b16 a[46:47], v11 offset:37888
    buffer_load_dwordx2 v[118:119], v17, s[20:23], s55 offen offset:256 sc1
    v_mfma_f32_32x32x16_bf16 v[80:95], a[12:15], a[76:79], v[80:95]
    ds_read_b128 a[112:115], v14 offset:34816
    s_mov_b32 s55, 65536
    ds_read_b128 a[116:119], v14 offset:38912
    buffer_load_dwordx2 v[104:105], v17, s[20:23], s55 offen offset:0 sc1
    v_mfma_f32_32x32x16_bf16 v[32:47], a[16:19], a[80:83], v[32:47]
    ds_read_b64_tr_b16 a[48:49], v10 offset:40960
    buffer_load_dwordx2 v[120:121], v17, s[20:23], s55 offen offset:256 sc1
    ds_read_b64_tr_b16 a[50:51], v10 offset:41984
    v_mfma_f32_32x32x16_bf16 v[48:63], a[16:19], a[84:87], v[48:63]
    s_mov_b32 s55, 81920
    ds_read_b64_tr_b16 a[52:53], v11 offset:40960
    buffer_load_dwordx2 v[106:107], v17, s[20:23], s55 offen offset:0 sc1
    ds_read_b64_tr_b16 a[54:55], v11 offset:41984
    v_mfma_f32_32x32x16_bf16 v[64:79], a[20:23], a[80:83], v[64:79]
    buffer_load_dwordx2 v[122:123], v17, s[20:23], s55 offen offset:256 sc1
    ds_read_b128 a[120:123], v14 offset:35840
    s_mov_b32 s55, 98304
    v_mfma_f32_32x32x16_bf16 v[80:95], a[20:23], a[84:87], v[80:95]
    ds_read_b128 a[124:127], v14 offset:39936
    buffer_load_dwordx2 v[108:109], v17, s[20:23], s55 offen offset:0 sc1
    ds_read_b64_tr_b16 a[56:57], v10 offset:45056
    buffer_load_dwordx2 v[124:125], v17, s[20:23], s55 offen offset:256 sc1
    v_mfma_f32_32x32x16_bf16 v[32:47], a[24:27], a[88:91], v[32:47]
    ds_read_b64_tr_b16 a[58:59], v10 offset:46080
    s_mov_b32 s55, 114688
    ds_read_b64_tr_b16 a[60:61], v11 offset:45056
    v_mfma_f32_32x32x16_bf16 v[48:63], a[24:27], a[92:95], v[48:63]
    buffer_load_dwordx2 v[110:111], v17, s[20:23], s55 offen offset:0 sc1
    ds_read_b64_tr_b16 a[62:63], v11 offset:46080
    buffer_load_dwordx2 v[126:127], v17, s[20:23], s55 offen offset:256 sc1
    v_mfma_f32_32x32x16_bf16 v[64:79], a[28:31], a[88:91], v[64:79]
    v_mfma_f32_32x32x16_bf16 v[80:95], a[28:31], a[92:95], v[80:95]
    s_waitcnt lgkmcnt(0)
    s_waitcnt vmcnt(24)
    s_barrier
    v_mfma_f32_32x32x16_bf16 v[32:47], a[32:35], a[96:99], v[32:47]
    ds_read_b128 a[64:67], v15 offset:0
    ds_read_b128 a[68:71], v15 offset:4096
    v_mfma_f32_32x32x16_bf16 v[48:63], a[32:35], a[100:103], v[48:63]
    ds_read_b64_tr_b16 a[0:1], v12 offset:0
    ds_read_b64_tr_b16 a[2:3], v12 offset:1024
    v_mfma_f32_32x32x16_bf16 v[64:79], a[36:39], a[96:99], v[64:79]
    ds_read_b64_tr_b16 a[4:5], v13 offset:0
    ds_read_b64_tr_b16 a[6:7], v13 offset:1024
    v_mfma_f32_32x32x16_bf16 v[80:95], a[36:39], a[100:103], v[80:95]
    ds_read_b128 a[72:75], v15 offset:1024
    v_mfma_f32_32x32x16_bf16 v[32:47], a[40:43], a[104:107], v[32:47]
    ds_read_b128 a[76:79], v15 offset:5120
    ds_read_b64_tr_b16 a[8:9], v12 offset:4096
    v_mfma_f32_32x32x16_bf16 v[48:63], a[40:43], a[108:111], v[48:63]
    ds_read_b64_tr_b16 a[10:11], v12 offset:5120
    ds_read_b64_tr_b16 a[12:13], v13 offset:4096
    v_mfma_f32_32x32x16_bf16 v[64:79], a[44:47], a[104:107], v[64:79]
    ds_read_b64_tr_b16 a[14:15], v13 offset:5120
    v_mfma_f32_32x32x16_bf16 v[80:95], a[44:47], a[108:111], v[80:95]
    ds_read_b128 a[80:83], v15 offset:2048
    ds_read_b128 a[84:87], v15 offset:6144
    v_mfma_f32_32x32x16_bf16 v[32:47], a[48:51], a[112:115], v[32:47]
    ds_read_b64_tr_b16 a[16:17], v12 offset:8192
    ds_read_b64_tr_b16 a[18:19], v12 offset:9216
    v_mfma_f32_32x32x16_bf16 v[48:63], a[48:51], a[116:119], v[48:63]
    ds_read_b64_tr_b16 a[20:21], v13 offset:8192
    ds_read_b64_tr_b16 a[22:23], v13 offset:9216
    v_mfma_f32_32x32x16_bf16 v[64:79], a[52:55], a[112:115], v[64:79]
    ds_read_b128 a[88:91], v15 offset:3072
    v_mfma_f32_32x32x16_bf16 v[80:95], a[52:55], a[116:119], v[80:95]
    ds_read_b128 a[92:95], v15 offset:7168
    ds_read_b64_tr_b16 a[24:25], v12 offset:12288
    v_mfma_f32_32x32x16_bf16 v[32:47], a[56:59], a[120:123], v[32:47]
    ds_read_b64_tr_b16 a[26:27], v12 offset:13312
    ds_read_b64_tr_b16 a[28:29], v13 offset:12288
    v_mfma_f32_32x32x16_bf16 v[48:63], a[56:59], a[124:127], v[48:63]
    ds_read_b64_tr_b16 a[30:31], v13 offset:13312
    v_mfma_f32_32x32x16_bf16 v[64:79], a[60:63], a[120:123], v[64:79]
    v_mfma_f32_32x32x16_bf16 v[80:95], a[60:63], a[124:127], v[80:95]
    s_waitcnt lgkmcnt(0)
    s_waitcnt vmcnt(16)
    s_barrier
    v_mfma_f32_32x32x16_bf16 v[32:47], a[0:3], a[64:67], v[32:47]
    ds_read_b128 a[96:99], v15 offset:32768
    ds_read_b128 a[100:103], v15 offset:36864
    v_mfma_f32_32x32x16_bf16 v[48:63], a[0:3], a[68:71], v[48:63]
    ds_read_b64_tr_b16 a[32:33], v12 offset:32768
    ds_read_b64_tr_b16 a[34:35], v12 offset:33792
    v_mfma_f32_32x32x16_bf16 v[64:79], a[4:7], a[64:67], v[64:79]
    ds_read_b64_tr_b16 a[36:37], v13 offset:32768
    ds_read_b64_tr_b16 a[38:39], v13 offset:33792
    v_mfma_f32_32x32x16_bf16 v[80:95], a[4:7], a[68:71], v[80:95]
    ds_read_b128 a[104:107], v15 offset:33792
    v_mfma_f32_32x32x16_bf16 v[32:47], a[8:11], a[72:75], v[32:47]
    ds_read_b128 a[108:111], v15 offset:37888
    ds_read_b64_tr_b16 a[40:41], v12 offset:36864
    v_mfma_f32_32x32x16_bf16 v[48:63], a[8:11], a[76:79], v[48:63]
    ds_read_b64_tr_b16 a[42:43], v12 offset:37888
    ds_read_b64_tr_b16 a[44:45], v13 offset:36864
    v_mfma_f32_32x32x16_bf16 v[64:79], a[12:15], a[72:75], v[64:79]
    ds_read_b64_tr_b16 a[46:47], v13 offset:37888
    v_mfma_f32_32x32x16_bf16 v[80:95], a[12:15], a[76:79], v[80:95]
    ds_read_b128 a[112:115], v15 offset:34816
    ds_read_b128 a[116:119], v15 offset:38912
    v_mfma_f32_32x32x16_bf16 v[32:47], a[16:19], a[80:83], v[32:47]
    ds_read_b64_tr_b16 a[48:49], v12 offset:40960
    ds_read_b64_tr_b16 a[50:51], v12 offset:41984
    v_mfma_f32_32x32x16_bf16 v[48:63], a[16:19], a[84:87], v[48:63]
    ds_read_b64_tr_b16 a[52:53], v13 offset:40960
    ds_read_b64_tr_b16 a[54:55], v13 offset:41984
    v_mfma_f32_32x32x16_bf16 v[64:79], a[20:23], a[80:83], v[64:79]
    ds_read_b128 a[120:123], v15 offset:35840
    v_mfma_f32_32x32x16_bf16 v[80:95], a[20:23], a[84:87], v[80:95]
    ds_read_b128 a[124:127], v15 offset:39936
    ds_read_b64_tr_b16 a[56:57], v12 offset:45056
    v_mfma_f32_32x32x16_bf16 v[32:47], a[24:27], a[88:91], v[32:47]
    ds_read_b64_tr_b16 a[58:59], v12 offset:46080
    ds_read_b64_tr_b16 a[60:61], v13 offset:45056
    v_mfma_f32_32x32x16_bf16 v[48:63], a[24:27], a[92:95], v[48:63]
    ds_read_b64_tr_b16 a[62:63], v13 offset:46080
    v_mfma_f32_32x32x16_bf16 v[64:79], a[28:31], a[88:91], v[64:79]
    v_mfma_f32_32x32x16_bf16 v[80:95], a[28:31], a[92:95], v[80:95]
    s_waitcnt lgkmcnt(0)
    v_mfma_f32_32x32x16_bf16 v[32:47], a[32:35], a[96:99], v[32:47]
    v_mfma_f32_32x32x16_bf16 v[48:63], a[32:35], a[100:103], v[48:63]
    v_mfma_f32_32x32x16_bf16 v[64:79], a[36:39], a[96:99], v[64:79]
    v_mfma_f32_32x32x16_bf16 v[80:95], a[36:39], a[100:103], v[80:95]
    v_mfma_f32_32x32x16_bf16 v[32:47], a[40:43], a[104:107], v[32:47]
    v_mfma_f32_32x32x16_bf16 v[48:63], a[40:43], a[108:111], v[48:63]
    v_mfma_f32_32x32x16_bf16 v[64:79], a[44:47], a[104:107], v[64:79]
    v_mfma_f32_32x32x16_bf16 v[80:95], a[44:47], a[108:111], v[80:95]
    v_mfma_f32_32x32x16_bf16 v[32:47], a[48:51], a[112:115], v[32:47]
    v_mfma_f32_32x32x16_bf16 v[48:63], a[48:51], a[116:119], v[48:63]
    v_mfma_f32_32x32x16_bf16 v[64:79], a[52:55], a[112:115], v[64:79]
    v_mfma_f32_32x32x16_bf16 v[80:95], a[52:55], a[116:119], v[80:95]
    v_mfma_f32_32x32x16_bf16 v[32:47], a[56:59], a[120:123], v[32:47]
    v_mfma_f32_32x32x16_bf16 v[48:63], a[56:59], a[124:127], v[48:63]
    v_mfma_f32_32x32x16_bf16 v[64:79], a[60:63], a[120:123], v[64:79]
    v_mfma_f32_32x32x16_bf16 v[80:95], a[60:63], a[124:127], v[80:95]
    s_barrier
    s_waitcnt vmcnt(0)
    v_add_f32 v96, v96, v104
    v_add_f32 v97, v97, v105
    v_add_f32 v98, v98, v106
    v_add_f32 v99, v99, v107
    v_add_f32 v100, v100, v108
    v_add_f32 v101, v101, v109
    v_add_f32 v102, v102, v110
    v_add_f32 v103, v103, v111
    v_add_f32 v96, v96, v100
    v_add_f32 v97, v97, v101
    v_add_f32 v98, v98, v102
    v_add_f32 v99, v99, v103
    v_add_f32 v96, v96, v98
    v_add_f32 v97, v97, v99
    v_add_f32 v112, v112, v120
    v_add_f32 v113, v113, v121
    v_add_f32 v114, v114, v122
    v_add_f32 v115, v115, v123
    v_add_f32 v116, v116, v124
    v_add_f32 v117, v117, v125
    v_add_f32 v118, v118, v126
    v_add_f32 v119, v119, v127
    v_add_f32 v112, v112, v116
    v_add_f32 v113, v113, v117
    v_add_f32 v114, v114, v118
    v_add_f32 v115, v115, v119
    v_add_f32 v112, v112, v114
    v_add_f32 v113, v113, v115
    v_mov_b32 v98, v96
    v_mov_b32 v99, v97
    v_mov_b32 v114, v112
    v_mov_b32 v115, v113
    s_nop 1
    v_permlane32_swap_b32 v96, v98
    v_permlane32_swap_b32 v97, v99
    v_permlane32_swap_b32 v112, v114
    v_permlane32_swap_b32 v113, v115
    s_nop 1
    v_add_f32 v96, v96, v98
    v_add_f32 v97, v97, v99
    v_mul_f32 v192, 0.001953125, v96
    v_mul_f32 v97, 0.001953125, v97
    v_fma_f32 v97, -v192, v192, v97
    v_max_f32 v97, 0, v97
    v_add_f32 v97, 0x3727c5ac, v97
    v_rsq_f32 v98, v97
    v_sqrt_f32 v204, v97
    s_nop 0
    v_mul_f32 v196, 0xc0135761, v98
    v_mul_f32 v99, v98, v98
    v_mul_f32 v200, v99, v98
    v_mul_f32 v200, 0xbdd2d3e8, v200
    v_add_f32 v112, v112, v114
    v_add_f32 v113, v113, v115
    v_mul_f32 v194, 0.001953125, v112
    v_mul_f32 v113, 0.001953125, v113
    v_fma_f32 v113, -v194, v194, v113
    v_max_f32 v113, 0, v113
    v_add_f32 v113, 0x3727c5ac, v113
    v_rsq_f32 v114, v113
    v_sqrt_f32 v206, v113
    s_nop 0
    v_mul_f32 v198, 0xc0135761, v114
    v_mul_f32 v115, v114, v114
    v_mul_f32 v202, v115, v114
    v_mul_f32 v202, 0xbdd2d3e8, v202
    v_pk_fma_f32 v[32:33], v[192:193], v[160:161], v[32:33] op_sel_hi:[0,1,1] neg_lo:[1,0,0] neg_hi:[1,0,0]
    v_pk_fma_f32 v[34:35], v[192:193], v[162:163], v[34:35] op_sel_hi:[0,1,1] neg_lo:[1,0,0] neg_hi:[1,0,0]
    v_pk_fma_f32 v[36:37], v[192:193], v[164:165], v[36:37] op_sel_hi:[0,1,1] neg_lo:[1,0,0] neg_hi:[1,0,0]
    v_pk_fma_f32 v[38:39], v[192:193], v[166:167], v[38:39] op_sel_hi:[0,1,1] neg_lo:[1,0,0] neg_hi:[1,0,0]
    v_pk_fma_f32 v[40:41], v[192:193], v[168:169], v[40:41] op_sel_hi:[0,1,1] neg_lo:[1,0,0] neg_hi:[1,0,0]
    v_pk_fma_f32 v[42:43], v[192:193], v[170:171], v[42:43] op_sel_hi:[0,1,1] neg_lo:[1,0,0] neg_hi:[1,0,0]
    v_pk_fma_f32 v[44:45], v[192:193], v[172:173], v[44:45] op_sel_hi:[0,1,1] neg_lo:[1,0,0] neg_hi:[1,0,0]
    v_pk_fma_f32 v[46:47], v[192:193], v[174:175], v[46:47] op_sel_hi:[0,1,1] neg_lo:[1,0,0] neg_hi:[1,0,0]
    v_pk_mul_f32 v[128:129], v[32:33], v[32:33]
    v_pk_mul_f32 v[130:131], v[34:35], v[34:35]
    v_pk_mul_f32 v[132:133], v[36:37], v[36:37]
    v_pk_mul_f32 v[134:135], v[38:39], v[38:39]
    v_pk_mul_f32 v[136:137], v[40:41], v[40:41]
    v_pk_mul_f32 v[138:139], v[42:43], v[42:43]
    v_pk_mul_f32 v[140:141], v[44:45], v[44:45]
    v_pk_mul_f32 v[142:143], v[46:47], v[46:47]
    v_pk_fma_f32 v[128:129], v[128:129], v[200:201], v[196:197] op_sel_hi:[1,0,0]
    v_pk_fma_f32 v[130:131], v[130:131], v[200:201], v[196:197] op_sel_hi:[1,0,0]
    v_pk_fma_f32 v[132:133], v[132:133], v[200:201], v[196:197] op_sel_hi:[1,0,0]
    v_pk_fma_f32 v[134:135], v[134:135], v[200:201], v[196:197] op_sel_hi:[1,0,0]
    v_pk_fma_f32 v[136:137], v[136:137], v[200:201], v[196:197] op_sel_hi:[1,0,0]
    v_pk_fma_f32 v[138:139], v[138:139], v[200:201], v[196:197] op_sel_hi:[1,0,0]
    v_pk_fma_f32 v[140:141], v[140:141], v[200:201], v[196:197] op_sel_hi:[1,0,0]
    v_pk_fma_f32 v[142:143], v[142:143], v[200:201], v[196:197] op_sel_hi:[1,0,0]
    v_pk_mul_f32 v[128:129], v[128:129], v[32:33]
    v_pk_mul_f32 v[130:131], v[130:131], v[34:35]
    v_pk_mul_f32 v[132:133], v[132:133], v[36:37]
    v_pk_mul_f32 v[134:135], v[134:135], v[38:39]
    v_pk_mul_f32 v[136:137], v[136:137], v[40:41]
    v_pk_mul_f32 v[138:139], v[138:139], v[42:43]
    v_pk_mul_f32 v[140:141], v[140:141], v[44:45]
    v_pk_mul_f32 v[142:143], v[142:143], v[46:47]
    v_exp_f32 v128, v128
    v_exp_f32 v129, v129
    v_exp_f32 v130, v130
    v_exp_f32 v131, v131
    v_exp_f32 v132, v132
    v_exp_f32 v133, v133
    v_exp_f32 v134, v134
    v_exp_f32 v135, v135
    v_exp_f32 v136, v136
    v_exp_f32 v137, v137
    v_exp_f32 v138, v138
    v_exp_f32 v139, v139
    v_exp_f32 v140, v140
    v_exp_f32 v141, v141
    v_exp_f32 v142, v142
    v_exp_f32 v143, v143
    v_pk_fma_f32 v[128:129], v[128:129], v[204:205], v[204:205] op_sel_hi:[1,0,0]
    v_pk_fma_f32 v[130:131], v[130:131], v[204:205], v[204:205] op_sel_hi:[1,0,0]
    v_pk_fma_f32 v[132:133], v[132:133], v[204:205], v[204:205] op_sel_hi:[1,0,0]
    v_pk_fma_f32 v[134:135], v[134:135], v[204:205], v[204:205] op_sel_hi:[1,0,0]
    v_pk_fma_f32 v[136:137], v[136:137], v[204:205], v[204:205] op_sel_hi:[1,0,0]
    v_pk_fma_f32 v[138:139], v[138:139], v[204:205], v[204:205] op_sel_hi:[1,0,0]
    v_pk_fma_f32 v[140:141], v[140:141], v[204:205], v[204:205] op_sel_hi:[1,0,0]
    v_pk_fma_f32 v[142:143], v[142:143], v[204:205], v[204:205] op_sel_hi:[1,0,0]
    v_rcp_f32 v128, v128
    v_rcp_f32 v129, v129
    v_rcp_f32 v130, v130
    v_rcp_f32 v131, v131
    v_rcp_f32 v132, v132
    v_rcp_f32 v133, v133
    v_rcp_f32 v134, v134
    v_rcp_f32 v135, v135
    v_rcp_f32 v136, v136
    v_rcp_f32 v137, v137
    v_rcp_f32 v138, v138
    v_rcp_f32 v139, v139
    v_rcp_f32 v140, v140
    v_rcp_f32 v141, v141
    v_rcp_f32 v142, v142
    v_rcp_f32 v143, v143
    v_pk_mul_f32 v[32:33], v[32:33], v[128:129]
    v_pk_mul_f32 v[34:35], v[34:35], v[130:131]
    v_pk_mul_f32 v[36:37], v[36:37], v[132:133]
    v_pk_mul_f32 v[38:39], v[38:39], v[134:135]
    v_pk_mul_f32 v[40:41], v[40:41], v[136:137]
    v_pk_mul_f32 v[42:43], v[42:43], v[138:139]
    v_pk_mul_f32 v[44:45], v[44:45], v[140:141]
    v_pk_mul_f32 v[46:47], v[46:47], v[142:143]
    v_cvt_pk_bf16_f32 v144, v32, v33
    v_cvt_pk_bf16_f32 v145, v34, v35
    v_cvt_pk_bf16_f32 v146, v36, v37
    v_cvt_pk_bf16_f32 v147, v38, v39
    s_mov_b32 s48, 0
    buffer_store_dwordx4 v[144:147], v16, s[16:19], s48 offen offset:0 sc1
    v_cvt_pk_bf16_f32 v148, v40, v41
    v_cvt_pk_bf16_f32 v149, v42, v43
    v_cvt_pk_bf16_f32 v150, v44, v45
    v_cvt_pk_bf16_f32 v151, v46, v47
    s_mov_b32 s48, 0
    buffer_store_dwordx4 v[148:151], v16, s[16:19], s48 offen offset:1024 sc1
    v_pk_fma_f32 v[64:65], v[192:193], v[176:177], v[64:65] op_sel_hi:[0,1,1] neg_lo:[1,0,0] neg_hi:[1,0,0]
    v_pk_fma_f32 v[66:67], v[192:193], v[178:179], v[66:67] op_sel_hi:[0,1,1] neg_lo:[1,0,0] neg_hi:[1,0,0]
    v_pk_fma_f32 v[68:69], v[192:193], v[180:181], v[68:69] op_sel_hi:[0,1,1] neg_lo:[1,0,0] neg_hi:[1,0,0]
    v_pk_fma_f32 v[70:71], v[192:193], v[182:183], v[70:71] op_sel_hi:[0,1,1] neg_lo:[1,0,0] neg_hi:[1,0,0]
    v_pk_fma_f32 v[72:73], v[192:193], v[184:185], v[72:73] op_sel_hi:[0,1,1] neg_lo:[1,0,0] neg_hi:[1,0,0]
    v_pk_fma_f32 v[74:75], v[192:193], v[186:187], v[74:75] op_sel_hi:[0,1,1] neg_lo:[1,0,0] neg_hi:[1,0,0]
    v_pk_fma_f32 v[76:77], v[192:193], v[188:189], v[76:77] op_sel_hi:[0,1,1] neg_lo:[1,0,0] neg_hi:[1,0,0]
    v_pk_fma_f32 v[78:79], v[192:193], v[190:191], v[78:79] op_sel_hi:[0,1,1] neg_lo:[1,0,0] neg_hi:[1,0,0]
    v_pk_mul_f32 v[128:129], v[64:65], v[64:65]
    v_pk_mul_f32 v[130:131], v[66:67], v[66:67]
    v_pk_mul_f32 v[132:133], v[68:69], v[68:69]
    v_pk_mul_f32 v[134:135], v[70:71], v[70:71]
    v_pk_mul_f32 v[136:137], v[72:73], v[72:73]
    v_pk_mul_f32 v[138:139], v[74:75], v[74:75]
    v_pk_mul_f32 v[140:141], v[76:77], v[76:77]
    v_pk_mul_f32 v[142:143], v[78:79], v[78:79]
    v_pk_fma_f32 v[128:129], v[128:129], v[200:201], v[196:197] op_sel_hi:[1,0,0]
    v_pk_fma_f32 v[130:131], v[130:131], v[200:201], v[196:197] op_sel_hi:[1,0,0]
    v_pk_fma_f32 v[132:133], v[132:133], v[200:201], v[196:197] op_sel_hi:[1,0,0]
    v_pk_fma_f32 v[134:135], v[134:135], v[200:201], v[196:197] op_sel_hi:[1,0,0]
    v_pk_fma_f32 v[136:137], v[136:137], v[200:201], v[196:197] op_sel_hi:[1,0,0]
    v_pk_fma_f32 v[138:139], v[138:139], v[200:201], v[196:197] op_sel_hi:[1,0,0]
    v_pk_fma_f32 v[140:141], v[140:141], v[200:201], v[196:197] op_sel_hi:[1,0,0]
    v_pk_fma_f32 v[142:143], v[142:143], v[200:201], v[196:197] op_sel_hi:[1,0,0]
    v_pk_mul_f32 v[128:129], v[128:129], v[64:65]
    v_pk_mul_f32 v[130:131], v[130:131], v[66:67]
    v_pk_mul_f32 v[132:133], v[132:133], v[68:69]
    v_pk_mul_f32 v[134:135], v[134:135], v[70:71]
    v_pk_mul_f32 v[136:137], v[136:137], v[72:73]
    v_pk_mul_f32 v[138:139], v[138:139], v[74:75]
    v_pk_mul_f32 v[140:141], v[140:141], v[76:77]
    v_pk_mul_f32 v[142:143], v[142:143], v[78:79]
    v_exp_f32 v128, v128
    v_exp_f32 v129, v129
    v_exp_f32 v130, v130
    v_exp_f32 v131, v131
    v_exp_f32 v132, v132
    v_exp_f32 v133, v133
    v_exp_f32 v134, v134
    v_exp_f32 v135, v135
    v_exp_f32 v136, v136
    v_exp_f32 v137, v137
    v_exp_f32 v138, v138
    v_exp_f32 v139, v139
    v_exp_f32 v140, v140
    v_exp_f32 v141, v141
    v_exp_f32 v142, v142
    v_exp_f32 v143, v143
    v_pk_fma_f32 v[128:129], v[128:129], v[204:205], v[204:205] op_sel_hi:[1,0,0]
    v_pk_fma_f32 v[130:131], v[130:131], v[204:205], v[204:205] op_sel_hi:[1,0,0]
    v_pk_fma_f32 v[132:133], v[132:133], v[204:205], v[204:205] op_sel_hi:[1,0,0]
    v_pk_fma_f32 v[134:135], v[134:135], v[204:205], v[204:205] op_sel_hi:[1,0,0]
    v_pk_fma_f32 v[136:137], v[136:137], v[204:205], v[204:205] op_sel_hi:[1,0,0]
    v_pk_fma_f32 v[138:139], v[138:139], v[204:205], v[204:205] op_sel_hi:[1,0,0]
    v_pk_fma_f32 v[140:141], v[140:141], v[204:205], v[204:205] op_sel_hi:[1,0,0]
    v_pk_fma_f32 v[142:143], v[142:143], v[204:205], v[204:205] op_sel_hi:[1,0,0]
    v_rcp_f32 v128, v128
    v_rcp_f32 v129, v129
    v_rcp_f32 v130, v130
    v_rcp_f32 v131, v131
    v_rcp_f32 v132, v132
    v_rcp_f32 v133, v133
    v_rcp_f32 v134, v134
    v_rcp_f32 v135, v135
    v_rcp_f32 v136, v136
    v_rcp_f32 v137, v137
    v_rcp_f32 v138, v138
    v_rcp_f32 v139, v139
    v_rcp_f32 v140, v140
    v_rcp_f32 v141, v141
    v_rcp_f32 v142, v142
    v_rcp_f32 v143, v143
    v_pk_mul_f32 v[64:65], v[64:65], v[128:129]
    v_pk_mul_f32 v[66:67], v[66:67], v[130:131]
    v_pk_mul_f32 v[68:69], v[68:69], v[132:133]
    v_pk_mul_f32 v[70:71], v[70:71], v[134:135]
    v_pk_mul_f32 v[72:73], v[72:73], v[136:137]
    v_pk_mul_f32 v[74:75], v[74:75], v[138:139]
    v_pk_mul_f32 v[76:77], v[76:77], v[140:141]
    v_pk_mul_f32 v[78:79], v[78:79], v[142:143]
    v_cvt_pk_bf16_f32 v152, v64, v65
    v_cvt_pk_bf16_f32 v153, v66, v67
    v_cvt_pk_bf16_f32 v154, v68, v69
    v_cvt_pk_bf16_f32 v155, v70, v71
    s_mov_b32 s48, 0
    buffer_store_dwordx4 v[152:155], v16, s[16:19], s48 offen offset:2048 sc1
    v_cvt_pk_bf16_f32 v156, v72, v73
    v_cvt_pk_bf16_f32 v157, v74, v75
    v_cvt_pk_bf16_f32 v158, v76, v77
    v_cvt_pk_bf16_f32 v159, v78, v79
    s_mov_b32 s48, 0
    buffer_store_dwordx4 v[156:159], v16, s[16:19], s48 offen offset:3072 sc1
    v_pk_fma_f32 v[48:49], v[194:195], v[160:161], v[48:49] op_sel_hi:[0,1,1] neg_lo:[1,0,0] neg_hi:[1,0,0]
    v_pk_fma_f32 v[50:51], v[194:195], v[162:163], v[50:51] op_sel_hi:[0,1,1] neg_lo:[1,0,0] neg_hi:[1,0,0]
    v_pk_fma_f32 v[52:53], v[194:195], v[164:165], v[52:53] op_sel_hi:[0,1,1] neg_lo:[1,0,0] neg_hi:[1,0,0]
    v_pk_fma_f32 v[54:55], v[194:195], v[166:167], v[54:55] op_sel_hi:[0,1,1] neg_lo:[1,0,0] neg_hi:[1,0,0]
    v_pk_fma_f32 v[56:57], v[194:195], v[168:169], v[56:57] op_sel_hi:[0,1,1] neg_lo:[1,0,0] neg_hi:[1,0,0]
    v_pk_fma_f32 v[58:59], v[194:195], v[170:171], v[58:59] op_sel_hi:[0,1,1] neg_lo:[1,0,0] neg_hi:[1,0,0]
    v_pk_fma_f32 v[60:61], v[194:195], v[172:173], v[60:61] op_sel_hi:[0,1,1] neg_lo:[1,0,0] neg_hi:[1,0,0]
    v_pk_fma_f32 v[62:63], v[194:195], v[174:175], v[62:63] op_sel_hi:[0,1,1] neg_lo:[1,0,0] neg_hi:[1,0,0]
    v_pk_mul_f32 v[128:129], v[48:49], v[48:49]
    v_pk_mul_f32 v[130:131], v[50:51], v[50:51]
    v_pk_mul_f32 v[132:133], v[52:53], v[52:53]
    v_pk_mul_f32 v[134:135], v[54:55], v[54:55]
    v_pk_mul_f32 v[136:137], v[56:57], v[56:57]
    v_pk_mul_f32 v[138:139], v[58:59], v[58:59]
    v_pk_mul_f32 v[140:141], v[60:61], v[60:61]
    v_pk_mul_f32 v[142:143], v[62:63], v[62:63]
    v_pk_fma_f32 v[128:129], v[128:129], v[202:203], v[198:199] op_sel_hi:[1,0,0]
    v_pk_fma_f32 v[130:131], v[130:131], v[202:203], v[198:199] op_sel_hi:[1,0,0]
    v_pk_fma_f32 v[132:133], v[132:133], v[202:203], v[198:199] op_sel_hi:[1,0,0]
    v_pk_fma_f32 v[134:135], v[134:135], v[202:203], v[198:199] op_sel_hi:[1,0,0]
    v_pk_fma_f32 v[136:137], v[136:137], v[202:203], v[198:199] op_sel_hi:[1,0,0]
    v_pk_fma_f32 v[138:139], v[138:139], v[202:203], v[198:199] op_sel_hi:[1,0,0]
    v_pk_fma_f32 v[140:141], v[140:141], v[202:203], v[198:199] op_sel_hi:[1,0,0]
    v_pk_fma_f32 v[142:143], v[142:143], v[202:203], v[198:199] op_sel_hi:[1,0,0]
    v_pk_mul_f32 v[128:129], v[128:129], v[48:49]
    v_pk_mul_f32 v[130:131], v[130:131], v[50:51]
    v_pk_mul_f32 v[132:133], v[132:133], v[52:53]
    v_pk_mul_f32 v[134:135], v[134:135], v[54:55]
    v_pk_mul_f32 v[136:137], v[136:137], v[56:57]
    v_pk_mul_f32 v[138:139], v[138:139], v[58:59]
    v_pk_mul_f32 v[140:141], v[140:141], v[60:61]
    v_pk_mul_f32 v[142:143], v[142:143], v[62:63]
    v_exp_f32 v128, v128
    v_exp_f32 v129, v129
    v_exp_f32 v130, v130
    v_exp_f32 v131, v131
    v_exp_f32 v132, v132
    v_exp_f32 v133, v133
    v_exp_f32 v134, v134
    v_exp_f32 v135, v135
    v_exp_f32 v136, v136
    v_exp_f32 v137, v137
    v_exp_f32 v138, v138
    v_exp_f32 v139, v139
    v_exp_f32 v140, v140
    v_exp_f32 v141, v141
    v_exp_f32 v142, v142
    v_exp_f32 v143, v143
    v_pk_fma_f32 v[128:129], v[128:129], v[206:207], v[206:207] op_sel_hi:[1,0,0]
    v_pk_fma_f32 v[130:131], v[130:131], v[206:207], v[206:207] op_sel_hi:[1,0,0]
    v_pk_fma_f32 v[132:133], v[132:133], v[206:207], v[206:207] op_sel_hi:[1,0,0]
    v_pk_fma_f32 v[134:135], v[134:135], v[206:207], v[206:207] op_sel_hi:[1,0,0]
    v_pk_fma_f32 v[136:137], v[136:137], v[206:207], v[206:207] op_sel_hi:[1,0,0]
    v_pk_fma_f32 v[138:139], v[138:139], v[206:207], v[206:207] op_sel_hi:[1,0,0]
    v_pk_fma_f32 v[140:141], v[140:141], v[206:207], v[206:207] op_sel_hi:[1,0,0]
    v_pk_fma_f32 v[142:143], v[142:143], v[206:207], v[206:207] op_sel_hi:[1,0,0]
    v_rcp_f32 v128, v128
    v_rcp_f32 v129, v129
    v_rcp_f32 v130, v130
    v_rcp_f32 v131, v131
    v_rcp_f32 v132, v132
    v_rcp_f32 v133, v133
    v_rcp_f32 v134, v134
    v_rcp_f32 v135, v135
    v_rcp_f32 v136, v136
    v_rcp_f32 v137, v137
    v_rcp_f32 v138, v138
    v_rcp_f32 v139, v139
    v_rcp_f32 v140, v140
    v_rcp_f32 v141, v141
    v_rcp_f32 v142, v142
    v_rcp_f32 v143, v143
    v_pk_mul_f32 v[48:49], v[48:49], v[128:129]
    v_pk_mul_f32 v[50:51], v[50:51], v[130:131]
    v_pk_mul_f32 v[52:53], v[52:53], v[132:133]
    v_pk_mul_f32 v[54:55], v[54:55], v[134:135]
    v_pk_mul_f32 v[56:57], v[56:57], v[136:137]
    v_pk_mul_f32 v[58:59], v[58:59], v[138:139]
    v_pk_mul_f32 v[60:61], v[60:61], v[140:141]
    v_pk_mul_f32 v[62:63], v[62:63], v[142:143]
    v_cvt_pk_bf16_f32 v144, v48, v49
    v_cvt_pk_bf16_f32 v145, v50, v51
    v_cvt_pk_bf16_f32 v146, v52, v53
    v_cvt_pk_bf16_f32 v147, v54, v55
    s_mov_b32 s48, 114688
    buffer_store_dwordx4 v[144:147], v16, s[16:19], s48 offen offset:0 sc1
    v_cvt_pk_bf16_f32 v148, v56, v57
    v_cvt_pk_bf16_f32 v149, v58, v59
    v_cvt_pk_bf16_f32 v150, v60, v61
    v_cvt_pk_bf16_f32 v151, v62, v63
    s_mov_b32 s48, 114688
    buffer_store_dwordx4 v[148:151], v16, s[16:19], s48 offen offset:1024 sc1
    v_pk_fma_f32 v[80:81], v[194:195], v[176:177], v[80:81] op_sel_hi:[0,1,1] neg_lo:[1,0,0] neg_hi:[1,0,0]
    v_pk_fma_f32 v[82:83], v[194:195], v[178:179], v[82:83] op_sel_hi:[0,1,1] neg_lo:[1,0,0] neg_hi:[1,0,0]
    v_pk_fma_f32 v[84:85], v[194:195], v[180:181], v[84:85] op_sel_hi:[0,1,1] neg_lo:[1,0,0] neg_hi:[1,0,0]
    v_pk_fma_f32 v[86:87], v[194:195], v[182:183], v[86:87] op_sel_hi:[0,1,1] neg_lo:[1,0,0] neg_hi:[1,0,0]
    v_pk_fma_f32 v[88:89], v[194:195], v[184:185], v[88:89] op_sel_hi:[0,1,1] neg_lo:[1,0,0] neg_hi:[1,0,0]
    v_pk_fma_f32 v[90:91], v[194:195], v[186:187], v[90:91] op_sel_hi:[0,1,1] neg_lo:[1,0,0] neg_hi:[1,0,0]
    v_pk_fma_f32 v[92:93], v[194:195], v[188:189], v[92:93] op_sel_hi:[0,1,1] neg_lo:[1,0,0] neg_hi:[1,0,0]
    v_pk_fma_f32 v[94:95], v[194:195], v[190:191], v[94:95] op_sel_hi:[0,1,1] neg_lo:[1,0,0] neg_hi:[1,0,0]
    v_pk_mul_f32 v[128:129], v[80:81], v[80:81]
    v_pk_mul_f32 v[130:131], v[82:83], v[82:83]
    v_pk_mul_f32 v[132:133], v[84:85], v[84:85]
    v_pk_mul_f32 v[134:135], v[86:87], v[86:87]
    v_pk_mul_f32 v[136:137], v[88:89], v[88:89]
    v_pk_mul_f32 v[138:139], v[90:91], v[90:91]
    v_pk_mul_f32 v[140:141], v[92:93], v[92:93]
    v_pk_mul_f32 v[142:143], v[94:95], v[94:95]
    v_pk_fma_f32 v[128:129], v[128:129], v[202:203], v[198:199] op_sel_hi:[1,0,0]
    v_pk_fma_f32 v[130:131], v[130:131], v[202:203], v[198:199] op_sel_hi:[1,0,0]
    v_pk_fma_f32 v[132:133], v[132:133], v[202:203], v[198:199] op_sel_hi:[1,0,0]
    v_pk_fma_f32 v[134:135], v[134:135], v[202:203], v[198:199] op_sel_hi:[1,0,0]
    v_pk_fma_f32 v[136:137], v[136:137], v[202:203], v[198:199] op_sel_hi:[1,0,0]
    v_pk_fma_f32 v[138:139], v[138:139], v[202:203], v[198:199] op_sel_hi:[1,0,0]
    v_pk_fma_f32 v[140:141], v[140:141], v[202:203], v[198:199] op_sel_hi:[1,0,0]
    v_pk_fma_f32 v[142:143], v[142:143], v[202:203], v[198:199] op_sel_hi:[1,0,0]
    v_pk_mul_f32 v[128:129], v[128:129], v[80:81]
    v_pk_mul_f32 v[130:131], v[130:131], v[82:83]
    v_pk_mul_f32 v[132:133], v[132:133], v[84:85]
    v_pk_mul_f32 v[134:135], v[134:135], v[86:87]
    v_pk_mul_f32 v[136:137], v[136:137], v[88:89]
    v_pk_mul_f32 v[138:139], v[138:139], v[90:91]
    v_pk_mul_f32 v[140:141], v[140:141], v[92:93]
    v_pk_mul_f32 v[142:143], v[142:143], v[94:95]
    v_exp_f32 v128, v128
    v_exp_f32 v129, v129
    v_exp_f32 v130, v130
    v_exp_f32 v131, v131
    v_exp_f32 v132, v132
    v_exp_f32 v133, v133
    v_exp_f32 v134, v134
    v_exp_f32 v135, v135
    v_exp_f32 v136, v136
    v_exp_f32 v137, v137
    v_exp_f32 v138, v138
    v_exp_f32 v139, v139
    v_exp_f32 v140, v140
    v_exp_f32 v141, v141
    v_exp_f32 v142, v142
    v_exp_f32 v143, v143
    v_pk_fma_f32 v[128:129], v[128:129], v[206:207], v[206:207] op_sel_hi:[1,0,0]
    v_pk_fma_f32 v[130:131], v[130:131], v[206:207], v[206:207] op_sel_hi:[1,0,0]
    v_pk_fma_f32 v[132:133], v[132:133], v[206:207], v[206:207] op_sel_hi:[1,0,0]
    v_pk_fma_f32 v[134:135], v[134:135], v[206:207], v[206:207] op_sel_hi:[1,0,0]
    v_pk_fma_f32 v[136:137], v[136:137], v[206:207], v[206:207] op_sel_hi:[1,0,0]
    v_pk_fma_f32 v[138:139], v[138:139], v[206:207], v[206:207] op_sel_hi:[1,0,0]
    v_pk_fma_f32 v[140:141], v[140:141], v[206:207], v[206:207] op_sel_hi:[1,0,0]
    v_pk_fma_f32 v[142:143], v[142:143], v[206:207], v[206:207] op_sel_hi:[1,0,0]
    v_rcp_f32 v128, v128
    v_rcp_f32 v129, v129
    v_rcp_f32 v130, v130
    v_rcp_f32 v131, v131
    v_rcp_f32 v132, v132
    v_rcp_f32 v133, v133
    v_rcp_f32 v134, v134
    v_rcp_f32 v135, v135
    v_rcp_f32 v136, v136
    v_rcp_f32 v137, v137
    v_rcp_f32 v138, v138
    v_rcp_f32 v139, v139
    v_rcp_f32 v140, v140
    v_rcp_f32 v141, v141
    v_rcp_f32 v142, v142
    v_rcp_f32 v143, v143
    v_pk_mul_f32 v[80:81], v[80:81], v[128:129]
    v_pk_mul_f32 v[82:83], v[82:83], v[130:131]
    v_pk_mul_f32 v[84:85], v[84:85], v[132:133]
    v_pk_mul_f32 v[86:87], v[86:87], v[134:135]
    v_pk_mul_f32 v[88:89], v[88:89], v[136:137]
    v_pk_mul_f32 v[90:91], v[90:91], v[138:139]
    v_pk_mul_f32 v[92:93], v[92:93], v[140:141]
    v_pk_mul_f32 v[94:95], v[94:95], v[142:143]
    v_cvt_pk_bf16_f32 v152, v80, v81
    v_cvt_pk_bf16_f32 v153, v82, v83
    v_cvt_pk_bf16_f32 v154, v84, v85
    v_cvt_pk_bf16_f32 v155, v86, v87
    s_mov_b32 s48, 114688
    buffer_store_dwordx4 v[152:155], v16, s[16:19], s48 offen offset:2048 sc1
    v_cvt_pk_bf16_f32 v156, v88, v89
    v_cvt_pk_bf16_f32 v157, v90, v91
    v_cvt_pk_bf16_f32 v158, v92, v93
    v_cvt_pk_bf16_f32 v159, v94, v95
    s_mov_b32 s48, 114688
    buffer_store_dwordx4 v[156:159], v16, s[16:19], s48 offen offset:3072 sc1
    s_lshr_b32 s64, s38, 3
    s_lshr_b32 s48, s39, 7
    s_add_u32 s64, s64, s48
    s_add_u32 s64, s64, 1600
    s_lshl_b32 s64, s64, 7
    s_load_dwordx2 s[44:45], s[0:1], 72
    s_load_dwordx2 s[52:53], s[0:1], 96
    s_and_b32 s48, s2, 7
    s_lshr_b32 s49, s2, 3
    s_lshl_b32 s48, s48, 2
    s_lshr_b32 s50, s49, 3
    s_add_u32 s48, s48, s50
    s_lshl_b32 s38, s48, 6
    s_and_b32 s49, s49, 7
    s_lshl_b32 s39, s49, 6
    s_waitcnt lgkmcnt(0)
    s_add_u32 s8, s44, 0
    s_addc_u32 s9, s45, 0
    s_mov_b32 s10, 1835008
    s_mov_b32 s11, 0x00020000
    s_add_u32 s12, s46, 50331648
    s_addc_u32 s13, s47, 0
    s_mov_b32 s14, 7340032
    s_mov_b32 s15, 0x00020000
    s_add_u32 s16, s52, 0
    s_addc_u32 s17, s53, 0
    s_mov_b32 s18, 2097152
    s_mov_b32 s19, 0x00020000
    s_add_u32 s20, s46, 46137344
    s_addc_u32 s21, s47, 0
    s_mov_b32 s22, 2097152
    s_mov_b32 s23, 0x00020000
    s_add_u32 s24, s46, 37748736
    s_addc_u32 s25, s47, 0
    s_mov_b32 s26, 2097152
    s_mov_b32 s27, 0x00020000
    s_add_u32 s28, s46, 6144
    s_addc_u32 s29, s47, 0
    s_mov_b32 s30, 2048
    s_mov_b32 s31, 0x00020000
    s_lshl_b32 s37, s32, 12
    v_lshrrev_b32 v16, 3, v1
    v_and_b32 v17, 7, v1
    v_lshrrev_b32 v18, 1, v16
    v_and_b32 v18, 1, v18
    v_lshlrev_b32 v18, 2, v18
    v_xor_b32 v18, v18, v17
    v_lshlrev_b32 v18, 4, v18
    s_mov_b32 s41, 1024
    v_mul_lo_u32 v19, v16, s41
    v_add_u32 v18, v18, v19
    s_mul_i32 s41, s32, 32768
    v_add_u32 v18, s41, v18
    v_add_u32 v2, 0, v18
    v_add_u32 v3, 7168, v18
    v_add_u32 v4, 14336, v18
    v_add_u32 v5, 21504, v18
    s_lshr_b32 s41, s32, 1
    s_mul_i32 s41, s41, 114688
    s_and_b32 s42, s32, 1
    s_lshl_b32 s42, s42, 12
    s_add_u32 s41, s41, s42
    v_lshlrev_b32 v16, 4, v1
    v_add_u32 v6, s41, v16
    v_and_b32 v16, 15, v1
    v_lshrrev_b32 v16, 2, v16
    v_and_b32 v17, 3, v1
    v_lshrrev_b32 v18, 4, v1
    v_and_b32 v18, 1, v18
    v_lshrrev_b32 v19, 5, v1
    v_and_b32 v20, 1, v17
    v_lshl_add_u32 v20, v18, 1, v20
    v_lshlrev_b32 v20, 4, v20
    v_lshrrev_b32 v17, 1, v17
    v_lshl_add_u32 v20, v17, 3, v20
    v_lshl_add_u32 v20, v16, 7, v20
    v_lshl_add_u32 v20, v19, 10, v20
    v_lshrrev_b32 v16, 1, v16
    s_mul_i32 s41, s34, 1
    s_add_u32 s41, s41, 0
    v_xor_b32 v21, s41, v16
    v_lshl_add_u32 v10, v21, 6, v20
    v_add_u32 v12, 65536, v10
    s_mul_i32 s41, s33, 8192
    s_add_u32 s41, s41, 16384
    v_lshlrev_b32 v16, 4, v1
    v_add_u32 v14, s41, v16
    v_add_u32 v15, 65536, v14
    s_lshl_b32 s35, s39, 1
    s_lshr_b32 s48, s38, 5
    s_mul_i32 s36, s48, 114688
    s_lshr_b32 s48, s39, 4
    s_add_u32 s48, s48, s32
    s_and_b32 s49, s48, 1
    s_lshr_b32 s48, s48, 1
    s_lshr_b32 s50, s48, 3
    s_and_b32 s48, s48, 7
    s_mul_i32 s50, s50, 114688
    s_lshl_b32 s48, s48, 10
    s_add_u32 s48, s48, s50
    s_lshl_b32 s49, s49, 9
    s_add_u32 s48, s48, s49
    v_and_b32 v27, 3, v1
    v_lshlrev_b32 v27, 7, v27
    v_add_u32 v27, s48, v27
    s_lshr_b32 s48, s38, 5
    s_mul_i32 s49, s33, 1
    s_add_u32 s48, s48, s49
    s_mul_i32 s48, s48, 32
    s_lshr_b32 s49, s39, 4
    s_add_u32 s48, s48, s49
    s_mul_i32 s49, s34, 2
    s_add_u32 s48, s48, s49
    s_lshl_b32 s48, s48, 10
    v_lshlrev_b32 v16, 4, v1
    v_add_u32 v16, s48, v16
    v_and_b32 v17, 31, v1
    s_lshl_b32 s48, s33, 5
    s_add_u32 s48, s48, s38
    v_add_u32 v17, s48, v17
    v_lshlrev_b32 v17, 10, v17
    v_lshrrev_b32 v18, 5, v1
    v_lshlrev_b32 v18, 3, v18
    s_lshl_b32 s48, s34, 5
    s_add_u32 s48, s48, s39
    v_add_u32 v18, s48, v18
    v_lshl_add_u32 v17, v18, 1, v17
    v_lshlrev_b32 v18, 2, v18
    s_waitcnt vmcnt(0)
    s_barrier
    s_cmp_lg_u32 s32, 0
    s_cbranch_scc1 L_sig13
    v_mov_b32 v216, 0
    v_mov_b32 v217, s100
    s_mov_b64 exec, 1
    buffer_store_dword v217, v216, s[68:71], s64 offen sc1
    s_mov_b64 exec, -1
L_sig13:
    s_branch L_tail_t4b
L_tail_skip:
    s_load_dwordx2 s[44:45], s[0:1], 72
    s_load_dwordx2 s[52:53], s[0:1], 96
    s_and_b32 s48, s2, 7
    s_lshr_b32 s49, s2, 3
    s_lshl_b32 s48, s48, 2
    s_lshr_b32 s50, s49, 3
    s_add_u32 s48, s48, s50
    s_lshl_b32 s38, s48, 6
    s_and_b32 s49, s49, 7
    s_lshl_b32 s39, s49, 6
    s_waitcnt lgkmcnt(0)
    s_add_u32 s8, s44, 0
    s_addc_u32 s9, s45, 0
    s_mov_b32 s10, 1835008
    s_mov_b32 s11, 0x00020000
    s_add_u32 s12, s46, 50331648
    s_addc_u32 s13, s47, 0
    s_mov_b32 s14, 7340032
    s_mov_b32 s15, 0x00020000
    s_add_u32 s16, s52, 0
    s_addc_u32 s17, s53, 0
    s_mov_b32 s18, 2097152
    s_mov_b32 s19, 0x00020000
    s_add_u32 s20, s46, 46137344
    s_addc_u32 s21, s47, 0
    s_mov_b32 s22, 2097152
    s_mov_b32 s23, 0x00020000
    s_add_u32 s24, s46, 37748736
    s_addc_u32 s25, s47, 0
    s_mov_b32 s26, 2097152
    s_mov_b32 s27, 0x00020000
    s_add_u32 s28, s46, 6144
    s_addc_u32 s29, s47, 0
    s_mov_b32 s30, 2048
    s_mov_b32 s31, 0x00020000
    s_lshl_b32 s37, s32, 12
    v_lshrrev_b32 v16, 3, v1
    v_and_b32 v17, 7, v1
    v_lshrrev_b32 v18, 1, v16
    v_and_b32 v18, 1, v18
    v_lshlrev_b32 v18, 2, v18
    v_xor_b32 v18, v18, v17
    v_lshlrev_b32 v18, 4, v18
    s_mov_b32 s41, 1024
    v_mul_lo_u32 v19, v16, s41
    v_add_u32 v18, v18, v19
    s_mul_i32 s41, s32, 32768
    v_add_u32 v18, s41, v18
    v_add_u32 v2, 0, v18
    v_add_u32 v3, 7168, v18
    v_add_u32 v4, 14336, v18
    v_add_u32 v5, 21504, v18
    s_lshr_b32 s41, s32, 1
    s_mul_i32 s41, s41, 114688
    s_and_b32 s42, s32, 1
    s_lshl_b32 s42, s42, 12
    s_add_u32 s41, s41, s42
    v_lshlrev_b32 v16, 4, v1
    v_add_u32 v6, s41, v16
    v_and_b32 v16, 15, v1
    v_lshrrev_b32 v16, 2, v16
    v_and_b32 v17, 3, v1
    v_lshrrev_b32 v18, 4, v1
    v_and_b32 v18, 1, v18
    v_lshrrev_b32 v19, 5, v1
    v_and_b32 v20, 1, v17
    v_lshl_add_u32 v20, v18, 1, v20
    v_lshlrev_b32 v20, 4, v20
    v_lshrrev_b32 v17, 1, v17
    v_lshl_add_u32 v20, v17, 3, v20
    v_lshl_add_u32 v20, v16, 7, v20
    v_lshl_add_u32 v20, v19, 10, v20
    v_lshrrev_b32 v16, 1, v16
    s_mul_i32 s41, s34, 1
    s_add_u32 s41, s41, 0
    v_xor_b32 v21, s41, v16
    v_lshl_add_u32 v10, v21, 6, v20
    v_add_u32 v12, 65536, v10
    s_mul_i32 s41, s33, 8192
    s_add_u32 s41, s41, 16384
    v_lshlrev_b32 v16, 4, v1
    v_add_u32 v14, s41, v16
    v_add_u32 v15, 65536, v14
    s_lshl_b32 s35, s39, 1
    s_lshr_b32 s48, s38, 5
    s_mul_i32 s36, s48, 114688
    s_lshr_b32 s48, s39, 4
    s_add_u32 s48, s48, s32
    s_and_b32 s49, s48, 1
    s_lshr_b32 s48, s48, 1
    s_lshr_b32 s50, s48, 3
    s_and_b32 s48, s48, 7
    s_mul_i32 s50, s50, 114688
    s_lshl_b32 s48, s48, 10
    s_add_u32 s48, s48, s50
    s_lshl_b32 s49, s49, 9
    s_add_u32 s48, s48, s49
    v_and_b32 v27, 3, v1
    v_lshlrev_b32 v27, 7, v27
    v_add_u32 v27, s48, v27
    s_lshr_b32 s48, s38, 5
    s_mul_i32 s49, s33, 1
    s_add_u32 s48, s48, s49
    s_mul_i32 s48, s48, 32
    s_lshr_b32 s49, s39, 4
    s_add_u32 s48, s48, s49
    s_mul_i32 s49, s34, 2
    s_add_u32 s48, s48, s49
    s_lshl_b32 s48, s48, 10
    v_lshlrev_b32 v16, 4, v1
    v_add_u32 v16, s48, v16
    v_and_b32 v17, 31, v1
    s_lshl_b32 s48, s33, 5
    s_add_u32 s48, s48, s38
    v_add_u32 v17, s48, v17
    v_lshlrev_b32 v17, 10, v17
    v_lshrrev_b32 v18, 5, v1
    v_lshlrev_b32 v18, 3, v18
    s_lshl_b32 s48, s34, 5
    s_add_u32 s48, s48, s39
    v_add_u32 v18, s48, v18
    v_lshl_add_u32 v17, v18, 1, v17
    v_lshlrev_b32 v18, 2, v18
    s_waitcnt vmcnt(0)
    s_barrier
    s_cmp_lg_u32 s32, 0
    s_cbranch_scc1 L_sig14
    v_mov_b32 v216, 0
    v_mov_b32 v217, s100
    s_mov_b64 exec, 1
    buffer_store_dword v217, v216, s[68:71], s64 offen sc1
    s_mov_b64 exec, -1
L_sig14:
    s_lshr_b32 s48, s2, 3
    s_sub_u32 s48, s48, 28
    s_lshl_b32 s48, s48, 2
    s_add_u32 s48, s48, s32
    s_mul_i32 s48, s48, 114688
    v_lshlrev_b32 v220, 7, v1
    buffer_load_dword v221, v220, s[8:11], s48 offen
    s_add_u32 s48, s48, 8192
    buffer_load_dword v221, v220, s[8:11], s48 offen
    s_add_u32 s48, s48, 8192
    buffer_load_dword v221, v220, s[8:11], s48 offen
    s_add_u32 s48, s48, 8192
    buffer_load_dword v221, v220, s[8:11], s48 offen
    s_add_u32 s48, s48, 8192
    buffer_load_dword v221, v220, s[8:11], s48 offen
    s_add_u32 s48, s48, 8192
    buffer_load_dword v221, v220, s[8:11], s48 offen
    s_add_u32 s48, s48, 8192
    buffer_load_dword v221, v220, s[8:11], s48 offen
    s_add_u32 s48, s48, 8192
    buffer_load_dword v221, v220, s[8:11], s48 offen
    s_add_u32 s48, s48, 8192
    buffer_load_dword v221, v220, s[8:11], s48 offen
    s_add_u32 s48, s48, 8192
    buffer_load_dword v221, v220, s[8:11], s48 offen
    s_add_u32 s48, s48, 8192
    buffer_load_dword v221, v220, s[8:11], s48 offen
    s_add_u32 s48, s48, 8192
    buffer_load_dword v221, v220, s[8:11], s48 offen
    s_add_u32 s48, s48, 8192
    buffer_load_dword v221, v220, s[8:11], s48 offen
    s_add_u32 s48, s48, 8192
    buffer_load_dword v221, v220, s[8:11], s48 offen
    s_add_u32 s48, s48, 8192
L_tail_t4b:
    s_lshr_b32 s65, s38, 7
    s_lshl_b32 s65, s65, 4
    s_add_u32 s65, s65, 1600
    s_lshl_b32 s65, s65, 7
    s_cmp_eq_u32 s32, 1
    s_cbranch_scc1 L_wp15
    s_add_u32 m0, s37, 0
    s_nop 0
    buffer_load_dwordx4 v2, s[8:11], s35 offen offset:0 lds
    buffer_load_dwordx4 v3, s[8:11], s35 offen offset:1024 lds
    buffer_load_dwordx4 v4, s[8:11], s35 offen offset:2048 lds
    buffer_load_dwordx4 v5, s[8:11], s35 offen offset:3072 lds
    s_add_u32 s35, s35, 131072
    s_add_u32 m0, s37, 32768
    s_nop 0
    buffer_load_dwordx4 v2, s[8:11], s35 offen offset:0 lds
    buffer_load_dwordx4 v3, s[8:11], s35 offen offset:1024 lds
    buffer_load_dwordx4 v4, s[8:11], s35 offen offset:2048 lds
    buffer_load_dwordx4 v5, s[8:11], s35 offen offset:3072 lds
    s_add_u32 s35, s35, 131072
    s_add_u32 m0, s37, 65536
    s_nop 0
    buffer_load_dwordx4 v2, s[8:11], s35 offen offset:0 lds
    buffer_load_dwordx4 v3, s[8:11], s35 offen offset:1024 lds
    buffer_load_dwordx4 v4, s[8:11], s35 offen offset:2048 lds
    buffer_load_dwordx4 v5, s[8:11], s35 offen offset:3072 lds
    s_add_u32 s35, s35, 131072
    s_add_u32 m0, s37, 98304
    s_nop 0
    buffer_load_dwordx4 v2, s[8:11], s35 offen offset:0 lds
    buffer_load_dwordx4 v3, s[8:11], s35 offen offset:1024 lds
    buffer_load_dwordx4 v4, s[8:11], s35 offen offset:2048 lds
    buffer_load_dwordx4 v5, s[8:11], s35 offen offset:3072 lds
    s_add_u32 s35, s35, 131072
    buffer_load_dwordx4 v[192:195], v18, s[28:31], 0 offen offset:0 sc1
    buffer_load_dwordx4 v[196:199], v18, s[28:31], 0 offen offset:16 sc1
    buffer_load_dwordx4 v[200:203], v18, s[28:31], 0 offen offset:64 sc1
    buffer_load_dwordx4 v[204:207], v18, s[28:31], 0 offen offset:80 sc1
    s_cmp_lg_u32 s2, 0
    s_cbranch_scc1 L_gen_done
    s_cmp_lg_u32 s32, 2
    s_cbranch_scc1 L_gen_done
    s_mov_b32 s62, 524288
    v_lshlrev_b32 v216, 7, v1
L_gen_poll:
    s_mov_b32 s61, 40960
    buffer_load_dword v217, v216, s[68:71], s61 offen sc1
    s_mov_b32 s61, 49152
    buffer_load_dword v218, v216, s[68:71], s61 offen sc1
    s_mov_b32 s61, 57344
    buffer_load_dword v219, v216, s[68:71], s61 offen sc1
    s_mov_b32 s61, 65536
    buffer_load_dword v220, v216, s[68:71], s61 offen sc1
    s_waitcnt vmcnt(0)
    v_cmp_ne_u32 vcc, s100, v217
    v_cmp_ne_u32 s[60:61], s100, v218
    s_nop 1
    s_or_b64 vcc, vcc, s[60:61]
    v_cmp_ne_u32 s[60:61], s100, v219
    s_nop 1
    s_or_b64 vcc, vcc, s[60:61]
    v_cmp_ne_u32 s[60:61], s100, v220
    s_nop 1
    s_or_b64 vcc, vcc, s[60:61]
    s_cbranch_vccz L_gen_go
    s_sleep 4
    s_sub_u32 s62, s62, 1
    s_cmp_lg_u32 s62, 0
    s_cbranch_scc1 L_gen_poll
L_gen_go:
    s_add_u32 s72, s46, 49520640
    s_addc_u32 s73, s47, 0
    s_mov_b32 s74, 4
    s_mov_b32 s75, 0x00020000
    v_mov_b32 v216, 0
    v_mov_b32 v217, s100
    s_mov_b64 exec, 1
    buffer_store_dword v217, v216, s[72:75], 0 offen
    s_mov_b64 exec, -1
L_gen_done:
    s_branch L_wdone15
L_wp15:
    s_mov_b32 s62, 524288
    v_min_u32 v216, 13, v1
    v_lshlrev_b32 v216, 7, v216
L_fp12:
    buffer_load_dword v217, v216, s[68:71], s65 offen sc1
    s_waitcnt vmcnt(0)
    v_cmp_ne_u32 vcc, s100, v217
    s_cbranch_vccz L_wgo15
    s_sleep 1
    s_sub_u32 s62, s62, 1
    s_cmp_lg_u32 s62, 0
    s_cbranch_scc1 L_fp12
L_wgo15:
    s_add_u32 m0, s37, 0
    s_nop 0
    buffer_load_dwordx4 v2, s[8:11], s35 offen offset:0 lds
    buffer_load_dwordx4 v3, s[8:11], s35 offen offset:1024 lds
    buffer_load_dwordx4 v4, s[8:11], s35 offen offset:2048 lds
    buffer_load_dwordx4 v5, s[8:11], s35 offen offset:3072 lds
    s_add_u32 s35, s35, 131072
    s_add_u32 m0, s37, 32768
    s_nop 0
    buffer_load_dwordx4 v2, s[8:11], s35 offen offset:0 lds
    buffer_load_dwordx4 v3, s[8:11], s35 offen offset:1024 lds
    buffer_load_dwordx4 v4, s[8:11], s35 offen offset:2048 lds
    buffer_load_dwordx4 v5, s[8:11], s35 offen offset:3072 lds
    s_add_u32 s35, s35, 131072
    s_add_u32 m0, s37, 65536
    s_nop 0
    buffer_load_dwordx4 v2, s[8:11], s35 offen offset:0 lds
    buffer_load_dwordx4 v3, s[8:11], s35 offen offset:1024 lds
    buffer_load_dwordx4 v4, s[8:11], s35 offen offset:2048 lds
    buffer_load_dwordx4 v5, s[8:11], s35 offen offset:3072 lds
    s_add_u32 s35, s35, 131072
    s_add_u32 m0, s37, 98304
    s_nop 0
    buffer_load_dwordx4 v2, s[8:11], s35 offen offset:0 lds
    buffer_load_dwordx4 v3, s[8:11], s35 offen offset:1024 lds
    buffer_load_dwordx4 v4, s[8:11], s35 offen offset:2048 lds
    buffer_load_dwordx4 v5, s[8:11], s35 offen offset:3072 lds
    s_add_u32 s35, s35, 131072
    buffer_load_dwordx4 v[192:195], v18, s[28:31], 0 offen offset:0 sc1
    buffer_load_dwordx4 v[196:199], v18, s[28:31], 0 offen offset:16 sc1
    buffer_load_dwordx4 v[200:203], v18, s[28:31], 0 offen offset:64 sc1
    buffer_load_dwordx4 v[204:207], v18, s[28:31], 0 offen offset:80 sc1
L_wdone15:
    s_barrier
    s_add_u32 m0, s37, 16384
    s_nop 0
    buffer_load_dwordx4 v6, s[12:15], s36 offen offset:0 sc1 lds
    buffer_load_dwordx4 v6, s[12:15], s36 offen offset:1024 sc1 lds
    buffer_load_dwordx4 v6, s[12:15], s36 offen offset:2048 sc1 lds
    buffer_load_dwordx4 v6, s[12:15], s36 offen offset:3072 sc1 lds
    s_add_u32 s36, s36, 8192
    s_add_u32 m0, s37, 49152
    s_nop 0
    buffer_load_dwordx4 v6, s[12:15], s36 offen offset:0 sc1 lds
    buffer_load_dwordx4 v6, s[12:15], s36 offen offset:1024 sc1 lds
    buffer_load_dwordx4 v6, s[12:15], s36 offen offset:2048 sc1 lds
    buffer_load_dwordx4 v6, s[12:15], s36 offen offset:3072 sc1 lds
    s_add_u32 s36, s36, 8192
    s_add_u32 m0, s37, 81920
    s_nop 0
    buffer_load_dwordx4 v6, s[12:15], s36 offen offset:0 sc1 lds
    buffer_load_dwordx4 v6, s[12:15], s36 offen offset:1024 sc1 lds
    buffer_load_dwordx4 v6, s[12:15], s36 offen offset:2048 sc1 lds
    buffer_load_dwordx4 v6, s[12:15], s36 offen offset:3072 sc1 lds
    s_add_u32 s36, s36, 8192
    s_add_u32 m0, s37, 114688
    s_nop 0
    buffer_load_dwordx4 v6, s[12:15], s36 offen offset:0 sc1 lds
    buffer_load_dwordx4 v6, s[12:15], s36 offen offset:1024 sc1 lds
    buffer_load_dwordx4 v6, s[12:15], s36 offen offset:2048 sc1 lds
    buffer_load_dwordx4 v6, s[12:15], s36 offen offset:3072 sc1 lds
    s_add_u32 s36, s36, 8192
    s_mov_b32 s63, s36
    buffer_load_dword v223, v27, s[12:15], s63 offen sc1
    s_add_u32 s63, s63, 8192
    buffer_load_dword v223, v27, s[12:15], s63 offen sc1
    s_add_u32 s63, s63, 8192
    s_waitcnt vmcnt(14)
    s_barrier
    ds_read_b128 a[64:67], v14 offset:0
    ds_read_b64_tr_b16 a[0:1], v10 offset:0
    ds_read_b64_tr_b16 a[2:3], v10 offset:512
    ds_read_b128 a[68:71], v14 offset:1024
    ds_read_b64_tr_b16 a[4:5], v10 offset:2048
    ds_read_b64_tr_b16 a[6:7], v10 offset:2560
    ds_read_b128 a[72:75], v14 offset:2048
    ds_read_b64_tr_b16 a[8:9], v10 offset:4096
    ds_read_b64_tr_b16 a[10:11], v10 offset:4608
    ds_read_b128 a[76:79], v14 offset:3072
    ds_read_b64_tr_b16 a[12:13], v10 offset:6144
    ds_read_b64_tr_b16 a[14:15], v10 offset:6656
    ds_read_b128 a[80:83], v14 offset:4096
    ds_read_b64_tr_b16 a[16:17], v10 offset:8192
    ds_read_b64_tr_b16 a[18:19], v10 offset:8704
    ds_read_b128 a[84:87], v14 offset:5120
    ds_read_b64_tr_b16 a[20:21], v10 offset:10240
    ds_read_b64_tr_b16 a[22:23], v10 offset:10752
    ds_read_b128 a[88:91], v14 offset:6144
    ds_read_b64_tr_b16 a[24:25], v10 offset:12288
    ds_read_b64_tr_b16 a[26:27], v10 offset:12800
    ds_read_b128 a[92:95], v14 offset:7168
    ds_read_b64_tr_b16 a[28:29], v10 offset:14336
    ds_read_b64_tr_b16 a[30:31], v10 offset:14848
    s_waitcnt lgkmcnt(0)
    s_waitcnt vmcnt(10)
    s_barrier
    v_mfma_f32_32x32x16_bf16 v[32:47], a[0:3], a[64:67], 0
    ds_read_b128 a[96:99], v14 offset:32768
    s_add_u32 m0, s37, 0
    ds_read_b64_tr_b16 a[32:33], v10 offset:32768
    buffer_load_dwordx4 v2, s[8:11], s35 offen offset:0 lds
    ds_read_b64_tr_b16 a[34:35], v10 offset:33280
    ds_read_b128 a[100:103], v14 offset:33792
    buffer_load_dwordx4 v3, s[8:11], s35 offen offset:1024 lds
    v_mfma_f32_32x32x16_bf16 v[32:47], a[4:7], a[68:71], v[32:47]
    ds_read_b64_tr_b16 a[36:37], v10 offset:34816
    ds_read_b64_tr_b16 a[38:39], v10 offset:35328
    buffer_load_dwordx4 v4, s[8:11], s35 offen offset:2048 lds
    ds_read_b128 a[104:107], v14 offset:34816
    buffer_load_dwordx4 v5, s[8:11], s35 offen offset:3072 lds
    ds_read_b64_tr_b16 a[40:41], v10 offset:36864
    v_mfma_f32_32x32x16_bf16 v[32:47], a[8:11], a[72:75], v[32:47]
    ds_read_b64_tr_b16 a[42:43], v10 offset:37376
    s_add_u32 s35, s35, 131072
    ds_read_b128 a[108:111], v14 offset:35840
    ds_read_b64_tr_b16 a[44:45], v10 offset:38912
    s_add_u32 m0, s37, 16384
    ds_read_b64_tr_b16 a[46:47], v10 offset:39424
    v_mfma_f32_32x32x16_bf16 v[32:47], a[12:15], a[76:79], v[32:47]
    ds_read_b128 a[112:115], v14 offset:36864
    buffer_load_dwordx4 v6, s[12:15], s36 offen offset:0 sc1 lds
    ds_read_b64_tr_b16 a[48:49], v10 offset:40960
    buffer_load_dwordx4 v6, s[12:15], s36 offen offset:1024 sc1 lds
    ds_read_b64_tr_b16 a[50:51], v10 offset:41472
    ds_read_b128 a[116:119], v14 offset:37888
    buffer_load_dwordx4 v6, s[12:15], s36 offen offset:2048 sc1 lds
    v_mfma_f32_32x32x16_bf16 v[32:47], a[16:19], a[80:83], v[32:47]
    ds_read_b64_tr_b16 a[52:53], v10 offset:43008
    ds_read_b64_tr_b16 a[54:55], v10 offset:43520
    buffer_load_dwordx4 v6, s[12:15], s36 offen offset:3072 sc1 lds
    ds_read_b128 a[120:123], v14 offset:38912
    s_add_u32 s36, s36, 8192
    ds_read_b64_tr_b16 a[56:57], v10 offset:45056
    v_mfma_f32_32x32x16_bf16 v[32:47], a[20:23], a[84:87], v[32:47]
    ds_read_b64_tr_b16 a[58:59], v10 offset:45568
    buffer_load_dword v223, v27, s[12:15], s63 offen sc1
    ds_read_b128 a[124:127], v14 offset:39936
    ds_read_b64_tr_b16 a[60:61], v10 offset:47104
    s_add_u32 s63, s63, 8192
    ds_read_b64_tr_b16 a[62:63], v10 offset:47616
    v_mfma_f32_32x32x16_bf16 v[32:47], a[24:27], a[88:91], v[32:47]
    v_mfma_f32_32x32x16_bf16 v[32:47], a[28:31], a[92:95], v[32:47]
    s_waitcnt lgkmcnt(0)
    s_waitcnt vmcnt(15)
    s_barrier
    v_mfma_f32_32x32x16_bf16 v[32:47], a[32:35], a[96:99], v[32:47]
    ds_read_b128 a[64:67], v15 offset:0
    s_add_u32 m0, s37, 32768
    ds_read_b64_tr_b16 a[0:1], v12 offset:0
    buffer_load_dwordx4 v2, s[8:11], s35 offen offset:0 lds
    ds_read_b64_tr_b16 a[2:3], v12 offset:512
    ds_read_b128 a[68:71], v15 offset:1024
    buffer_load_dwordx4 v3, s[8:11], s35 offen offset:1024 lds
    v_mfma_f32_32x32x16_bf16 v[32:47], a[36:39], a[100:103], v[32:47]
    ds_read_b64_tr_b16 a[4:5], v12 offset:2048
    ds_read_b64_tr_b16 a[6:7], v12 offset:2560
    buffer_load_dwordx4 v4, s[8:11], s35 offen offset:2048 lds
    ds_read_b128 a[72:75], v15 offset:2048
    buffer_load_dwordx4 v5, s[8:11], s35 offen offset:3072 lds
    ds_read_b64_tr_b16 a[8:9], v12 offset:4096
    v_mfma_f32_32x32x16_bf16 v[32:47], a[40:43], a[104:107], v[32:47]
    ds_read_b64_tr_b16 a[10:11], v12 offset:4608
    s_add_u32 s35, s35, 131072
    ds_read_b128 a[76:79], v15 offset:3072
    ds_read_b64_tr_b16 a[12:13], v12 offset:6144
    s_add_u32 m0, s37, 49152
    ds_read_b64_tr_b16 a[14:15], v12 offset:6656
    v_mfma_f32_32x32x16_bf16 v[32:47], a[44:47], a[108:111], v[32:47]
    ds_read_b128 a[80:83], v15 offset:4096
    buffer_load_dwordx4 v6, s[12:15], s36 offen offset:0 sc1 lds
    ds_read_b64_tr_b16 a[16:17], v12 offset:8192
    buffer_load_dwordx4 v6, s[12:15], s36 offen offset:1024 sc1 lds
    ds_read_b64_tr_b16 a[18:19], v12 offset:8704
    ds_read_b128 a[84:87], v15 offset:5120
    buffer_load_dwordx4 v6, s[12:15], s36 offen offset:2048 sc1 lds
    v_mfma_f32_32x32x16_bf16 v[32:47], a[48:51], a[112:115], v[32:47]
    ds_read_b64_tr_b16 a[20:21], v12 offset:10240
    ds_read_b64_tr_b16 a[22:23], v12 offset:10752
    buffer_load_dwordx4 v6, s[12:15], s36 offen offset:3072 sc1 lds
    ds_read_b128 a[88:91], v15 offset:6144
    s_add_u32 s36, s36, 8192
    ds_read_b64_tr_b16 a[24:25], v12 offset:12288
    v_mfma_f32_32x32x16_bf16 v[32:47], a[52:55], a[116:119], v[32:47]
    ds_read_b64_tr_b16 a[26:27], v12 offset:12800
    buffer_load_dword v223, v27, s[12:15], s63 offen sc1
    ds_read_b128 a[92:95], v15 offset:7168
    ds_read_b64_tr_b16 a[28:29], v12 offset:14336
    s_add_u32 s63, s63, 8192
    ds_read_b64_tr_b16 a[30:31], v12 offset:14848
    v_mfma_f32_32x32x16_bf16 v[32:47], a[56:59], a[120:123], v[32:47]
    v_mfma_f32_32x32x16_bf16 v[32:47], a[60:63], a[124:127], v[32:47]
    s_waitcnt lgkmcnt(0)
    s_waitcnt vmcnt(20)
    s_barrier
    v_mfma_f32_32x32x16_bf16 v[32:47], a[0:3], a[64:67], v[32:47]
    ds_read_b128 a[96:99], v15 offset:32768
    s_add_u32 m0, s37, 65536
    ds_read_b64_tr_b16 a[32:33], v12 offset:32768
    buffer_load_dwordx4 v2, s[8:11], s35 offen offset:0 lds
    ds_read_b64_tr_b16 a[34:35], v12 offset:33280
    ds_read_b128 a[100:103], v15 offset:33792
    buffer_load_dwordx4 v3, s[8:11], s35 offen offset:1024 lds
    v_mfma_f32_32x32x16_bf16 v[32:47], a[4:7], a[68:71], v[32:47]
    ds_read_b64_tr_b16 a[36:37], v12 offset:34816
    ds_read_b64_tr_b16 a[38:39], v12 offset:35328
    buffer_load_dwordx4 v4, s[8:11], s35 offen offset:2048 lds
    ds_read_b128 a[104:107], v15 offset:34816
    buffer_load_dwordx4 v5, s[8:11], s35 offen offset:3072 lds
    ds_read_b64_tr_b16 a[40:41], v12 offset:36864
    v_mfma_f32_32x32x16_bf16 v[32:47], a[8:11], a[72:75], v[32:47]
    ds_read_b64_tr_b16 a[42:43], v12 offset:37376
    s_add_u32 s35, s35, 131072
    ds_read_b128 a[108:111], v15 offset:35840
    ds_read_b64_tr_b16 a[44:45], v12 offset:38912
    s_add_u32 m0, s37, 81920
    ds_read_b64_tr_b16 a[46:47], v12 offset:39424
    v_mfma_f32_32x32x16_bf16 v[32:47], a[12:15], a[76:79], v[32:47]
    ds_read_b128 a[112:115], v15 offset:36864
    buffer_load_dwordx4 v6, s[12:15], s36 offen offset:0 sc1 lds
    ds_read_b64_tr_b16 a[48:49], v12 offset:40960
    buffer_load_dwordx4 v6, s[12:15], s36 offen offset:1024 sc1 lds
    ds_read_b64_tr_b16 a[50:51], v12 offset:41472
    ds_read_b128 a[116:119], v15 offset:37888
    buffer_load_dwordx4 v6, s[12:15], s36 offen offset:2048 sc1 lds
    v_mfma_f32_32x32x16_bf16 v[32:47], a[16:19], a[80:83], v[32:47]
    ds_read_b64_tr_b16 a[52:53], v12 offset:43008
    ds_read_b64_tr_b16 a[54:55], v12 offset:43520
    buffer_load_dwordx4 v6, s[12:15], s36 offen offset:3072 sc1 lds
    ds_read_b128 a[120:123], v15 offset:38912
    s_add_u32 s36, s36, 8192
    ds_read_b64_tr_b16 a[56:57], v12 offset:45056
    v_mfma_f32_32x32x16_bf16 v[32:47], a[20:23], a[84:87], v[32:47]
    ds_read_b64_tr_b16 a[58:59], v12 offset:45568
    buffer_load_dword v223, v27, s[12:15], s63 offen sc1
    ds_read_b128 a[124:127], v15 offset:39936
    ds_read_b64_tr_b16 a[60:61], v12 offset:47104
    s_add_u32 s63, s63, 8192
    ds_read_b64_tr_b16 a[62:63], v12 offset:47616
    v_mfma_f32_32x32x16_bf16 v[32:47], a[24:27], a[88:91], v[32:47]
    v_mfma_f32_32x32x16_bf16 v[32:47], a[28:31], a[92:95], v[32:47]
    s_waitcnt lgkmcnt(0)
    s_waitcnt vmcnt(19)
    s_barrier
    v_mfma_f32_32x32x16_bf16 v[32:47], a[32:35], a[96:99], v[32:47]
    ds_read_b128 a[64:67], v14 offset:0
    s_add_u32 m0, s37, 98304
    ds_read_b64_tr_b16 a[0:1], v10 offset:0
    buffer_load_dwordx4 v2, s[8:11], s35 offen offset:0 lds
    ds_read_b64_tr_b16 a[2:3], v10 offset:512
    ds_read_b128 a[68:71], v14 offset:1024
    buffer_load_dwordx4 v3, s[8:11], s35 offen offset:1024 lds
    v_mfma_f32_32x32x16_bf16 v[32:47], a[36:39], a[100:103], v[32:47]
    ds_read_b64_tr_b16 a[4:5], v10 offset:2048
    ds_read_b64_tr_b16 a[6:7], v10 offset:2560
    buffer_load_dwordx4 v4, s[8:11], s35 offen offset:2048 lds
    ds_read_b128 a[72:75], v14 offset:2048
    buffer_load_dwordx4 v5, s[8:11], s35 offen offset:3072 lds
    ds_read_b64_tr_b16 a[8:9], v10 offset:4096
    v_mfma_f32_32x32x16_bf16 v[32:47], a[40:43], a[104:107], v[32:47]
    ds_read_b64_tr_b16 a[10:11], v10 offset:4608
    s_add_u32 s35, s35, 131072
    ds_read_b128 a[76:79], v14 offset:3072
    ds_read_b64_tr_b16 a[12:13], v10 offset:6144
    s_add_u32 m0, s37, 114688
    ds_read_b64_tr_b16 a[14:15], v10 offset:6656
    v_mfma_f32_32x32x16_bf16 v[32:47], a[44:47], a[108:111], v[32:47]
    ds_read_b128 a[80:83], v14 offset:4096
    buffer_load_dwordx4 v6, s[12:15], s36 offen offset:0 sc1 lds
    ds_read_b64_tr_b16 a[16:17], v10 offset:8192
    buffer_load_dwordx4 v6, s[12:15], s36 offen offset:1024 sc1 lds
    ds_read_b64_tr_b16 a[18:19], v10 offset:8704
    ds_read_b128 a[84:87], v14 offset:5120
    buffer_load_dwordx4 v6, s[12:15], s36 offen offset:2048 sc1 lds
    v_mfma_f32_32x32x16_bf16 v[32:47], a[48:51], a[112:115], v[32:47]
    ds_read_b64_tr_b16 a[20:21], v10 offset:10240
    ds_read_b64_tr_b16 a[22:23], v10 offset:10752
    buffer_load_dwordx4 v6, s[12:15], s36 offen offset:3072 sc1 lds
    ds_read_b128 a[88:91], v14 offset:6144
    s_add_u32 s36, s36, 8192
    ds_read_b64_tr_b16 a[24:25], v10 offset:12288
    v_mfma_f32_32x32x16_bf16 v[32:47], a[52:55], a[116:119], v[32:47]
    ds_read_b64_tr_b16 a[26:27], v10 offset:12800
    buffer_load_dword v223, v27, s[12:15], s63 offen sc1
    ds_read_b128 a[92:95], v14 offset:7168
    ds_read_b64_tr_b16 a[28:29], v10 offset:14336
    s_add_u32 s63, s63, 8192
    ds_read_b64_tr_b16 a[30:31], v10 offset:14848
    v_mfma_f32_32x32x16_bf16 v[32:47], a[56:59], a[120:123], v[32:47]
    v_mfma_f32_32x32x16_bf16 v[32:47], a[60:63], a[124:127], v[32:47]
    s_waitcnt lgkmcnt(0)
    s_waitcnt vmcnt(19)
    s_barrier
    v_mfma_f32_32x32x16_bf16 v[32:47], a[0:3], a[64:67], v[32:47]
    ds_read_b128 a[96:99], v14 offset:32768
    s_add_u32 m0, s37, 0
    ds_read_b64_tr_b16 a[32:33], v10 offset:32768
    buffer_load_dwordx4 v2, s[8:11], s35 offen offset:0 lds
    ds_read_b64_tr_b16 a[34:35], v10 offset:33280
    ds_read_b128 a[100:103], v14 offset:33792
    buffer_load_dwordx4 v3, s[8:11], s35 offen offset:1024 lds
    v_mfma_f32_32x32x16_bf16 v[32:47], a[4:7], a[68:71], v[32:47]
    ds_read_b64_tr_b16 a[36:37], v10 offset:34816
    ds_read_b64_tr_b16 a[38:39], v10 offset:35328
    buffer_load_dwordx4 v4, s[8:11], s35 offen offset:2048 lds
    ds_read_b128 a[104:107], v14 offset:34816
    buffer_load_dwordx4 v5, s[8:11], s35 offen offset:3072 lds
    ds_read_b64_tr_b16 a[40:41], v10 offset:36864
    v_mfma_f32_32x32x16_bf16 v[32:47], a[8:11], a[72:75], v[32:47]
    ds_read_b64_tr_b16 a[42:43], v10 offset:37376
    s_add_u32 s35, s35, 131072
    ds_read_b128 a[108:111], v14 offset:35840
    ds_read_b64_tr_b16 a[44:45], v10 offset:38912
    s_add_u32 m0, s37, 16384
    ds_read_b64_tr_b16 a[46:47], v10 offset:39424
    v_mfma_f32_32x32x16_bf16 v[32:47], a[12:15], a[76:79], v[32:47]
    ds_read_b128 a[112:115], v14 offset:36864
    buffer_load_dwordx4 v6, s[12:15], s36 offen offset:0 sc1 lds
    ds_read_b64_tr_b16 a[48:49], v10 offset:40960
    buffer_load_dwordx4 v6, s[12:15], s36 offen offset:1024 sc1 lds
    ds_read_b64_tr_b16 a[50:51], v10 offset:41472
    ds_read_b128 a[116:119], v14 offset:37888
    buffer_load_dwordx4 v6, s[12:15], s36 offen offset:2048 sc1 lds
    v_mfma_f32_32x32x16_bf16 v[32:47], a[16:19], a[80:83], v[32:47]
    ds_read_b64_tr_b16 a[52:53], v10 offset:43008
    ds_read_b64_tr_b16 a[54:55], v10 offset:43520
    buffer_load_dwordx4 v6, s[12:15], s36 offen offset:3072 sc1 lds
    ds_read_b128 a[120:123], v14 offset:38912
    s_add_u32 s36, s36, 8192
    ds_read_b64_tr_b16 a[56:57], v10 offset:45056
    v_mfma_f32_32x32x16_bf16 v[32:47], a[20:23], a[84:87], v[32:47]
    ds_read_b64_tr_b16 a[58:59], v10 offset:45568
    buffer_load_dword v223, v27, s[12:15], s63 offen sc1
    ds_read_b128 a[124:127], v14 offset:39936
    ds_read_b64_tr_b16 a[60:61], v10 offset:47104
    s_add_u32 s63, s63, 8192
    ds_read_b64_tr_b16 a[62:63], v10 offset:47616
    v_mfma_f32_32x32x16_bf16 v[32:47], a[24:27], a[88:91], v[32:47]
    v_mfma_f32_32x32x16_bf16 v[32:47], a[28:31], a[92:95], v[32:47]
    s_waitcnt lgkmcnt(0)
    s_waitcnt vmcnt(19)
    s_barrier
    v_mfma_f32_32x32x16_bf16 v[32:47], a[32:35], a[96:99], v[32:47]
    ds_read_b128 a[64:67], v15 offset:0
    s_add_u32 m0, s37, 32768
    ds_read_b64_tr_b16 a[0:1], v12 offset:0
    buffer_load_dwordx4 v2, s[8:11], s35 offen offset:0 lds
    ds_read_b64_tr_b16 a[2:3], v12 offset:512
    ds_read_b128 a[68:71], v15 offset:1024
    buffer_load_dwordx4 v3, s[8:11], s35 offen offset:1024 lds
    v_mfma_f32_32x32x16_bf16 v[32:47], a[36:39], a[100:103], v[32:47]
    ds_read_b64_tr_b16 a[4:5], v12 offset:2048
    ds_read_b64_tr_b16 a[6:7], v12 offset:2560
    buffer_load_dwordx4 v4, s[8:11], s35 offen offset:2048 lds
    ds_read_b128 a[72:75], v15 offset:2048
    buffer_load_dwordx4 v5, s[8:11], s35 offen offset:3072 lds
    ds_read_b64_tr_b16 a[8:9], v12 offset:4096
    v_mfma_f32_32x32x16_bf16 v[32:47], a[40:43], a[104:107], v[32:47]
    ds_read_b64_tr_b16 a[10:11], v12 offset:4608
    s_add_u32 s35, s35, 131072
    ds_read_b128 a[76:79], v15 offset:3072
    ds_read_b64_tr_b16 a[12:13], v12 offset:6144
    s_add_u32 m0, s37, 49152
    ds_read_b64_tr_b16 a[14:15], v12 offset:6656
    v_mfma_f32_32x32x16_bf16 v[32:47], a[44:47], a[108:111], v[32:47]
    ds_read_b128 a[80:83], v15 offset:4096
    buffer_load_dwordx4 v6, s[12:15], s36 offen offset:0 sc1 lds
    ds_read_b64_tr_b16 a[16:17], v12 offset:8192
    buffer_load_dwordx4 v6, s[12:15], s36 offen offset:1024 sc1 lds
    ds_read_b64_tr_b16 a[18:19], v12 offset:8704
    ds_read_b128 a[84:87], v15 offset:5120
    buffer_load_dwordx4 v6, s[12:15], s36 offen offset:2048 sc1 lds
    v_mfma_f32_32x32x16_bf16 v[32:47], a[48:51], a[112:115], v[32:47]
    ds_read_b64_tr_b16 a[20:21], v12 offset:10240
    ds_read_b64_tr_b16 a[22:23], v12 offset:10752
    buffer_load_dwordx4 v6, s[12:15], s36 offen offset:3072 sc1 lds
    ds_read_b128 a[88:91], v15 offset:6144
    s_add_u32 s36, s36, 8192
    ds_read_b64_tr_b16 a[24:25], v12 offset:12288
    v_mfma_f32_32x32x16_bf16 v[32:47], a[52:55], a[116:119], v[32:47]
    ds_read_b64_tr_b16 a[26:27], v12 offset:12800
    buffer_load_dword v223, v27, s[12:15], s63 offen sc1
    ds_read_b128 a[92:95], v15 offset:7168
    ds_read_b64_tr_b16 a[28:29], v12 offset:14336
    s_add_u32 s63, s63, 8192
    ds_read_b64_tr_b16 a[30:31], v12 offset:14848
    v_mfma_f32_32x32x16_bf16 v[32:47], a[56:59], a[120:123], v[32:47]
    v_mfma_f32_32x32x16_bf16 v[32:47], a[60:63], a[124:127], v[32:47]
    s_waitcnt lgkmcnt(0)
    s_waitcnt vmcnt(19)
    s_barrier
    v_mfma_f32_32x32x16_bf16 v[32:47], a[0:3], a[64:67], v[32:47]
    ds_read_b128 a[96:99], v15 offset:32768
    s_add_u32 m0, s37, 65536
    ds_read_b64_tr_b16 a[32:33], v12 offset:32768
    buffer_load_dwordx4 v2, s[8:11], s35 offen offset:0 lds
    ds_read_b64_tr_b16 a[34:35], v12 offset:33280
    ds_read_b128 a[100:103], v15 offset:33792
    buffer_load_dwordx4 v3, s[8:11], s35 offen offset:1024 lds
    v_mfma_f32_32x32x16_bf16 v[32:47], a[4:7], a[68:71], v[32:47]
    ds_read_b64_tr_b16 a[36:37], v12 offset:34816
    ds_read_b64_tr_b16 a[38:39], v12 offset:35328
    buffer_load_dwordx4 v4, s[8:11], s35 offen offset:2048 lds
    ds_read_b128 a[104:107], v15 offset:34816
    buffer_load_dwordx4 v5, s[8:11], s35 offen offset:3072 lds
    ds_read_b64_tr_b16 a[40:41], v12 offset:36864
    v_mfma_f32_32x32x16_bf16 v[32:47], a[8:11], a[72:75], v[32:47]
    ds_read_b64_tr_b16 a[42:43], v12 offset:37376
    s_add_u32 s35, s35, 131072
    ds_read_b128 a[108:111], v15 offset:35840
    ds_read_b64_tr_b16 a[44:45], v12 offset:38912
    s_add_u32 m0, s37, 81920
    ds_read_b64_tr_b16 a[46:47], v12 offset:39424
    v_mfma_f32_32x32x16_bf16 v[32:47], a[12:15], a[76:79], v[32:47]
    ds_read_b128 a[112:115], v15 offset:36864
    buffer_load_dwordx4 v6, s[12:15], s36 offen offset:0 sc1 lds
    ds_read_b64_tr_b16 a[48:49], v12 offset:40960
    buffer_load_dwordx4 v6, s[12:15], s36 offen offset:1024 sc1 lds
    ds_read_b64_tr_b16 a[50:51], v12 offset:41472
    ds_read_b128 a[116:119], v15 offset:37888
    buffer_load_dwordx4 v6, s[12:15], s36 offen offset:2048 sc1 lds
    v_mfma_f32_32x32x16_bf16 v[32:47], a[16:19], a[80:83], v[32:47]
    ds_read_b64_tr_b16 a[52:53], v12 offset:43008
    ds_read_b64_tr_b16 a[54:55], v12 offset:43520
    buffer_load_dwordx4 v6, s[12:15], s36 offen offset:3072 sc1 lds
    ds_read_b128 a[120:123], v15 offset:38912
    s_add_u32 s36, s36, 8192
    ds_read_b64_tr_b16 a[56:57], v12 offset:45056
    v_mfma_f32_32x32x16_bf16 v[32:47], a[20:23], a[84:87], v[32:47]
    ds_read_b64_tr_b16 a[58:59], v12 offset:45568
    buffer_load_dword v223, v27, s[12:15], s63 offen sc1
    ds_read_b128 a[124:127], v15 offset:39936
    ds_read_b64_tr_b16 a[60:61], v12 offset:47104
    s_add_u32 s63, s63, 8192
    ds_read_b64_tr_b16 a[62:63], v12 offset:47616
    v_mfma_f32_32x32x16_bf16 v[32:47], a[24:27], a[88:91], v[32:47]
    v_mfma_f32_32x32x16_bf16 v[32:47], a[28:31], a[92:95], v[32:47]
    s_waitcnt lgkmcnt(0)
    s_waitcnt vmcnt(19)
    s_barrier
    v_mfma_f32_32x32x16_bf16 v[32:47], a[32:35], a[96:99], v[32:47]
    ds_read_b128 a[64:67], v14 offset:0
    s_add_u32 m0, s37, 98304
    ds_read_b64_tr_b16 a[0:1], v10 offset:0
    buffer_load_dwordx4 v2, s[8:11], s35 offen offset:0 lds
    ds_read_b64_tr_b16 a[2:3], v10 offset:512
    ds_read_b128 a[68:71], v14 offset:1024
    buffer_load_dwordx4 v3, s[8:11], s35 offen offset:1024 lds
    v_mfma_f32_32x32x16_bf16 v[32:47], a[36:39], a[100:103], v[32:47]
    ds_read_b64_tr_b16 a[4:5], v10 offset:2048
    ds_read_b64_tr_b16 a[6:7], v10 offset:2560
    buffer_load_dwordx4 v4, s[8:11], s35 offen offset:2048 lds
    ds_read_b128 a[72:75], v14 offset:2048
    buffer_load_dwordx4 v5, s[8:11], s35 offen offset:3072 lds
    ds_read_b64_tr_b16 a[8:9], v10 offset:4096
    v_mfma_f32_32x32x16_bf16 v[32:47], a[40:43], a[104:107], v[32:47]
    ds_read_b64_tr_b16 a[10:11], v10 offset:4608
    s_add_u32 s35, s35, 131072
    ds_read_b128 a[76:79], v14 offset:3072
    ds_read_b64_tr_b16 a[12:13], v10 offset:6144
    s_add_u32 m0, s37, 114688
    ds_read_b64_tr_b16 a[14:15], v10 offset:6656
    v_mfma_f32_32x32x16_bf16 v[32:47], a[44:47], a[108:111], v[32:47]
    ds_read_b128 a[80:83], v14 offset:4096
    buffer_load_dwordx4 v6, s[12:15], s36 offen offset:0 sc1 lds
    ds_read_b64_tr_b16 a[16:17], v10 offset:8192
    buffer_load_dwordx4 v6, s[12:15], s36 offen offset:1024 sc1 lds
    ds_read_b64_tr_b16 a[18:19], v10 offset:8704
    ds_read_b128 a[84:87], v14 offset:5120
    buffer_load_dwordx4 v6, s[12:15], s36 offen offset:2048 sc1 lds
    v_mfma_f32_32x32x16_bf16 v[32:47], a[48:51], a[112:115], v[32:47]
    ds_read_b64_tr_b16 a[20:21], v10 offset:10240
    ds_read_b64_tr_b16 a[22:23], v10 offset:10752
    buffer_load_dwordx4 v6, s[12:15], s36 offen offset:3072 sc1 lds
    ds_read_b128 a[88:91], v14 offset:6144
    s_add_u32 s36, s36, 8192
    ds_read_b64_tr_b16 a[24:25], v10 offset:12288
    v_mfma_f32_32x32x16_bf16 v[32:47], a[52:55], a[116:119], v[32:47]
    ds_read_b64_tr_b16 a[26:27], v10 offset:12800
    buffer_load_dword v223, v27, s[12:15], s63 offen sc1
    ds_read_b128 a[92:95], v14 offset:7168
    ds_read_b64_tr_b16 a[28:29], v10 offset:14336
    s_add_u32 s63, s63, 8192
    ds_read_b64_tr_b16 a[30:31], v10 offset:14848
    v_mfma_f32_32x32x16_bf16 v[32:47], a[56:59], a[120:123], v[32:47]
    v_mfma_f32_32x32x16_bf16 v[32:47], a[60:63], a[124:127], v[32:47]
    s_waitcnt lgkmcnt(0)
    s_waitcnt vmcnt(19)
    s_barrier
    v_mfma_f32_32x32x16_bf16 v[32:47], a[0:3], a[64:67], v[32:47]
    ds_read_b128 a[96:99], v14 offset:32768
    s_add_u32 m0, s37, 0
    ds_read_b64_tr_b16 a[32:33], v10 offset:32768
    ds_read_b64_tr_b16 a[34:35], v10 offset:33280
    buffer_load_dwordx4 v2, s[8:11], s35 offen offset:0 lds
    ds_read_b128 a[100:103], v14 offset:33792
    v_mfma_f32_32x32x16_bf16 v[32:47], a[4:7], a[68:71], v[32:47]
    ds_read_b64_tr_b16 a[36:37], v10 offset:34816
    buffer_load_dwordx4 v3, s[8:11], s35 offen offset:1024 lds
    ds_read_b64_tr_b16 a[38:39], v10 offset:35328
    ds_read_b128 a[104:107], v14 offset:34816
    buffer_load_dwordx4 v4, s[8:11], s35 offen offset:2048 lds
    ds_read_b64_tr_b16 a[40:41], v10 offset:36864
    v_mfma_f32_32x32x16_bf16 v[32:47], a[8:11], a[72:75], v[32:47]
    ds_read_b64_tr_b16 a[42:43], v10 offset:37376
    buffer_load_dwordx4 v5, s[8:11], s35 offen offset:3072 lds
    ds_read_b128 a[108:111], v14 offset:35840
    ds_read_b64_tr_b16 a[44:45], v10 offset:38912
    s_add_u32 s35, s35, 131072
    ds_read_b64_tr_b16 a[46:47], v10 offset:39424
    v_mfma_f32_32x32x16_bf16 v[32:47], a[12:15], a[76:79], v[32:47]
    ds_read_b128 a[112:115], v14 offset:36864
    s_add_u32 m0, s37, 16384
    ds_read_b64_tr_b16 a[48:49], v10 offset:40960
    ds_read_b64_tr_b16 a[50:51], v10 offset:41472
    buffer_load_dwordx4 v6, s[12:15], s36 offen offset:0 sc1 lds
    ds_read_b128 a[116:119], v14 offset:37888
    v_mfma_f32_32x32x16_bf16 v[32:47], a[16:19], a[80:83], v[32:47]
    ds_read_b64_tr_b16 a[52:53], v10 offset:43008
    buffer_load_dwordx4 v6, s[12:15], s36 offen offset:1024 sc1 lds
    ds_read_b64_tr_b16 a[54:55], v10 offset:43520
    ds_read_b128 a[120:123], v14 offset:38912
    buffer_load_dwordx4 v6, s[12:15], s36 offen offset:2048 sc1 lds
    ds_read_b64_tr_b16 a[56:57], v10 offset:45056
    v_mfma_f32_32x32x16_bf16 v[32:47], a[20:23], a[84:87], v[32:47]
    ds_read_b64_tr_b16 a[58:59], v10 offset:45568
    buffer_load_dwordx4 v6, s[12:15], s36 offen offset:3072 sc1 lds
    ds_read_b128 a[124:127], v14 offset:39936
    ds_read_b64_tr_b16 a[60:61], v10 offset:47104
    s_add_u32 s36, s36, 8192
    ds_read_b64_tr_b16 a[62:63], v10 offset:47616
    v_mfma_f32_32x32x16_bf16 v[32:47], a[24:27], a[88:91], v[32:47]
    v_mfma_f32_32x32x16_bf16 v[32:47], a[28:31], a[92:95], v[32:47]
    s_waitcnt lgkmcnt(0)
    s_waitcnt vmcnt(18)
    s_barrier
    v_mfma_f32_32x32x16_bf16 v[32:47], a[32:35], a[96:99], v[32:47]
    ds_read_b128 a[64:67], v15 offset:0
    s_add_u32 m0, s37, 32768
    ds_read_b64_tr_b16 a[0:1], v12 offset:0
    ds_read_b64_tr_b16 a[2:3], v12 offset:512
    buffer_load_dwordx4 v2, s[8:11], s35 offen offset:0 lds
    ds_read_b128 a[68:71], v15 offset:1024
    v_mfma_f32_32x32x16_bf16 v[32:47], a[36:39], a[100:103], v[32:47]
    ds_read_b64_tr_b16 a[4:5], v12 offset:2048
    buffer_load_dwordx4 v3, s[8:11], s35 offen offset:1024 lds
    ds_read_b64_tr_b16 a[6:7], v12 offset:2560
    ds_read_b128 a[72:75], v15 offset:2048
    buffer_load_dwordx4 v4, s[8:11], s35 offen offset:2048 lds
    ds_read_b64_tr_b16 a[8:9], v12 offset:4096
    v_mfma_f32_32x32x16_bf16 v[32:47], a[40:43], a[104:107], v[32:47]
    ds_read_b64_tr_b16 a[10:11], v12 offset:4608
    buffer_load_dwordx4 v5, s[8:11], s35 offen offset:3072 lds
    ds_read_b128 a[76:79], v15 offset:3072
    ds_read_b64_tr_b16 a[12:13], v12 offset:6144
    s_add_u32 s35, s35, 131072
    ds_read_b64_tr_b16 a[14:15], v12 offset:6656
    v_mfma_f32_32x32x16_bf16 v[32:47], a[44:47], a[108:111], v[32:47]
    ds_read_b128 a[80:83], v15 offset:4096
    s_add_u32 m0, s37, 49152
    ds_read_b64_tr_b16 a[16:17], v12 offset:8192
    ds_read_b64_tr_b16 a[18:19], v12 offset:8704
    buffer_load_dwordx4 v6, s[12:15], s36 offen offset:0 sc1 lds
    ds_read_b128 a[84:87], v15 offset:5120
    v_mfma_f32_32x32x16_bf16 v[32:47], a[48:51], a[112:115], v[32:47]
    ds_read_b64_tr_b16 a[20:21], v12 offset:10240
    buffer_load_dwordx4 v6, s[12:15], s36 offen offset:1024 sc1 lds
    ds_read_b64_tr_b16 a[22:23], v12 offset:10752
    ds_read_b128 a[88:91], v15 offset:6144
    buffer_load_dwordx4 v6, s[12:15], s36 offen offset:2048 sc1 lds
    ds_read_b64_tr_b16 a[24:25], v12 offset:12288
    v_mfma_f32_32x32x16_bf16 v[32:47], a[52:55], a[116:119], v[32:47]
    ds_read_b64_tr_b16 a[26:27], v12 offset:12800
    buffer_load_dwordx4 v6, s[12:15], s36 offen offset:3072 sc1 lds
    ds_read_b128 a[92:95], v15 offset:7168
    ds_read_b64_tr_b16 a[28:29], v12 offset:14336
    s_add_u32 s36, s36, 8192
    ds_read_b64_tr_b16 a[30:31], v12 offset:14848
    v_mfma_f32_32x32x16_bf16 v[32:47], a[56:59], a[120:123], v[32:47]
    v_mfma_f32_32x32x16_bf16 v[32:47], a[60:63], a[124:127], v[32:47]
    s_waitcnt lgkmcnt(0)
    s_waitcnt vmcnt(17)
    s_barrier
    v_mfma_f32_32x32x16_bf16 v[32:47], a[0:3], a[64:67], v[32:47]
    ds_read_b128 a[96:99], v15 offset:32768
    ds_read_b64_tr_b16 a[32:33], v12 offset:32768
    ds_read_b64_tr_b16 a[34:35], v12 offset:33280
    ds_read_b128 a[100:103], v15 offset:33792
    v_mfma_f32_32x32x16_bf16 v[32:47], a[4:7], a[68:71], v[32:47]
    ds_read_b64_tr_b16 a[36:37], v12 offset:34816
    ds_read_b64_tr_b16 a[38:39], v12 offset:35328
    ds_read_b128 a[104:107], v15 offset:34816
    ds_read_b64_tr_b16 a[40:41], v12 offset:36864
    v_mfma_f32_32x32x16_bf16 v[32:47], a[8:11], a[72:75], v[32:47]
    ds_read_b64_tr_b16 a[42:43], v12 offset:37376
    ds_read_b128 a[108:111], v15 offset:35840
    ds_read_b64_tr_b16 a[44:45], v12 offset:38912
    ds_read_b64_tr_b16 a[46:47], v12 offset:39424
    v_mfma_f32_32x32x16_bf16 v[32:47], a[12:15], a[76:79], v[32:47]
    ds_read_b128 a[112:115], v15 offset:36864
    ds_read_b64_tr_b16 a[48:49], v12 offset:40960
    ds_read_b64_tr_b16 a[50:51], v12 offset:41472
    ds_read_b128 a[116:119], v15 offset:37888
    v_mfma_f32_32x32x16_bf16 v[32:47], a[16:19], a[80:83], v[32:47]
    ds_read_b64_tr_b16 a[52:53], v12 offset:43008
    ds_read_b64_tr_b16 a[54:55], v12 offset:43520
    ds_read_b128 a[120:123], v15 offset:38912
    ds_read_b64_tr_b16 a[56:57], v12 offset:45056
    v_mfma_f32_32x32x16_bf16 v[32:47], a[20:23], a[84:87], v[32:47]
    ds_read_b64_tr_b16 a[58:59], v12 offset:45568
    ds_read_b128 a[124:127], v15 offset:39936
    ds_read_b64_tr_b16 a[60:61], v12 offset:47104
    ds_read_b64_tr_b16 a[62:63], v12 offset:47616
    v_mfma_f32_32x32x16_bf16 v[32:47], a[24:27], a[88:91], v[32:47]
    v_mfma_f32_32x32x16_bf16 v[32:47], a[28:31], a[92:95], v[32:47]
    s_waitcnt lgkmcnt(0)
    s_waitcnt vmcnt(8)
    s_barrier
    v_mfma_f32_32x32x16_bf16 v[32:47], a[32:35], a[96:99], v[32:47]
    ds_read_b128 a[64:67], v14 offset:0
    ds_read_b64_tr_b16 a[0:1], v10 offset:0
    ds_read_b64_tr_b16 a[2:3], v10 offset:512
    ds_read_b128 a[68:71], v14 offset:1024
    v_mfma_f32_32x32x16_bf16 v[32:47], a[36:39], a[100:103], v[32:47]
    ds_read_b64_tr_b16 a[4:5], v10 offset:2048
    ds_read_b64_tr_b16 a[6:7], v10 offset:2560
    ds_read_b128 a[72:75], v14 offset:2048
    ds_read_b64_tr_b16 a[8:9], v10 offset:4096
    v_mfma_f32_32x32x16_bf16 v[32:47], a[40:43], a[104:107], v[32:47]
    ds_read_b64_tr_b16 a[10:11], v10 offset:4608
    ds_read_b128 a[76:79], v14 offset:3072
    ds_read_b64_tr_b16 a[12:13], v10 offset:6144
    ds_read_b64_tr_b16 a[14:15], v10 offset:6656
    v_mfma_f32_32x32x16_bf16 v[32:47], a[44:47], a[108:111], v[32:47]
    ds_read_b128 a[80:83], v14 offset:4096
    ds_read_b64_tr_b16 a[16:17], v10 offset:8192
    ds_read_b64_tr_b16 a[18:19], v10 offset:8704
    ds_read_b128 a[84:87], v14 offset:5120
    v_mfma_f32_32x32x16_bf16 v[32:47], a[48:51], a[112:115], v[32:47]
    ds_read_b64_tr_b16 a[20:21], v10 offset:10240
    ds_read_b64_tr_b16 a[22:23], v10 offset:10752
    ds_read_b128 a[88:91], v14 offset:6144
    ds_read_b64_tr_b16 a[24:25], v10 offset:12288
    v_mfma_f32_32x32x16_bf16 v[32:47], a[52:55], a[116:119], v[32:47]
    ds_read_b64_tr_b16 a[26:27], v10 offset:12800
    ds_read_b128 a[92:95], v14 offset:7168
    ds_read_b64_tr_b16 a[28:29], v10 offset:14336
    ds_read_b64_tr_b16 a[30:31], v10 offset:14848
    v_mfma_f32_32x32x16_bf16 v[32:47], a[56:59], a[120:123], v[32:47]
    v_mfma_f32_32x32x16_bf16 v[32:47], a[60:63], a[124:127], v[32:47]
    s_waitcnt lgkmcnt(0)
    s_waitcnt vmcnt(0)
    s_barrier
    v_mfma_f32_32x32x16_bf16 v[32:47], a[0:3], a[64:67], v[32:47]
    ds_read_b128 a[96:99], v14 offset:32768
    buffer_load_dwordx4 v[48:51], v16, s[20:23], 0 offen offset:0 sc1
    ds_read_b64_tr_b16 a[32:33], v10 offset:32768
    ds_read_b64_tr_b16 a[34:35], v10 offset:33280
    ds_read_b128 a[100:103], v14 offset:33792
    v_mfma_f32_32x32x16_bf16 v[32:47], a[4:7], a[68:71], v[32:47]
    ds_read_b64_tr_b16 a[36:37], v10 offset:34816
    ds_read_b64_tr_b16 a[38:39], v10 offset:35328
    ds_read_b128 a[104:107], v14 offset:34816
    buffer_load_dwordx4 v[56:59], v16, s[24:27], 0 offen offset:0 sc1
    ds_read_b64_tr_b16 a[40:41], v10 offset:36864
    v_mfma_f32_32x32x16_bf16 v[32:47], a[8:11], a[72:75], v[32:47]
    ds_read_b64_tr_b16 a[42:43], v10 offset:37376
    ds_read_b128 a[108:111], v14 offset:35840
    ds_read_b64_tr_b16 a[44:45], v10 offset:38912
    ds_read_b64_tr_b16 a[46:47], v10 offset:39424
    v_mfma_f32_32x32x16_bf16 v[32:47], a[12:15], a[76:79], v[32:47]
    ds_read_b128 a[112:115], v14 offset:36864
    buffer_load_dwordx4 v[52:55], v16, s[20:23], 0 offen offset:1024 sc1
    ds_read_b64_tr_b16 a[48:49], v10 offset:40960
    ds_read_b64_tr_b16 a[50:51], v10 offset:41472
    ds_read_b128 a[116:119], v14 offset:37888
    v_mfma_f32_32x32x16_bf16 v[32:47], a[16:19], a[80:83], v[32:47]
    ds_read_b64_tr_b16 a[52:53], v10 offset:43008
    ds_read_b64_tr_b16 a[54:55], v10 offset:43520
    ds_read_b128 a[120:123], v14 offset:38912
    buffer_load_dwordx4 v[60:63], v16, s[24:27], 0 offen offset:1024 sc1
    ds_read_b64_tr_b16 a[56:57], v10 offset:45056
    v_mfma_f32_32x32x16_bf16 v[32:47], a[20:23], a[84:87], v[32:47]
    ds_read_b64_tr_b16 a[58:59], v10 offset:45568
    ds_read_b128 a[124:127], v14 offset:39936
    ds_read_b64_tr_b16 a[60:61], v10 offset:47104
    ds_read_b64_tr_b16 a[62:63], v10 offset:47616
    v_mfma_f32_32x32x16_bf16 v[32:47], a[24:27], a[88:91], v[32:47]
    v_mfma_f32_32x32x16_bf16 v[32:47], a[28:31], a[92:95], v[32:47]
    s_waitcnt lgkmcnt(0)
    v_mfma_f32_32x32x16_bf16 v[32:47], a[32:35], a[96:99], v[32:47]
    v_mfma_f32_32x32x16_bf16 v[32:47], a[36:39], a[100:103], v[32:47]
    v_mfma_f32_32x32x16_bf16 v[32:47], a[40:43], a[104:107], v[32:47]
    v_mfma_f32_32x32x16_bf16 v[32:47], a[44:47], a[108:111], v[32:47]
    v_mfma_f32_32x32x16_bf16 v[32:47], a[48:51], a[112:115], v[32:47]
    v_mfma_f32_32x32x16_bf16 v[32:47], a[52:55], a[116:119], v[32:47]
    v_mfma_f32_32x32x16_bf16 v[32:47], a[56:59], a[120:123], v[32:47]
    v_mfma_f32_32x32x16_bf16 v[32:47], a[60:63], a[124:127], v[32:47]
    s_nop 11
    s_waitcnt vmcnt(0)
    v_lshlrev_b32 v160, 16, v48
    v_and_b32 v161, 0xffff0000, v48
    v_lshlrev_b32 v162, 16, v49
    v_and_b32 v163, 0xffff0000, v49
    v_lshlrev_b32 v164, 16, v50
    v_and_b32 v165, 0xffff0000, v50
    v_lshlrev_b32 v166, 16, v51
    v_and_b32 v167, 0xffff0000, v51
    v_pk_add_f32 v[32:33], v[32:33], v[160:161]
    v_pk_add_f32 v[34:35], v[34:35], v[162:163]
    v_pk_add_f32 v[36:37], v[36:37], v[164:165]
    v_pk_add_f32 v[38:39], v[38:39], v[166:167]
    v_lshlrev_b32 v160, 16, v56
    v_and_b32 v161, 0xffff0000, v56
    v_lshlrev_b32 v162, 16, v57
    v_and_b32 v163, 0xffff0000, v57
    v_lshlrev_b32 v164, 16, v58
    v_and_b32 v165, 0xffff0000, v58
    v_lshlrev_b32 v166, 16, v59
    v_and_b32 v167, 0xffff0000, v59
    v_pk_fma_f32 v[32:33], v[32:33], v[192:193], v[160:161]
    v_pk_fma_f32 v[34:35], v[34:35], v[194:195], v[162:163]
    v_pk_fma_f32 v[36:37], v[36:37], v[196:197], v[164:165]
    v_pk_fma_f32 v[38:39], v[38:39], v[198:199], v[166:167]
    v_cvt_pk_bf16_f32 v104, v32, v33
    v_cvt_pk_bf16_f32 v105, v34, v35
    v_cvt_pk_bf16_f32 v106, v36, v37
    v_cvt_pk_bf16_f32 v107, v38, v39
    buffer_store_dwordx4 v[104:107], v17, s[16:19], 0 offen offset:0
    v_lshlrev_b32 v160, 16, v52
    v_and_b32 v161, 0xffff0000, v52
    v_lshlrev_b32 v162, 16, v53
    v_and_b32 v163, 0xffff0000, v53
    v_lshlrev_b32 v164, 16, v54
    v_and_b32 v165, 0xffff0000, v54
    v_lshlrev_b32 v166, 16, v55
    v_and_b32 v167, 0xffff0000, v55
    v_pk_add_f32 v[40:41], v[40:41], v[160:161]
    v_pk_add_f32 v[42:43], v[42:43], v[162:163]
    v_pk_add_f32 v[44:45], v[44:45], v[164:165]
    v_pk_add_f32 v[46:47], v[46:47], v[166:167]
    v_lshlrev_b32 v160, 16, v60
    v_and_b32 v161, 0xffff0000, v60
    v_lshlrev_b32 v162, 16, v61
    v_and_b32 v163, 0xffff0000, v61
    v_lshlrev_b32 v164, 16, v62
    v_and_b32 v165, 0xffff0000, v62
    v_lshlrev_b32 v166, 16, v63
    v_and_b32 v167, 0xffff0000, v63
    v_pk_fma_f32 v[40:41], v[40:41], v[200:201], v[160:161]
    v_pk_fma_f32 v[42:43], v[42:43], v[202:203], v[162:163]
    v_pk_fma_f32 v[44:45], v[44:45], v[204:205], v[164:165]
    v_pk_fma_f32 v[46:47], v[46:47], v[206:207], v[166:167]
    v_cvt_pk_bf16_f32 v108, v40, v41
    v_cvt_pk_bf16_f32 v109, v42, v43
    v_cvt_pk_bf16_f32 v110, v44, v45
    v_cvt_pk_bf16_f32 v111, v46, v47
    buffer_store_dwordx4 v[108:111], v17, s[16:19], 0 offen offset:32
    s_endpgm
L_at_redo:
    s_waitcnt vmcnt(0)
    s_mov_b32 s33, 1
    s_mov_b32 s29, 0
    s_mov_b32 s32, 32
    v_mov_b32 v2, 0xff800000
    v_mov_b32 v3, 0xff800000
L_at_maxloop:
    s_barrier
    s_add_u32 m0, s28, 0
    s_nop 0
    buffer_load_dwordx4 v22, s[8:11], s29 offen offset:0 lds
    buffer_load_dwordx4 v23, s[8:11], s29 offen offset:1024 lds
    buffer_load_dwordx4 v24, s[8:11], s29 offen offset:2048 lds
    buffer_load_dwordx4 v25, s[8:11], s29 offen offset:3072 lds
    s_add_u32 s29, s29, 16384
    s_waitcnt vmcnt(0)
    s_barrier
    ds_read_b128 a[128:131], v10 offset:0
    ds_read_b128 a[132:135], v11 offset:0
    ds_read_b128 a[136:139], v12 offset:0
    ds_read_b128 a[140:143], v13 offset:0
    ds_read_b128 a[144:147], v14 offset:0
    ds_read_b128 a[148:151], v15 offset:0
    ds_read_b128 a[152:155], v16 offset:0
    ds_read_b128 a[156:159], v17 offset:0
    s_waitcnt lgkmcnt(0)
    v_mfma_f32_32x32x16_bf16 v[40:55], a[128:131], v[168:171], 0
    v_mfma_f32_32x32x16_bf16 v[40:55], a[132:135], v[172:175], v[40:55]
    v_mfma_f32_32x32x16_bf16 v[40:55], a[136:139], v[176:179], v[40:55]
    v_mfma_f32_32x32x16_bf16 v[40:55], a[140:143], v[180:183], v[40:55]
    v_mfma_f32_32x32x16_bf16 v[40:55], a[144:147], v[184:187], v[40:55]
    v_mfma_f32_32x32x16_bf16 v[40:55], a[148:151], v[188:191], v[40:55]
    v_mfma_f32_32x32x16_bf16 v[40:55], a[152:155], v[192:195], v[40:55]
    v_mfma_f32_32x32x16_bf16 v[40:55], a[156:159], v[196:199], v[40:55]
    v_mfma_f32_32x32x16_bf16 v[56:71], a[128:131], v[200:203], 0
    v_mfma_f32_32x32x16_bf16 v[56:71], a[132:135], v[204:207], v[56:71]
    v_mfma_f32_32x32x16_bf16 v[56:71], a[136:139], v[208:211], v[56:71]
    v_mfma_f32_32x32x16_bf16 v[56:71], a[140:143], v[212:215], v[56:71]
    v_mfma_f32_32x32x16_bf16 v[56:71], a[144:147], v[216:219], v[56:71]
    v_mfma_f32_32x32x16_bf16 v[56:71], a[148:151], v[220:223], v[56:71]
    v_mfma_f32_32x32x16_bf16 v[56:71], a[152:155], v[224:227], v[56:71]
    v_mfma_f32_32x32x16_bf16 v[56:71], a[156:159], v[228:231], v[56:71]
    s_nop 15
    v_max3_f32 v2, v2, v40, v41
    v_max3_f32 v2, v2, v42, v43
    v_max3_f32 v2, v2, v44, v45
    v_max3_f32 v2, v2, v46, v47
    v_max3_f32 v2, v2, v48, v49
    v_max3_f32 v2, v2, v50, v51
    v_max3_f32 v2, v2, v52, v53
    v_max3_f32 v2, v2, v54, v55
    v_max3_f32 v3, v3, v56, v57
    v_max3_f32 v3, v3, v58, v59
    v_max3_f32 v3, v3, v60, v61
    v_max3_f32 v3, v3, v62, v63
    v_max3_f32 v3, v3, v64, v65
    v_max3_f32 v3, v3, v66, v67
    v_max3_f32 v3, v3, v68, v69
    v_max3_f32 v3, v3, v70, v71
    ds_read_b128 a[128:131], v10 offset:8192
    ds_read_b128 a[132:135], v11 offset:8192
    ds_read_b128 a[136:139], v12 offset:8192
    ds_read_b128 a[140:143], v13 offset:8192
    ds_read_b128 a[144:147], v14 offset:8192
    ds_read_b128 a[148:151], v15 offset:8192
    ds_read_b128 a[152:155], v16 offset:8192
    ds_read_b128 a[156:159], v17 offset:8192
    s_waitcnt lgkmcnt(0)
    v_mfma_f32_32x32x16_bf16 v[40:55], a[128:131], v[168:171], 0
    v_mfma_f32_32x32x16_bf16 v[40:55], a[132:135], v[172:175], v[40:55]
    v_mfma_f32_32x32x16_bf16 v[40:55], a[136:139], v[176:179], v[40:55]
    v_mfma_f32_32x32x16_bf16 v[40:55], a[140:143], v[180:183], v[40:55]
    v_mfma_f32_32x32x16_bf16 v[40:55], a[144:147], v[184:187], v[40:55]
    v_mfma_f32_32x32x16_bf16 v[40:55], a[148:151], v[188:191], v[40:55]
    v_mfma_f32_32x32x16_bf16 v[40:55], a[152:155], v[192:195], v[40:55]
    v_mfma_f32_32x32x16_bf16 v[40:55], a[156:159], v[196:199], v[40:55]
    v_mfma_f32_32x32x16_bf16 v[56:71], a[128:131], v[200:203], 0
    v_mfma_f32_32x32x16_bf16 v[56:71], a[132:135], v[204:207], v[56:71]
    v_mfma_f32_32x32x16_bf16 v[56:71], a[136:139], v[208:211], v[56:71]
    v_mfma_f32_32x32x16_bf16 v[56:71], a[140:143], v[212:215], v[56:71]
    v_mfma_f32_32x32x16_bf16 v[56:71], a[144:147], v[216:219], v[56:71]
    v_mfma_f32_32x32x16_bf16 v[56:71], a[148:151], v[220:223], v[56:71]
    v_mfma_f32_32x32x16_bf16 v[56:71], a[152:155], v[224:227], v[56:71]
    v_mfma_f32_32x32x16_bf16 v[56:71], a[156:159], v[228:231], v[56:71]
    s_nop 15
    v_max3_f32 v2, v2, v40, v41
    v_max3_f32 v2, v2, v42, v43
    v_max3_f32 v2, v2, v44, v45
    v_max3_f32 v2, v2, v46, v47
    v_max3_f32 v2, v2, v48, v49
    v_max3_f32 v2, v2, v50, v51
    v_max3_f32 v2, v2, v52, v53
    v_max3_f32 v2, v2, v54, v55
    v_max3_f32 v3, v3, v56, v57
    v_max3_f32 v3, v3, v58, v59
    v_max3_f32 v3, v3, v60, v61
    v_max3_f32 v3, v3, v62, v63
    v_max3_f32 v3, v3, v64, v65
    v_max3_f32 v3, v3, v66, v67
    v_max3_f32 v3, v3, v68, v69
    v_max3_f32 v3, v3, v70, v71
    s_sub_u32 s32, s32, 1
    s_cmp_lg_u32 s32, 0
    s_cbranch_scc1 L_at_maxloop
    v_mov_b32 v4, v2
    v_mov_b32 v5, v3
    s_nop 1
    v_permlane32_swap_b32 v2, v4
    v_permlane32_swap_b32 v3, v5
    s_nop 1
    v_max_f32 v2, v2, v4
    v_sub_f32 v2, 0, v2
    v_max_f32 v3, v3, v5
    v_sub_f32 v3, 0, v3
    v_mov_b32 v104, v2
    v_mov_b32 v105, v2
    v_mov_b32 v106, v2
    v_mov_b32 v107, v2
    v_mov_b32 v108, v2
    v_mov_b32 v109, v2
    v_mov_b32 v110, v2
    v_mov_b32 v111, v2
    v_mov_b32 v112, v2
    v_mov_b32 v113, v2
    v_mov_b32 v114, v2
    v_mov_b32 v115, v2
    v_mov_b32 v116, v2
    v_mov_b32 v117, v2
    v_mov_b32 v118, v2
    v_mov_b32 v119, v2
    v_mov_b32 v120, v3
    v_mov_b32 v121, v3
    v_mov_b32 v122, v3
    v_mov_b32 v123, v3
    v_mov_b32 v124, v3
    v_mov_b32 v125, v3
    v_mov_b32 v126, v3
    v_mov_b32 v127, v3
    v_mov_b32 v128, v3
    v_mov_b32 v129, v3
    v_mov_b32 v130, v3
    v_mov_b32 v131, v3
    v_mov_b32 v132, v3
    v_mov_b32 v133, v3
    v_mov_b32 v134, v3
    v_mov_b32 v135, v3
    v_accvgpr_write_b32 a0, 0
    v_accvgpr_write_b32 a1, 0
    v_accvgpr_write_b32 a2, 0
    v_accvgpr_write_b32 a3, 0
    v_accvgpr_write_b32 a4, 0
    v_accvgpr_write_b32 a5, 0
    v_accvgpr_write_b32 a6, 0
    v_accvgpr_write_b32 a7, 0
    v_accvgpr_write_b32 a8, 0
    v_accvgpr_write_b32 a9, 0
    v_accvgpr_write_b32 a10, 0
    v_accvgpr_write_b32 a11, 0
    v_accvgpr_write_b32 a12, 0
    v_accvgpr_write_b32 a13, 0
    v_accvgpr_write_b32 a14, 0
    v_accvgpr_write_b32 a15, 0
    v_accvgpr_write_b32 a16, 0
    v_accvgpr_write_b32 a17, 0
    v_accvgpr_write_b32 a18, 0
    v_accvgpr_write_b32 a19, 0
    v_accvgpr_write_b32 a20, 0
    v_accvgpr_write_b32 a21, 0
    v_accvgpr_write_b32 a22, 0
    v_accvgpr_write_b32 a23, 0
    v_accvgpr_write_b32 a24, 0
    v_accvgpr_write_b32 a25, 0
    v_accvgpr_write_b32 a26, 0
    v_accvgpr_write_b32 a27, 0
    v_accvgpr_write_b32 a28, 0
    v_accvgpr_write_b32 a29, 0
    v_accvgpr_write_b32 a30, 0
    v_accvgpr_write_b32 a31, 0
    v_accvgpr_write_b32 a32, 0
    v_accvgpr_write_b32 a33, 0
    v_accvgpr_write_b32 a34, 0
    v_accvgpr_write_b32 a35, 0
    v_accvgpr_write_b32 a36, 0
    v_accvgpr_write_b32 a37, 0
    v_accvgpr_write_b32 a38, 0
    v_accvgpr_write_b32 a39, 0
    v_accvgpr_write_b32 a40, 0
    v_accvgpr_write_b32 a41, 0
    v_accvgpr_write_b32 a42, 0
    v_accvgpr_write_b32 a43, 0
    v_accvgpr_write_b32 a44, 0
    v_accvgpr_write_b32 a45, 0
    v_accvgpr_write_b32 a46, 0
    v_accvgpr_write_b32 a47, 0
    v_accvgpr_write_b32 a48, 0
    v_accvgpr_write_b32 a49, 0
    v_accvgpr_write_b32 a50, 0
    v_accvgpr_write_b32 a51, 0
    v_accvgpr_write_b32 a52, 0
    v_accvgpr_write_b32 a53, 0
    v_accvgpr_write_b32 a54, 0
    v_accvgpr_write_b32 a55, 0
    v_accvgpr_write_b32 a56, 0
    v_accvgpr_write_b32 a57, 0
    v_accvgpr_write_b32 a58, 0
    v_accvgpr_write_b32 a59, 0
    v_accvgpr_write_b32 a60, 0
    v_accvgpr_write_b32 a61, 0
    v_accvgpr_write_b32 a62, 0
    v_accvgpr_write_b32 a63, 0
    v_accvgpr_write_b32 a64, 0
    v_accvgpr_write_b32 a65, 0
    v_accvgpr_write_b32 a66, 0
    v_accvgpr_write_b32 a67, 0
    v_accvgpr_write_b32 a68, 0
    v_accvgpr_write_b32 a69, 0
    v_accvgpr_write_b32 a70, 0
    v_accvgpr_write_b32 a71, 0
    v_accvgpr_write_b32 a72, 0
    v_accvgpr_write_b32 a73, 0
    v_accvgpr_write_b32 a74, 0
    v_accvgpr_write_b32 a75, 0
    v_accvgpr_write_b32 a76, 0
    v_accvgpr_write_b32 a77, 0
    v_accvgpr_write_b32 a78, 0
    v_accvgpr_write_b32 a79, 0
    v_accvgpr_write_b32 a80, 0
    v_accvgpr_write_b32 a81, 0
    v_accvgpr_write_b32 a82, 0
    v_accvgpr_write_b32 a83, 0
    v_accvgpr_write_b32 a84, 0
    v_accvgpr_write_b32 a85, 0
    v_accvgpr_write_b32 a86, 0
    v_accvgpr_write_b32 a87, 0
    v_accvgpr_write_b32 a88, 0
    v_accvgpr_write_b32 a89, 0
    v_accvgpr_write_b32 a90, 0
    v_accvgpr_write_b32 a91, 0
    v_accvgpr_write_b32 a92, 0
    v_accvgpr_write_b32 a93, 0
    v_accvgpr_write_b32 a94, 0
    v_accvgpr_write_b32 a95, 0
    v_accvgpr_write_b32 a96, 0
    v_accvgpr_write_b32 a97, 0
    v_accvgpr_write_b32 a98, 0
    v_accvgpr_write_b32 a99, 0
    v_accvgpr_write_b32 a100, 0
    v_accvgpr_write_b32 a101, 0
    v_accvgpr_write_b32 a102, 0
    v_accvgpr_write_b32 a103, 0
    v_accvgpr_write_b32 a104, 0
    v_accvgpr_write_b32 a105, 0
    v_accvgpr_write_b32 a106, 0
    v_accvgpr_write_b32 a107, 0
    v_accvgpr_write_b32 a108, 0
    v_accvgpr_write_b32 a109, 0
    v_accvgpr_write_b32 a110, 0
    v_accvgpr_write_b32 a111, 0
    v_accvgpr_write_b32 a112, 0
    v_accvgpr_write_b32 a113, 0
    v_accvgpr_write_b32 a114, 0
    v_accvgpr_write_b32 a115, 0
    v_accvgpr_write_b32 a116, 0
    v_accvgpr_write_b32 a117, 0
    v_accvgpr_write_b32 a118, 0
    v_accvgpr_write_b32 a119, 0
    v_accvgpr_write_b32 a120, 0
    v_accvgpr_write_b32 a121, 0
    v_accvgpr_write_b32 a122, 0
    v_accvgpr_write_b32 a123, 0
    v_accvgpr_write_b32 a124, 0
    v_accvgpr_write_b32 a125, 0
    v_accvgpr_write_b32 a126, 0
    v_accvgpr_write_b32 a127, 0
    v_mov_b32 v28, 0
    v_mov_b32 v29, 0
    v_mov_b32 v30, 0
    v_mov_b32 v31, 0
    s_barrier
    s_mov_b32 s29, 0
    s_mov_b32 s30, 0
    s_add_u32 m0, s28, 0
    s_nop 0
    buffer_load_dwordx4 v22, s[8:11], s29 offen offset:0 lds
    buffer_load_dwordx4 v23, s[8:11], s29 offen offset:1024 lds
    buffer_load_dwordx4 v24, s[8:11], s29 offen offset:2048 lds
    buffer_load_dwordx4 v25, s[8:11], s29 offen offset:3072 lds
    s_add_u32 s29, s29, 16384
    s_min_u32 s29, s29, 507904
    s_add_u32 m0, s28, 16384
    s_nop 0
    buffer_load_dwordx4 v22, s[8:11], s29 offen offset:0 lds
    buffer_load_dwordx4 v23, s[8:11], s29 offen offset:1024 lds
    buffer_load_dwordx4 v24, s[8:11], s29 offen offset:2048 lds
    buffer_load_dwordx4 v25, s[8:11], s29 offen offset:3072 lds
    s_add_u32 s29, s29, 16384
    s_min_u32 s29, s29, 507904
    s_add_u32 m0, s28, 65536
    s_nop 0
    buffer_load_dwordx4 v26, s[12:15], s30 offen offset:0 lds
    buffer_load_dwordx4 v26, s[12:15], s30 offen offset:1024 lds
    buffer_load_dwordx4 v26, s[12:15], s30 offen offset:2048 lds
    buffer_load_dwordx4 v26, s[12:15], s30 offen offset:3072 lds
    s_add_u32 s30, s30, 16384
    s_min_u32 s30, s30, 507904
    s_add_u32 m0, s28, 81920
    s_nop 0
    buffer_load_dwordx4 v26, s[12:15], s30 offen offset:0 lds
    buffer_load_dwordx4 v26, s[12:15], s30 offen offset:1024 lds
    buffer_load_dwordx4 v26, s[12:15], s30 offen offset:2048 lds
    buffer_load_dwordx4 v26, s[12:15], s30 offen offset:3072 lds
    s_add_u32 s30, s30, 16384
    s_min_u32 s30, s30, 507904
    s_add_u32 m0, s28, 32768
    s_nop 0
    buffer_load_dwordx4 v22, s[8:11], s29 offen offset:0 lds
    buffer_load_dwordx4 v23, s[8:11], s29 offen offset:1024 lds
    buffer_load_dwordx4 v24, s[8:11], s29 offen offset:2048 lds
    buffer_load_dwordx4 v25, s[8:11], s29 offen offset:3072 lds
    s_add_u32 s29, s29, 16384
    s_min_u32 s29, s29, 507904
    s_add_u32 m0, s28, 49152
    s_nop 0
    buffer_load_dwordx4 v22, s[8:11], s29 offen offset:0 lds
    buffer_load_dwordx4 v23, s[8:11], s29 offen offset:1024 lds
    buffer_load_dwordx4 v24, s[8:11], s29 offen offset:2048 lds
    buffer_load_dwordx4 v25, s[8:11], s29 offen offset:3072 lds
    s_add_u32 s29, s29, 16384
    s_min_u32 s29, s29, 507904
    s_add_u32 m0, s28, 98304
    s_nop 0
    buffer_load_dwordx4 v26, s[12:15], s30 offen offset:0 lds
    buffer_load_dwordx4 v26, s[12:15], s30 offen offset:1024 lds
    buffer_load_dwordx4 v26, s[12:15], s30 offen offset:2048 lds
    buffer_load_dwordx4 v26, s[12:15], s30 offen offset:3072 lds
    s_add_u32 s30, s30, 16384
    s_min_u32 s30, s30, 507904
    s_waitcnt vmcnt(24)
    s_barrier
    ds_read_b128 a[128:131], v10 offset:0
    ds_read_b128 a[132:135], v11 offset:0
    ds_read_b128 a[136:139], v12 offset:0
    ds_read_b128 a[140:143], v13 offset:0
    ds_read_b128 a[144:147], v14 offset:0
    ds_read_b128 a[148:151], v15 offset:0
    ds_read_b128 a[152:155], v16 offset:0
    ds_read_b128 a[156:159], v17 offset:0
    s_waitcnt lgkmcnt(0)
    v_mfma_f32_32x32x16_bf16 v[40:55], a[128:131], v[168:171], v[104:119]
    v_mfma_f32_32x32x16_bf16 v[40:55], a[132:135], v[172:175], v[40:55]
    v_mfma_f32_32x32x16_bf16 v[40:55], a[136:139], v[176:179], v[40:55]
    v_mfma_f32_32x32x16_bf16 v[40:55], a[140:143], v[180:183], v[40:55]
    v_mfma_f32_32x32x16_bf16 v[40:55], a[144:147], v[184:187], v[40:55]
    v_mfma_f32_32x32x16_bf16 v[40:55], a[148:151], v[188:191], v[40:55]
    v_mfma_f32_32x32x16_bf16 v[40:55], a[152:155], v[192:195], v[40:55]
    v_mfma_f32_32x32x16_bf16 v[40:55], a[156:159], v[196:199], v[40:55]
    v_mfma_f32_32x32x16_bf16 v[56:71], a[128:131], v[200:203], v[120:135]
    v_mfma_f32_32x32x16_bf16 v[56:71], a[132:135], v[204:207], v[56:71]
    v_mfma_f32_32x32x16_bf16 v[56:71], a[136:139], v[208:211], v[56:71]
    v_mfma_f32_32x32x16_bf16 v[56:71], a[140:143], v[212:215], v[56:71]
    v_mfma_f32_32x32x16_bf16 v[56:71], a[144:147], v[216:219], v[56:71]
    v_mfma_f32_32x32x16_bf16 v[56:71], a[148:151], v[220:223], v[56:71]
    v_mfma_f32_32x32x16_bf16 v[56:71], a[152:155], v[224:227], v[56:71]
    v_mfma_f32_32x32x16_bf16 v[56:71], a[156:159], v[228:231], v[56:71]
    ds_read_b128 a[128:131], v10 offset:8192
    ds_read_b128 a[132:135], v11 offset:8192
    ds_read_b128 a[136:139], v12 offset:8192
    ds_read_b128 a[140:143], v13 offset:8192
    ds_read_b128 a[144:147], v14 offset:8192
    ds_read_b128 a[148:151], v15 offset:8192
    ds_read_b128 a[152:155], v16 offset:8192
    ds_read_b128 a[156:159], v17 offset:8192
    s_nop 7
    s_branch L_at_step1
L_at_end:
    s_endpgm
.section .rodata,"a"
.p2align 6
.amdhsa_kernel adaLN_cond__mha_block_cached__mixer_s_mlp__prompt_kernel
  .amdhsa_next_free_vgpr 512
  .amdhsa_next_free_sgpr 102
  .amdhsa_accum_offset 256
  .amdhsa_group_segment_fixed_size 0
  .amdhsa_kernarg_size 120
  .amdhsa_user_sgpr_count 2
  .amdhsa_user_sgpr_kernarg_segment_ptr 1
  .amdhsa_system_sgpr_workgroup_id_x 1
  .amdhsa_float_denorm_mode_32 3
.end_amdhsa_kernel
```
